```python
import torch

def _softmax(x, axis=-1):
    return torch.softmax(x, dim=axis)

def _gelu(x):
    return torch.nn.functional.gelu(x, approximate='tanh')

def _silu(x):
    return torch.nn.functional.silu(x)

def _sigmoid(x):
    return torch.sigmoid(x)

def _layernorm(x, axis=-1, eps=1e-05):
    m = x.mean(dim=axis, keepdim=True)
    v = x.var(dim=axis, keepdim=True, unbiased=False)
    return (x - m) / torch.sqrt(v + eps)

def _scatter_add(tgt, idx, src, axis=0):
    return tgt.clone().index_add_(axis, idx, src)

def _segment_sum(src, seg, n):
    out = torch.zeros((n,) + src.shape[1:], dtype=src.dtype)
    return out.index_add_(0, seg, src)

def _pad(x, pw):
    flat = tuple((v for pair in reversed(pw) for v in pair))
    return torch.nn.functional.pad(x, flat)
kernel_name = 'adaLN_cond__spectral_gfnet__mixer_channel_mlp__prompt'

def setup_inputs():

    _w = lambda a: (lambda t: t.to(torch.bfloat16) if t.is_floating_point() else t)(torch.as_tensor(a))

    def _A_setup():
        B, S, D = (1, 2048, 1024)
        Df = D // 2 + 1
        return {'x': _w((lambda *s: torch.randn(*s, dtype=torch.bfloat16) * 0.05)(B, S, D)), 'w_r': _w((lambda *s: torch.randn(*s, dtype=torch.bfloat16) * 1.6)(S, Df) * 0.02), 'w_i': _w((lambda *s: torch.randn(*s, dtype=torch.bfloat16) * 1.6)(S, Df) * 0.02)}
    _A_in = _A_setup()

    def _B_setup():
        B, S, D, F = (1, 2048, 1024, 3584)
        return {'x': _w((lambda *s: torch.randn(*s, dtype=torch.bfloat16) * 0.05)(B, S, D)), 'w1': _w((lambda *s: torch.randn(*s, dtype=torch.bfloat16) * 3.2)(D, F) * D ** (-0.5)), 'b1': _w((lambda *s: torch.randn(*s, dtype=torch.bfloat16) * 0.8)(F)), 'w2': _w((lambda *s: torch.randn(*s, dtype=torch.bfloat16) * 0.05)(F, D) * F ** (-0.5)), 'b2': _w((lambda *s: torch.randn(*s, dtype=torch.bfloat16) * 0.1)(D))}
    _B_in = _B_setup()
    return {'A_x': _A_in['x'], 'A_w_r': _A_in['w_r'], 'A_w_i': _A_in['w_i'], 'B_x': _B_in['x'], 'B_w1': _B_in['w1'], 'B_b1': _B_in['b1'], 'B_w2': _B_in['w2'], 'B_b2': _B_in['b2'], 'c': _w((lambda *s: torch.randn(*s, dtype=torch.bfloat16) * 0.2)(1, 1024) * 8.0), 'w_mod': _w((lambda *s: torch.randn(*s, dtype=torch.bfloat16) * 0.2)(1024, 6 * 1024) * 1024 ** (-0.5) * 8.0)}

def reference(A_x, A_w_r, A_w_i, B_x, B_w1, B_b1, B_w2, B_b2, c, w_mod):

    def _A_ref(x, w_r, w_i):
        B, S, D = x.shape
        X = (lambda x, axes=(-2, -1): torch.fft.rfft2(x.float(), dim=axes))(x, axes=(-2, -1))
        W = w_r + 1j * w_i
        X = X * W
        y = (lambda x, s, axes=(-2, -1): torch.fft.irfft2(x, s=s, dim=axes).to(torch.bfloat16))(X, (S, D), axes=(-2, -1))
        return y

    def _B_ref(x, w1, b1, w2, b2):
        y = _layernorm(x, axis=-1)
        h = _gelu(torch.einsum('bsd,df->bsf', y, w1) + b1)
        return torch.einsum('bsf,fd->bsd', h, w2) + b2
    x = A_x
    mod = (_silu(c) @ w_mod).reshape(c.shape[0], 6, 1, -1)
    sa, ca, ga, sb, cb, gb = (mod[:, 0].clone(), mod[:, 1].clone(), mod[:, 2].clone(), mod[:, 3].clone(), mod[:, 4].clone(), mod[:, 5].clone())
    h = _layernorm(x, axis=-1) * (1 + ca) + sa
    x = x + ga * _A_ref(h, A_w_r, A_w_i)
    h = _layernorm(x, axis=-1) * (1 + cb) + sb
    x = x + gb * _B_ref(h, B_w1, B_b1, B_w2, B_b2)
    return x
```

```asm
; @launch kernel=uni_kernel grid=(256,1,1) block=(512,1,1) lds=163840
.amdgcn_target "amdgcn-amd-amdhsa--gfx950"
.text
.p2align 8
.globl uni_kernel
.type uni_kernel,@function
uni_kernel:
  s_cmp_ge_u32 s2, 256
  s_cbranch_scc1 CG_end
  s_load_dwordx2 s[72:73], s[0:1], 72
  s_load_dwordx2 s[76:77], s[0:1], 64
  s_load_dwordx2 s[68:69], s[0:1], 88
  s_memrealtime s[80:81]
  s_lshr_b32 s48, s2, 3
  v_subrev_u32 v136, 448, v0
  v_min_u32 v136, 64, v136
  s_getpc_b64 s[90:91]
CP9_uni_kernel:
  s_add_u32 s90, s90, PRE_A-CP9_uni_kernel
  s_addc_u32 s91, s91, 0
  s_lshl_b32 s94, s48, 7
  v_lshl_add_u32 v138, v136, 12, s94
  v_cmp_gt_u32 vcc, CODE_END-PRE_A, v138
  s_nop 0
  s_and_saveexec_b64 s[92:93], vcc
  s_nop 2
  s_cbranch_execz CP9_uni_kernele
  v_mov_b32 v139, s91
  v_add_co_u32 v138, vcc, s90, v138
  s_nop 1
  v_addc_co_u32 v139, vcc, 0, v139, vcc
  global_load_dword v147, v[138:139], off
CP9_uni_kernele:
  s_mov_b64 exec, s[92:93]
PRE_A:
  v_lshrrev_b32 v5, 3, v0
  v_mul_u32_u24 v93, 12288, v5
  v_and_b32 v4, 7, v0
  v_lshl_add_u32 v93, v4, 4, v93
  v_lshlrev_b32 v94, 1, v5
  s_and_b32 s86, s2, 31
  s_lshr_b32 s87, s2, 5
  s_mul_i32 s82, s87, 1572864
  s_lshl_b32 s20, s86, 7
  s_add_u32 s82, s82, s20
  s_lshl_b32 s85, s87, 8
  s_mov_b32 s78, 2048
  s_mov_b32 s79, 0x20000
  s_mov_b32 s74, 12582912
  s_mov_b32 s75, 0x20000
  s_mov_b32 s70, 256
  s_mov_b32 s71, 0x20000
  v_lshlrev_b32 v133, 2, v0
  s_cmp_lg_u32 s2, 0
  s_waitcnt lgkmcnt(0)
  s_cbranch_scc1 EP_np
  s_or_b32 s36, s80, 1
  s_mul_i32 s36, s36, 0x9e3779b1
  s_lshr_b32 s20, s36, 15
  s_xor_b32 s36, s36, s20
  s_mul_i32 s36, s36, 0x85ebca6b
  s_lshr_b32 s20, s36, 13
  s_xor_b32 s36, s36, s20
  v_mov_b32 v132, s36
  s_movk_i32 s70, 192
  buffer_store_dword v132, v133, s[68:71], 0 offen sc1
  s_movk_i32 s70, 256
EP_np:
  buffer_load_ushort v96, v94, s[76:79], s85 offen offset:0
  buffer_load_ushort v97, v94, s[76:79], s85 offen offset:128
  buffer_load_dwordx4 v[100:103], v93, s[72:75], s82 offen
  s_add_u32 s82, s82, 786432
  buffer_load_dwordx4 v[104:107], v93, s[72:75], s82 offen
  s_load_dwordx2 s[4:5], s[0:1], 0
  s_load_dwordx2 s[6:7], s[0:1], 96
  s_load_dwordx8 s[8:15], s[0:1], 32
  s_load_dwordx2 s[16:17], s[0:1], 80
  s_load_dwordx2 s[56:57], s[0:1], 8
  s_load_dwordx2 s[60:61], s[0:1], 16
  v_lshrrev_b32 v4, 6, v0
  v_and_b32 v1, 63, v0
  v_readfirstlane_b32 s18, v4
  v_and_b32 v2, 15, v1
  v_lshrrev_b32 v3, 4, v1
  s_and_b32 s21, s2, 3
  s_lshl_b32 s21, s21, 2
  s_lshr_b32 s20, s2, 3
  s_and_b32 s20, s20, 3
  s_add_u32 s21, s21, s20
  s_and_b32 s22, s2, 7
  s_lshr_b32 s22, s22, 2
  s_lshl_b32 s22, s22, 3
  s_lshr_b32 s20, s2, 5
  s_add_u32 s22, s22, s20
  s_and_b32 s23, s18, 1
  s_bfe_u32 s24, s18, 0x10001
  s_mov_b32 s19, 0xffff0000
  v_lshlrev_b32 v12, 4, v1
  s_lshr_b32 s48, s2, 3
  s_lshl_b32 s37, s21, 4
  s_add_u32 s37, s37, s22
  s_lshl_b32 s38, s18, 8
  s_add_u32 s38, s38, s37
  s_lshl_b32 s38, s38, 11
  s_mov_b32 s58, 2101248
  s_mov_b32 s59, 0x20000
  s_mov_b32 s62, 2101248
  s_mov_b32 s63, 0x20000
  v_add_u32 v23, 65536, v12
  s_lshl_b32 s64, s87, 13
  s_lshl_b32 s20, s86, 8
  s_add_u32 s64, s64, s20
  s_and_b32 s86, s2, 31
  s_lshl_b32 s86, s86, 1
  s_add_u32 s86, s86, 0
  s_lshl_b32 s65, s87, 14
  s_lshl_b32 s20, s86, 8
  s_add_u32 s65, s65, s20
  s_add_u32 s65, s65, 655360
  s_add_u32 s86, s86, 32
  s_mul_i32 s83, s87, 1572864
  s_lshl_b32 s20, s86, 7
  s_add_u32 s83, s83, s20
  s_and_b32 s86, s2, 31
  s_lshl_b32 s86, s86, 1
  s_add_u32 s86, s86, 1
  s_lshl_b32 s66, s87, 14
  s_lshl_b32 s20, s86, 8
  s_add_u32 s66, s66, s20
  s_add_u32 s66, s66, 655360
  s_add_u32 s86, s86, 32
  s_mul_i32 s84, s87, 1572864
  s_lshl_b32 s20, s86, 7
  s_add_u32 s84, s84, s20
  s_waitcnt lgkmcnt(0)
  s_mov_b32 s92, s4
  s_mov_b32 s93, s5
  s_mov_b32 s94, 4194304
  s_mov_b32 s95, 0x20000
  s_mov_b32 s44, s6
  s_mov_b32 s45, s7
  s_mov_b32 s46, 3145728
  s_mov_b32 s47, 0x20000
  s_add_u32 s32, s6, 262144
  s_addc_u32 s33, s7, 0
  s_mov_b32 s34, 0x100000
  s_mov_b32 s35, 0x20000
  buffer_load_dwordx4 v[40:43], v12, s[92:95], s38 offen
  buffer_load_dwordx4 v[44:47], v12, s[92:95], s38 offen offset:1024
  v_mov_b32 v141, 0
  s_cmp_ge_u32 s18, 4
  s_nop 0
  s_cbranch_scc1 TA_hi
  s_lshl_b32 s88, s23, 4
  s_lshl_b32 s89, s24, 4
  v_add_u32 v8, s89, v2
  v_add_u32 v9, s88, v3
  s_lshl_b32 s20, s18, 11
  s_add_u32 s20, s20, 82176
  v_add_u32 v11, s20, v12
  v_add_u32 v4, 0, v9
  v_mul_u32_u24 v4, v4, v8
  v_cvt_f32_u32 v7, v4
  v_mul_f32 v7, 0x3d000000, v7
  v_cos_f32 v5, v7
  v_sin_f32 v6, v7
  v_mul_f32 v5, 0x3e3504f3, v5
  v_mul_f32 v6, 0x3e3504f3, v6
  v_cvt_pk_f16_f32 v132, v5, v6
  v_cvt_pk_f16_f32 v136, -v6, v5
  v_add_u32 v4, 4, v9
  v_mul_u32_u24 v4, v4, v8
  v_cvt_f32_u32 v7, v4
  v_mul_f32 v7, 0x3d000000, v7
  v_cos_f32 v5, v7
  v_sin_f32 v6, v7
  v_mul_f32 v5, 0x3e3504f3, v5
  v_mul_f32 v6, 0x3e3504f3, v6
  v_cvt_pk_f16_f32 v133, v5, v6
  v_cvt_pk_f16_f32 v137, -v6, v5
  v_add_u32 v4, 8, v9
  v_mul_u32_u24 v4, v4, v8
  v_cvt_f32_u32 v7, v4
  v_mul_f32 v7, 0x3d000000, v7
  v_cos_f32 v5, v7
  v_sin_f32 v6, v7
  v_mul_f32 v5, 0x3e3504f3, v5
  v_mul_f32 v6, 0x3e3504f3, v6
  v_cvt_pk_f16_f32 v134, v5, v6
  v_cvt_pk_f16_f32 v138, -v6, v5
  v_add_u32 v4, 12, v9
  v_mul_u32_u24 v4, v4, v8
  v_cvt_f32_u32 v7, v4
  v_mul_f32 v7, 0x3d000000, v7
  v_cos_f32 v5, v7
  v_sin_f32 v6, v7
  v_mul_f32 v5, 0x3e3504f3, v5
  v_mul_f32 v6, 0x3e3504f3, v6
  v_cvt_pk_f16_f32 v135, v5, v6
  v_cvt_pk_f16_f32 v139, -v6, v5
  ds_write_b128 v11, v[132:135] offset:0
  ds_write_b128 v11, v[136:139] offset:1024
  s_cmp_lg_u32 s18, 0
  s_cbranch_scc1 TA_done
  s_and_b32 s88, s2, 1
  s_lshl_b32 s88, s88, 7
  buffer_load_dword v140, v141, s[68:71], s88 offen sc1
  s_branch TA_done
TA_hi:
  s_cmp_eq_u32 s18, 5
  s_cbranch_scc1 TA_5
  s_cmp_eq_u32 s18, 6
  s_cbranch_scc1 TA_6
  s_cmp_eq_u32 s18, 7
  s_cbranch_scc1 TA_7
  v_lshl_add_u32 v4, v3, 2, 0
  v_add_u32 v5, 0, v2
  v_mul_u32_u24 v4, v4, v5
  v_cvt_f32_u32 v7, v4
  v_mul_f32 v7, 0x3b000000, v7
  v_cos_f32 v132, v7
  v_sin_f32 v140, v7
  v_lshl_add_u32 v4, v3, 2, 1
  v_add_u32 v5, 0, v2
  v_mul_u32_u24 v4, v4, v5
  v_cvt_f32_u32 v7, v4
  v_mul_f32 v7, 0x3b000000, v7
  v_cos_f32 v133, v7
  v_sin_f32 v141, v7
  v_lshl_add_u32 v4, v3, 2, 2
  v_add_u32 v5, 0, v2
  v_mul_u32_u24 v4, v4, v5
  v_cvt_f32_u32 v7, v4
  v_mul_f32 v7, 0x3b000000, v7
  v_cos_f32 v134, v7
  v_sin_f32 v142, v7
  v_lshl_add_u32 v4, v3, 2, 3
  v_add_u32 v5, 0, v2
  v_mul_u32_u24 v4, v4, v5
  v_cvt_f32_u32 v7, v4
  v_mul_f32 v7, 0x3b000000, v7
  v_cos_f32 v135, v7
  v_sin_f32 v143, v7
  v_lshl_add_u32 v4, v3, 2, 0
  v_add_u32 v5, 16, v2
  v_mul_u32_u24 v4, v4, v5
  v_cvt_f32_u32 v7, v4
  v_mul_f32 v7, 0x3b000000, v7
  v_cos_f32 v136, v7
  v_sin_f32 v144, v7
  v_lshl_add_u32 v4, v3, 2, 1
  v_add_u32 v5, 16, v2
  v_mul_u32_u24 v4, v4, v5
  v_cvt_f32_u32 v7, v4
  v_mul_f32 v7, 0x3b000000, v7
  v_cos_f32 v137, v7
  v_sin_f32 v145, v7
  v_lshl_add_u32 v4, v3, 2, 2
  v_add_u32 v5, 16, v2
  v_mul_u32_u24 v4, v4, v5
  v_cvt_f32_u32 v7, v4
  v_mul_f32 v7, 0x3b000000, v7
  v_cos_f32 v138, v7
  v_sin_f32 v146, v7
  v_lshl_add_u32 v4, v3, 2, 3
  v_add_u32 v5, 16, v2
  v_mul_u32_u24 v4, v4, v5
  v_cvt_f32_u32 v7, v4
  v_mul_f32 v7, 0x3b000000, v7
  v_cos_f32 v139, v7
  v_sin_f32 v147, v7
  v_add_u32 v11, 16640, v23
  ds_write_b128 v11, v[132:135] offset:8192
  ds_write_b128 v11, v[136:139] offset:9216
  ds_write_b128 v11, v[140:143] offset:10240
  ds_write_b128 v11, v[144:147] offset:11264
  s_branch TA_done
TA_5:
  v_lshl_add_u32 v4, v3, 2, 0
  v_mul_u32_u24 v4, v4, v2
  v_cvt_f32_u32 v7, v4
  v_mul_f32 v7, 0x3d800000, v7
  v_cos_f32 v5, v7
  v_sin_f32 v6, v7
  v_mul_f32 v5, 0x3e800000, v5
  v_mul_f32 v6, 0x3e800000, v6
  v_cvt_pk_f16_f32 v132, v5, v6
  v_cvt_pk_f16_f32 v136, -v6, v5
  v_lshl_add_u32 v4, v3, 2, 1
  v_mul_u32_u24 v4, v4, v2
  v_cvt_f32_u32 v7, v4
  v_mul_f32 v7, 0x3d800000, v7
  v_cos_f32 v5, v7
  v_sin_f32 v6, v7
  v_mul_f32 v5, 0x3e800000, v5
  v_mul_f32 v6, 0x3e800000, v6
  v_cvt_pk_f16_f32 v133, v5, v6
  v_cvt_pk_f16_f32 v137, -v6, v5
  v_lshl_add_u32 v4, v3, 2, 2
  v_mul_u32_u24 v4, v4, v2
  v_cvt_f32_u32 v7, v4
  v_mul_f32 v7, 0x3d800000, v7
  v_cos_f32 v5, v7
  v_sin_f32 v6, v7
  v_mul_f32 v5, 0x3e800000, v5
  v_mul_f32 v6, 0x3e800000, v6
  v_cvt_pk_f16_f32 v134, v5, v6
  v_cvt_pk_f16_f32 v138, -v6, v5
  v_lshl_add_u32 v4, v3, 2, 3
  v_mul_u32_u24 v4, v4, v2
  v_cvt_f32_u32 v7, v4
  v_mul_f32 v7, 0x3d800000, v7
  v_cos_f32 v5, v7
  v_sin_f32 v6, v7
  v_mul_f32 v5, 0x3e800000, v5
  v_mul_f32 v6, 0x3e800000, v6
  v_cvt_pk_f16_f32 v135, v5, v6
  v_cvt_pk_f16_f32 v139, -v6, v5
  v_add_u32 v11, 16640, v23
  ds_write_b128 v11, v[132:135] offset:12288
  ds_write_b128 v11, v[136:139] offset:13312
  s_branch TA_done
TA_6:
  v_lshrrev_b32 v4, 3, v2
  v_lshrrev_b32 v5, 1, v3
  v_cmp_eq_u32 vcc, v4, v5
  v_mov_b32 v6, 0x3eb504f3
  s_nop 0
  v_cndmask_b32 v10, 0, v6, vcc
  v_and_b32 v11, 7, v2
  v_and_b32 v4, 1, v3
  v_lshl_add_u32 v4, v4, 2, 0
  v_lshl_add_u32 v4, v4, 8, s37
  v_mul_u32_u24 v4, v4, v11
  v_and_b32 v4, 0x7ff, v4
  v_cvt_f32_u32 v7, v4
  v_mul_f32 v7, 0x3a000000, v7
  v_cos_f32 v5, v7
  v_sin_f32 v6, v7
  v_mul_f32 v5, v10, v5
  v_mul_f32 v6, v10, v6
  v_cvt_pk_f16_f32 v132, v5, v6
  v_cvt_pk_f16_f32 v136, -v6, v5
  v_cvt_pk_f16_f32 v140, v5, -v6
  v_cvt_pk_f16_f32 v144, -v6, -v5
  v_and_b32 v4, 1, v3
  v_lshl_add_u32 v4, v4, 2, 1
  v_lshl_add_u32 v4, v4, 8, s37
  v_mul_u32_u24 v4, v4, v11
  v_and_b32 v4, 0x7ff, v4
  v_cvt_f32_u32 v7, v4
  v_mul_f32 v7, 0x3a000000, v7
  v_cos_f32 v5, v7
  v_sin_f32 v6, v7
  v_mul_f32 v5, v10, v5
  v_mul_f32 v6, v10, v6
  v_cvt_pk_f16_f32 v133, v5, v6
  v_cvt_pk_f16_f32 v137, -v6, v5
  v_cvt_pk_f16_f32 v141, v5, -v6
  v_cvt_pk_f16_f32 v145, -v6, -v5
  v_and_b32 v4, 1, v3
  v_lshl_add_u32 v4, v4, 2, 2
  v_lshl_add_u32 v4, v4, 8, s37
  v_mul_u32_u24 v4, v4, v11
  v_and_b32 v4, 0x7ff, v4
  v_cvt_f32_u32 v7, v4
  v_mul_f32 v7, 0x3a000000, v7
  v_cos_f32 v5, v7
  v_sin_f32 v6, v7
  v_mul_f32 v5, v10, v5
  v_mul_f32 v6, v10, v6
  v_cvt_pk_f16_f32 v134, v5, v6
  v_cvt_pk_f16_f32 v138, -v6, v5
  v_cvt_pk_f16_f32 v142, v5, -v6
  v_cvt_pk_f16_f32 v146, -v6, -v5
  v_and_b32 v4, 1, v3
  v_lshl_add_u32 v4, v4, 2, 3
  v_lshl_add_u32 v4, v4, 8, s37
  v_mul_u32_u24 v4, v4, v11
  v_and_b32 v4, 0x7ff, v4
  v_cvt_f32_u32 v7, v4
  v_mul_f32 v7, 0x3a000000, v7
  v_cos_f32 v5, v7
  v_sin_f32 v6, v7
  v_mul_f32 v5, v10, v5
  v_mul_f32 v6, v10, v6
  v_cvt_pk_f16_f32 v135, v5, v6
  v_cvt_pk_f16_f32 v139, -v6, v5
  v_cvt_pk_f16_f32 v143, v5, -v6
  v_cvt_pk_f16_f32 v147, -v6, -v5
  v_add_u32 v11, 16640, v23
  ds_write_b128 v11, v[132:135] offset:14336
  ds_write_b128 v11, v[136:139] offset:15360
  ds_write_b128 v11, v[140:143] offset:16384
  ds_write_b128 v11, v[144:147] offset:17408
  s_branch TA_done
TA_7:
  s_cmp_lg_u32 s2, 1
  s_cbranch_scc1 TA_done
  v_mov_b32 v132, 0
  v_mov_b32 v133, 0
  v_mov_b32 v134, 0
  v_mov_b32 v135, 0
  s_mov_b32 s20, 360448
  s_mov_b32 s88, 368640
  buffer_store_dwordx4 v[132:135], v12, s[32:35], s20 offen offset:0 sc1
  buffer_store_dwordx4 v[132:135], v12, s[32:35], s20 offen offset:1024 sc1
  buffer_store_dwordx4 v[132:135], v12, s[32:35], s20 offen offset:2048 sc1
  buffer_store_dwordx4 v[132:135], v12, s[32:35], s20 offen offset:3072 sc1
  buffer_store_dwordx4 v[132:135], v12, s[32:35], s88 offen offset:0 sc1
  buffer_store_dwordx4 v[132:135], v12, s[32:35], s88 offen offset:1024 sc1
TA_done:
  v_and_b32 v4, 7, v1
  v_lshlrev_b32 v4, 5, v4
  v_lshl_add_u32 v4, v3, 2, v4
  s_lshl_b32 s20, s18, 8
  v_add_u32 v95, s20, v4
  s_and_b32 s20, s2, 7
  s_lshl_b32 s52, s20, 5
  s_add_u32 s20, s20, 1
  s_lshr_b32 s50, s20, 1
  s_and_b32 s51, s20, 1
  s_lshl_b32 s51, s51, 5
  s_cmp_eq_u32 s50, 0
  s_cselect_b32 s51, 0, s51
  s_lshr_b32 s20, s2, 3
  s_add_u32 s51, s51, s20
  s_add_u32 s52, s52, s20
  v_bfe_u32 v4, v0, 4, 4
  v_lshl_add_u32 v4, v2, 4, v4
  v_lshl_add_u32 v6, v4, 3, s50
  v_sub_u32 v7, 2048, v6
  v_and_b32 v7, 2047, v7
  s_lshl_b32 s53, s51, 4
  s_sub_u32 s20, 1010, s53
  s_cmp_ge_u32 s18, 4
  s_cselect_b32 s53, s20, s53
  s_cselect_b64 vcc, -1, 0
  s_cselect_b32 s54, 1024, 0
  v_cndmask_b32 v4, v6, v7, vcc
  v_mul_u32_u24 v92, 1026, v4
  s_lshl_b32 s20, s2, 3
  s_add_u32 s20, s20, s18
  s_cmp_eq_u32 s20, 15
  s_cbranch_scc1 W_z
  s_cmp_eq_u32 s18, 0
  s_cbranch_scc1 W_e
  s_waitcnt vmcnt(2)
W_e:
  s_waitcnt vmcnt(3)
W_z:
  s_waitcnt vmcnt(8)
  v_lshlrev_b32 v96, 16, v96
  v_mul_f32 v98, 0xbfb8aa3b, v96
  v_lshlrev_b32 v97, 16, v97
  v_mul_f32 v99, 0xbfb8aa3b, v97
  v_exp_f32 v98, v98
  v_exp_f32 v99, v99
  v_add_f32 v98, 1.0, v98
  v_add_f32 v99, 1.0, v99
  v_rcp_f32 v98, v98
  v_rcp_f32 v99, v99
  v_mul_f32 v96, v96, v98
  v_mul_f32 v97, v97, v99
  v_cvt_pk_bf16_f32 v98, v96, v97
  v_lshlrev_b32 v96, 16, v98
  v_and_b32 v97, s19, v98
  v_lshlrev_b32 v4, 16, v100
  v_and_b32 v5, s19, v100
  v_pk_mul_f32 v[124:125], v[4:5], v[96:97] op_sel_hi:[1,0]
  v_lshlrev_b32 v6, 16, v101
  v_and_b32 v7, s19, v101
  v_pk_mul_f32 v[126:127], v[6:7], v[96:97] op_sel_hi:[1,0]
  v_lshlrev_b32 v4, 16, v102
  v_and_b32 v5, s19, v102
  v_pk_mul_f32 v[128:129], v[4:5], v[96:97] op_sel_hi:[1,0]
  v_lshlrev_b32 v6, 16, v103
  v_and_b32 v7, s19, v103
  v_pk_mul_f32 v[130:131], v[6:7], v[96:97] op_sel_hi:[1,0]
  v_lshlrev_b32 v4, 16, v104
  v_and_b32 v5, s19, v104
  v_pk_fma_f32 v[124:125], v[4:5], v[96:97], v[124:125] op_sel:[0,1,0] op_sel_hi:[1,1,1]
  v_lshlrev_b32 v6, 16, v105
  v_and_b32 v7, s19, v105
  v_pk_fma_f32 v[126:127], v[6:7], v[96:97], v[126:127] op_sel:[0,1,0] op_sel_hi:[1,1,1]
  v_lshlrev_b32 v4, 16, v106
  v_and_b32 v5, s19, v106
  v_pk_fma_f32 v[128:129], v[4:5], v[96:97], v[128:129] op_sel:[0,1,0] op_sel_hi:[1,1,1]
  v_lshlrev_b32 v6, 16, v107
  v_and_b32 v7, s19, v107
  v_pk_fma_f32 v[130:131], v[6:7], v[96:97], v[130:131] op_sel:[0,1,0] op_sel_hi:[1,1,1]
  v_permlane16_swap_b32 v124, v125
  v_permlane16_swap_b32 v126, v127
  v_permlane16_swap_b32 v128, v129
  v_permlane16_swap_b32 v130, v131
  v_add_f32 v124, v124, v125
  v_add_f32 v126, v126, v127
  v_add_f32 v128, v128, v129
  v_add_f32 v130, v130, v131
  v_permlane32_swap_b32 v124, v126
  s_nop 0
  v_permlane32_swap_b32 v128, v130
  v_add_f32 v124, v124, v126
  v_add_f32 v128, v128, v130
  s_nop 0
  v_add_f32_dpp v124, v124, v124 row_ror:8 row_mask:0xf bank_mask:0xf
  v_add_f32_dpp v128, v128, v128 row_ror:8 row_mask:0xf bank_mask:0xf
  ds_write_b32 v95, v124 offset:0
  ds_write_b32 v95, v128 offset:16
  s_waitcnt lgkmcnt(0)
  s_barrier
  s_cmp_lg_u32 s18, 0
  s_cbranch_scc1 G0_nf
  v_lshlrev_b32 v10, 2, v1
  ds_read2st64_b32 v[132:133], v10 offset0:0 offset1:1
  ds_read2st64_b32 v[134:135], v10 offset0:2 offset1:3
  ds_read2st64_b32 v[136:137], v10 offset0:4 offset1:5
  ds_read2st64_b32 v[138:139], v10 offset0:6 offset1:7
  v_lshlrev_b32 v4, 1, v1
  v_and_b32 v4, 24, v4
  v_and_b32 v5, 3, v1
  v_cmp_eq_u32 vcc, 0, v5
  v_mov_b32 v5, 0xff
  s_nop 0
  v_cndmask_b32 v5, 0, v5, vcc
  s_waitcnt lgkmcnt(0)
  v_pk_add_f32 v[132:133], v[132:133], v[136:137]
  v_pk_add_f32 v[134:135], v[134:135], v[138:139]
  v_pk_add_f32 v[132:133], v[132:133], v[134:135]
  v_add_f32 v132, v132, v133
  s_waitcnt vmcnt(0)
  v_cmp_eq_u32 vcc, 0, v140
  s_nop 4
  s_cbranch_vccz EP_poll_ok
EP_poll:
  buffer_load_dword v140, v141, s[68:71], s88 offen sc1
  s_waitcnt vmcnt(0)
  v_cmp_eq_u32 vcc, 0, v140
  s_nop 4
  s_cbranch_vccz EP_poll_ok
  s_sleep 2
  s_branch EP_poll
EP_poll_ok:
  v_lshrrev_b32 v4, v4, v140
  v_bfi_b32 v132, v5, v4, v132
  buffer_store_dword v132, v10, s[44:47], s64 offen sc1
  v_mov_b32 v141, 6144
  ds_write_b32 v141, v140
G0_nf:
  v_and_b32 v11, 7, v2
  v_lshrrev_b32 v4, 1, v3
  v_lshl_add_u32 v4, v4, 4, v2
  s_lshl_b32 s20, s18, 6
  s_add_u32 s20, s20, 0
  v_add_u32 v4, s20, v4
  v_lshrrev_b32 v5, 3, v4
  v_and_b32 v5, 28, v5
  v_xor_b32 v4, v4, v5
  v_and_b32 v5, 1, v3
  v_mul_u32_u24 v5, 8256, v5
  v_lshl_add_u32 v80, v4, 2, v5
  v_add_u32 v80, 65536, v80
  v_lshrrev_b32 v4, 1, v3
  v_lshl_add_u32 v4, v4, 4, v2
  s_lshl_b32 s20, s18, 6
  s_add_u32 s20, s20, 0
  v_add_u32 v4, s20, v4
  v_sub_u32 v4, 512, v4
  v_and_b32 v4, 511, v4
  v_lshrrev_b32 v5, 3, v4
  v_and_b32 v5, 28, v5
  v_xor_b32 v4, v4, v5
  v_and_b32 v5, 1, v3
  v_mul_u32_u24 v5, 8256, v5
  v_lshl_add_u32 v81, v4, 2, v5
  v_add_u32 v81, 65536, v81
  v_lshrrev_b32 v4, 1, v3
  v_lshl_add_u32 v4, v4, 4, v2
  s_lshl_b32 s20, s18, 6
  s_add_u32 s20, s20, 32
  v_add_u32 v4, s20, v4
  v_lshrrev_b32 v5, 3, v4
  v_and_b32 v5, 28, v5
  v_xor_b32 v4, v4, v5
  v_and_b32 v5, 1, v3
  v_mul_u32_u24 v5, 8256, v5
  v_lshl_add_u32 v82, v4, 2, v5
  v_add_u32 v82, 65536, v82
  v_lshrrev_b32 v4, 1, v3
  v_lshl_add_u32 v4, v4, 4, v2
  s_lshl_b32 s20, s18, 6
  s_add_u32 s20, s20, 32
  v_add_u32 v4, s20, v4
  v_sub_u32 v4, 512, v4
  v_and_b32 v4, 511, v4
  v_lshrrev_b32 v5, 3, v4
  v_and_b32 v5, 28, v5
  v_xor_b32 v4, v4, v5
  v_and_b32 v5, 1, v3
  v_mul_u32_u24 v5, 8256, v5
  v_lshl_add_u32 v83, v4, 2, v5
  v_add_u32 v83, 65536, v83
  v_lshrrev_b32 v4, 3, v2
  v_lshlrev_b32 v4, 1, v4
  s_lshl_b32 s20, s18, 3
  s_add_u32 s20, s20, 0
  v_add_u32 v4, s20, v4
  v_lshlrev_b32 v5, 6, v11
  v_subrev_u32 v5, 32, v5
  v_max_i32 v5, 0, v5
  v_add_u32 v5, v5, v4
  v_mul_u32_u24 v5, 16640, v5
  v_and_b32 v6, 1, v3
  v_lshl_add_u32 v5, v6, 5, v5
  v_lshrrev_b32 v6, 1, v3
  v_lshl_add_u32 v5, v6, 4, v5
  v_and_b32 v6, 3, v11
  v_cmp_eq_u32 vcc, 0, v6
  v_mov_b32 v7, 64
  s_nop 0
  v_cndmask_b32 v7, v7, 32, vcc
  v_cmp_lt_u32 vcc, 4, v11
  s_nop 1
  v_cndmask_b32 v7, v7, 0, vcc
  v_cmp_lt_u32 vcc, v4, v7
  v_mov_b32 v6, 2147483632
  s_nop 0
  v_cndmask_b32 v84, v6, v5, vcc
  v_lshrrev_b32 v4, 3, v2
  v_lshlrev_b32 v4, 1, v4
  s_lshl_b32 s20, s18, 3
  s_add_u32 s20, s20, 1
  v_add_u32 v4, s20, v4
  v_lshlrev_b32 v5, 6, v11
  v_subrev_u32 v5, 32, v5
  v_max_i32 v5, 0, v5
  v_add_u32 v5, v5, v4
  v_mul_u32_u24 v5, 16640, v5
  v_and_b32 v6, 1, v3
  v_lshl_add_u32 v5, v6, 5, v5
  v_lshrrev_b32 v6, 1, v3
  v_lshl_add_u32 v5, v6, 4, v5
  v_and_b32 v6, 3, v11
  v_cmp_eq_u32 vcc, 0, v6
  v_mov_b32 v7, 64
  s_nop 0
  v_cndmask_b32 v7, v7, 32, vcc
  v_cmp_lt_u32 vcc, 4, v11
  s_nop 1
  v_cndmask_b32 v7, v7, 0, vcc
  v_cmp_lt_u32 vcc, v4, v7
  v_mov_b32 v6, 2147483632
  s_nop 0
  v_cndmask_b32 v85, v6, v5, vcc
  v_lshrrev_b32 v4, 3, v2
  v_lshlrev_b32 v4, 1, v4
  s_lshl_b32 s20, s18, 3
  s_add_u32 s20, s20, 4
  v_add_u32 v4, s20, v4
  v_lshlrev_b32 v5, 6, v11
  v_subrev_u32 v5, 32, v5
  v_max_i32 v5, 0, v5
  v_add_u32 v5, v5, v4
  v_mul_u32_u24 v5, 16640, v5
  v_and_b32 v6, 1, v3
  v_lshl_add_u32 v5, v6, 5, v5
  v_lshrrev_b32 v6, 1, v3
  v_lshl_add_u32 v5, v6, 4, v5
  v_and_b32 v6, 3, v11
  v_cmp_eq_u32 vcc, 0, v6
  v_mov_b32 v7, 64
  s_nop 0
  v_cndmask_b32 v7, v7, 32, vcc
  v_cmp_lt_u32 vcc, 4, v11
  s_nop 1
  v_cndmask_b32 v7, v7, 0, vcc
  v_cmp_lt_u32 vcc, v4, v7
  v_mov_b32 v6, 2147483632
  s_nop 0
  v_cndmask_b32 v86, v6, v5, vcc
  v_lshrrev_b32 v4, 3, v2
  v_lshlrev_b32 v4, 1, v4
  s_lshl_b32 s20, s18, 3
  s_add_u32 s20, s20, 5
  v_add_u32 v4, s20, v4
  v_lshlrev_b32 v5, 6, v11
  v_subrev_u32 v5, 32, v5
  v_max_i32 v5, 0, v5
  v_add_u32 v5, v5, v4
  v_mul_u32_u24 v5, 16640, v5
  v_and_b32 v6, 1, v3
  v_lshl_add_u32 v5, v6, 5, v5
  v_lshrrev_b32 v6, 1, v3
  v_lshl_add_u32 v5, v6, 4, v5
  v_and_b32 v6, 3, v11
  v_cmp_eq_u32 vcc, 0, v6
  v_mov_b32 v7, 64
  s_nop 0
  v_cndmask_b32 v7, v7, 32, vcc
  v_cmp_lt_u32 vcc, 4, v11
  s_nop 1
  v_cndmask_b32 v7, v7, 0, vcc
  v_cmp_lt_u32 vcc, v4, v7
  v_mov_b32 v6, 2147483632
  s_nop 0
  v_cndmask_b32 v87, v6, v5, vcc
  s_waitcnt lgkmcnt(0)
  s_barrier
  v_mov_b32 v9, 6144
  ds_read_b32 v8, v9
  s_lshl_b32 s20, s2, 3
  s_add_u32 s20, s20, s18
  s_cmp_lg_u32 s20, 15
  s_cbranch_scc1 Z_np
  v_lshlrev_b32 v4, 2, v2
  v_mov_b32 v5, 1
  s_waitcnt vmcnt(0)
  buffer_store_dword v5, v4, s[68:71], 0 offen offset:192 sc1
Z_np:
  buffer_load_dwordx4 v[108:111], v93, s[72:75], s83 offen
  s_add_u32 s83, s83, 786432
  buffer_load_dwordx4 v[112:115], v93, s[72:75], s83 offen
  buffer_load_dwordx4 v[116:119], v93, s[72:75], s84 offen
  s_add_u32 s84, s84, 786432
  buffer_load_dwordx4 v[120:123], v93, s[72:75], s84 offen
  s_mov_b32 s28, s8
  s_mov_b32 s29, s9
  s_mov_b32 s30, 7340032
  s_mov_b32 s31, 0x20000
  s_lshl_b32 s20, s2, 3
  s_add_u32 s20, s20, s18
  s_mul_i32 s20, s20, 3584
  v_min_u32 v11, 27, v1
  v_lshlrev_b32 v11, 7, v11
  buffer_load_dword v38, v11, s[28:31], s20 offen
  s_mul_i32 s20, s2, 8208
  v_lshlrev_b32 v11, 4, v0
  buffer_load_dwordx4 v[28:31], v11, s[56:59], s20 offen
  buffer_load_dwordx4 v[32:35], v11, s[60:63], s20 offen
  s_waitcnt lgkmcnt(0)
  v_readfirstlane_b32 s36, v8
  v_and_b32 v6, 7, v1
  v_lshrrev_b32 v7, 3, v1
  v_mul_u32_u24 v90, 1026, v6
  v_lshl_add_u32 v90, v7, 9, v90
  v_lshlrev_b32 v91, 10, v1
  v_lshl_add_u32 v7, v6, 1, 0
  v_add_u32 v7, 8192, v7
  v_cmp_gt_u32 vcc, 24, v1
  s_nop 1
  v_cndmask_b32 v90, v7, v90, vcc
  v_mov_b32 v6, 2147483632
  v_cndmask_b32 v91, v6, v91, vcc
  v_subrev_u32 v7, 384, v0
  v_cmp_gt_u32 vcc, 32, v7
  s_nop 1
  v_cndmask_b32 v90, v6, v90, vcc
  v_cndmask_b32 v91, v6, v91, vcc
  s_mul_i32 s20, s2, 8208
  buffer_load_ushort v88, v90, s[56:59], s20 offen
  buffer_load_ushort v89, v90, s[60:63], s20 offen
  s_cmp_lt_u32 s18, 4
  s_cbranch_scc1 TC_lo
  s_lshl_b32 s88, s23, 4
  s_lshl_b32 s89, s24, 4
  v_add_u32 v8, s89, v2
  v_lshl_add_u32 v9, v3, 2, s88
  s_and_b32 s20, s18, 3
  s_lshl_b32 s20, s20, 11
  v_add_u32 v11, s20, v12
  v_add_u32 v4, 0, v9
  v_mul_u32_u24 v4, v4, v8
  v_cvt_f32_u32 v7, v4
  v_mul_f32 v7, 0x3d000000, v7
  v_cos_f32 v5, v7
  v_sin_f32 v6, v7
  v_mul_f32 v5, 0x3e3504f3, v5
  v_mul_f32 v6, 0x3e3504f3, v6
  v_cvt_pk_f16_f32 v132, v5, -v6
  v_cvt_pk_f16_f32 v136, v6, v5
  v_add_u32 v4, 1, v9
  v_mul_u32_u24 v4, v4, v8
  v_cvt_f32_u32 v7, v4
  v_mul_f32 v7, 0x3d000000, v7
  v_cos_f32 v5, v7
  v_sin_f32 v6, v7
  v_mul_f32 v5, 0x3e3504f3, v5
  v_mul_f32 v6, 0x3e3504f3, v6
  v_cvt_pk_f16_f32 v133, v5, -v6
  v_cvt_pk_f16_f32 v137, v6, v5
  v_add_u32 v4, 2, v9
  v_mul_u32_u24 v4, v4, v8
  v_cvt_f32_u32 v7, v4
  v_mul_f32 v7, 0x3d000000, v7
  v_cos_f32 v5, v7
  v_sin_f32 v6, v7
  v_mul_f32 v5, 0x3e3504f3, v5
  v_mul_f32 v6, 0x3e3504f3, v6
  v_cvt_pk_f16_f32 v134, v5, -v6
  v_cvt_pk_f16_f32 v138, v6, v5
  v_add_u32 v4, 3, v9
  v_mul_u32_u24 v4, v4, v8
  v_cvt_f32_u32 v7, v4
  v_mul_f32 v7, 0x3d000000, v7
  v_cos_f32 v5, v7
  v_sin_f32 v6, v7
  v_mul_f32 v5, 0x3e3504f3, v5
  v_mul_f32 v6, 0x3e3504f3, v6
  v_cvt_pk_f16_f32 v135, v5, -v6
  v_cvt_pk_f16_f32 v139, v6, v5
  ds_write_b128 v11, v[132:135] offset:40064
  ds_write_b128 v11, v[136:139] offset:41088
  s_branch TC_done
TC_lo:
  s_cmp_lt_u32 s18, 2
  s_cbranch_scc1 TC_done
  s_cmp_eq_u32 s18, 3
  s_cbranch_scc1 TC_3
  v_lshl_add_u32 v4, v3, 2, 0
  v_mul_u32_u24 v4, v4, v2
  v_cvt_f32_u32 v7, v4
  v_mul_f32 v7, 0x3b000000, v7
  v_cos_f32 v132, v7
  v_sin_f32 v140, v7
  v_lshl_add_u32 v4, v3, 2, 1
  v_mul_u32_u24 v4, v4, v2
  v_cvt_f32_u32 v7, v4
  v_mul_f32 v7, 0x3b000000, v7
  v_cos_f32 v133, v7
  v_sin_f32 v141, v7
  v_lshl_add_u32 v4, v3, 2, 2
  v_mul_u32_u24 v4, v4, v2
  v_cvt_f32_u32 v7, v4
  v_mul_f32 v7, 0x3b000000, v7
  v_cos_f32 v134, v7
  v_sin_f32 v142, v7
  v_lshl_add_u32 v4, v3, 2, 3
  v_mul_u32_u24 v4, v4, v2
  v_cvt_f32_u32 v7, v4
  v_mul_f32 v7, 0x3b000000, v7
  v_cos_f32 v135, v7
  v_sin_f32 v143, v7
  v_lshl_add_u32 v4, v3, 2, 16
  v_mul_u32_u24 v4, v4, v2
  v_cvt_f32_u32 v7, v4
  v_mul_f32 v7, 0x3b000000, v7
  v_cos_f32 v136, v7
  v_sin_f32 v144, v7
  v_lshl_add_u32 v4, v3, 2, 17
  v_mul_u32_u24 v4, v4, v2
  v_cvt_f32_u32 v7, v4
  v_mul_f32 v7, 0x3b000000, v7
  v_cos_f32 v137, v7
  v_sin_f32 v145, v7
  v_lshl_add_u32 v4, v3, 2, 18
  v_mul_u32_u24 v4, v4, v2
  v_cvt_f32_u32 v7, v4
  v_mul_f32 v7, 0x3b000000, v7
  v_cos_f32 v138, v7
  v_sin_f32 v146, v7
  v_lshl_add_u32 v4, v3, 2, 19
  v_mul_u32_u24 v4, v4, v2
  v_cvt_f32_u32 v7, v4
  v_mul_f32 v7, 0x3b000000, v7
  v_cos_f32 v139, v7
  v_sin_f32 v147, v7
  v_mov_b32 v11, v12
  ds_write_b128 v11, v[132:135] offset:35968
  ds_write_b128 v11, v[136:139] offset:36992
  ds_write_b128 v11, v[140:143] offset:38016
  ds_write_b128 v11, v[144:147] offset:39040
  s_branch TC_done
TC_3:
  s_mov_b32 s88, 0x80008000
  v_lshrrev_b32 v10, 1, v3
  v_and_b32 v11, 1, v3
  v_lshrrev_b32 v4, 3, v2
  v_cmp_eq_u32 vcc, v4, v10
  v_mov_b32 v6, 0x3eb504f3
  s_nop 0
  v_cndmask_b32 v140, 0, v6, vcc
  v_and_b32 v141, 7, v2
  v_lshl_add_u32 v141, v141, 8, s37
  v_add_u32 v8, 0, v11
  v_xor_b32 v9, v10, v11
  v_mul_u32_u24 v4, v141, v8
  v_and_b32 v4, 0x7ff, v4
  v_cvt_f32_u32 v7, v4
  v_mul_f32 v7, 0x3a000000, v7
  v_cos_f32 v5, v7
  v_sin_f32 v6, v7
  v_mul_f32 v5, v140, v5
  v_mul_f32 v6, v140, v6
  v_cvt_pk_f16_f32 v132, v5, -v6
  v_cvt_pk_f16_f32 v136, v6, v5
  v_mul_lo_u32 v4, v9, s88
  v_xor_b32 v136, v4, v136
  v_add_u32 v8, 1, v11
  v_xor_b32 v9, v10, v11
  v_mul_u32_u24 v4, v141, v8
  v_and_b32 v4, 0x7ff, v4
  v_cvt_f32_u32 v7, v4
  v_mul_f32 v7, 0x3a000000, v7
  v_cos_f32 v5, v7
  v_sin_f32 v6, v7
  v_mul_f32 v5, v140, v5
  v_mul_f32 v6, v140, v6
  v_cvt_pk_f16_f32 v133, v5, -v6
  v_cvt_pk_f16_f32 v137, v6, v5
  v_mul_lo_u32 v4, v9, s88
  v_xor_b32 v137, v4, v137
  v_add_u32 v8, 2, v11
  v_xor_b32 v9, v10, v11
  v_mul_u32_u24 v4, v141, v8
  v_and_b32 v4, 0x7ff, v4
  v_cvt_f32_u32 v7, v4
  v_mul_f32 v7, 0x3a000000, v7
  v_cos_f32 v5, v7
  v_sin_f32 v6, v7
  v_mul_f32 v5, v140, v5
  v_mul_f32 v6, v140, v6
  v_cvt_pk_f16_f32 v134, v5, -v6
  v_cvt_pk_f16_f32 v138, v6, v5
  v_mul_lo_u32 v4, v9, s88
  v_xor_b32 v138, v4, v138
  v_add_u32 v8, 3, v11
  v_mov_b32 v9, v10
  v_mul_u32_u24 v4, v141, v8
  v_and_b32 v4, 0x7ff, v4
  v_cvt_f32_u32 v7, v4
  v_mul_f32 v7, 0x3a000000, v7
  v_cos_f32 v5, v7
  v_sin_f32 v6, v7
  v_mul_f32 v5, v140, v5
  v_mul_f32 v6, v140, v6
  v_cvt_pk_f16_f32 v135, v5, -v6
  v_cvt_pk_f16_f32 v139, v6, v5
  v_mul_lo_u32 v4, v9, s88
  v_xor_b32 v139, v4, v139
  v_mov_b32 v11, v12
  ds_write_b128 v11, v[132:135] offset:48256
  ds_write_b128 v11, v[136:139] offset:49280
  v_add_u32 v4, 0, v3
  v_mul_u32_u24 v4, v4, v2
  v_cvt_f32_u32 v7, v4
  v_mul_f32 v7, 0x3d800000, v7
  v_cos_f32 v5, v7
  v_sin_f32 v6, v7
  v_mul_f32 v5, 0x3e800000, v5
  v_mul_f32 v6, 0x3e800000, v6
  v_cvt_pk_f16_f32 v140, v5, -v6
  v_cvt_pk_f16_f32 v144, v6, v5
  v_add_u32 v4, 4, v3
  v_mul_u32_u24 v4, v4, v2
  v_cvt_f32_u32 v7, v4
  v_mul_f32 v7, 0x3d800000, v7
  v_cos_f32 v5, v7
  v_sin_f32 v6, v7
  v_mul_f32 v5, 0x3e800000, v5
  v_mul_f32 v6, 0x3e800000, v6
  v_cvt_pk_f16_f32 v141, v5, -v6
  v_cvt_pk_f16_f32 v145, v6, v5
  v_add_u32 v4, 8, v3
  v_mul_u32_u24 v4, v4, v2
  v_cvt_f32_u32 v7, v4
  v_mul_f32 v7, 0x3d800000, v7
  v_cos_f32 v5, v7
  v_sin_f32 v6, v7
  v_mul_f32 v5, 0x3e800000, v5
  v_mul_f32 v6, 0x3e800000, v6
  v_cvt_pk_f16_f32 v142, v5, -v6
  v_cvt_pk_f16_f32 v146, v6, v5
  v_add_u32 v4, 12, v3
  v_mul_u32_u24 v4, v4, v2
  v_cvt_f32_u32 v7, v4
  v_mul_f32 v7, 0x3d800000, v7
  v_cos_f32 v5, v7
  v_sin_f32 v6, v7
  v_mul_f32 v5, 0x3e800000, v5
  v_mul_f32 v6, 0x3e800000, v6
  v_cvt_pk_f16_f32 v143, v5, -v6
  v_cvt_pk_f16_f32 v147, v6, v5
  ds_write_b128 v11, v[140:143] offset:33920
  ds_write_b128 v11, v[144:147] offset:34944
TC_done:
  v_add_u32 v4, 0, v1
  v_mul_u32_u24 v5, 2341, v4
  v_lshrrev_b32 v5, 16, v5
  v_mul_u32_u24 v6, 28, v5
  v_sub_u32 v4, v4, v6
  v_lshrrev_b32 v6, 2, v5
  v_and_b32 v6, 2, v6
  v_xor_b32 v4, v4, v6
  v_mul_u32_u24 v5, 7168, v5
  v_lshl_add_u32 v16, v4, 4, v5
  v_add_u32 v4, 64, v1
  v_mul_u32_u24 v5, 2341, v4
  v_lshrrev_b32 v5, 16, v5
  v_mul_u32_u24 v6, 28, v5
  v_sub_u32 v4, v4, v6
  v_lshrrev_b32 v6, 2, v5
  v_and_b32 v6, 2, v6
  v_xor_b32 v4, v4, v6
  v_mul_u32_u24 v5, 7168, v5
  v_lshl_add_u32 v17, v4, 4, v5
  v_add_u32 v4, 128, v1
  v_mul_u32_u24 v5, 2341, v4
  v_lshrrev_b32 v5, 16, v5
  v_mul_u32_u24 v6, 28, v5
  v_sub_u32 v4, v4, v6
  v_lshrrev_b32 v6, 2, v5
  v_and_b32 v6, 2, v6
  v_xor_b32 v4, v4, v6
  v_mul_u32_u24 v5, 7168, v5
  v_lshl_add_u32 v18, v4, 4, v5
  v_add_u32 v4, 192, v1
  v_mul_u32_u24 v5, 2341, v4
  v_lshrrev_b32 v5, 16, v5
  v_mul_u32_u24 v6, 28, v5
  v_sub_u32 v4, v4, v6
  v_lshrrev_b32 v6, 2, v5
  v_and_b32 v6, 2, v6
  v_xor_b32 v4, v4, v6
  v_mul_u32_u24 v5, 7168, v5
  v_lshl_add_u32 v19, v4, 4, v5
  v_add_u32 v4, 256, v1
  v_mul_u32_u24 v5, 2341, v4
  v_lshrrev_b32 v5, 16, v5
  v_mul_u32_u24 v6, 28, v5
  v_sub_u32 v4, v4, v6
  v_lshrrev_b32 v6, 2, v5
  v_and_b32 v6, 2, v6
  v_xor_b32 v4, v4, v6
  v_mul_u32_u24 v5, 7168, v5
  v_lshl_add_u32 v20, v4, 4, v5
  v_add_u32 v4, 320, v1
  v_mul_u32_u24 v5, 2341, v4
  v_lshrrev_b32 v5, 16, v5
  v_mul_u32_u24 v6, 28, v5
  v_sub_u32 v4, v4, v6
  v_lshrrev_b32 v6, 2, v5
  v_and_b32 v6, 2, v6
  v_xor_b32 v4, v4, v6
  v_mul_u32_u24 v5, 7168, v5
  v_lshl_add_u32 v21, v4, 4, v5
  v_add_u32 v4, 384, v1
  v_mul_u32_u24 v5, 2341, v4
  v_lshrrev_b32 v5, 16, v5
  v_mul_u32_u24 v6, 28, v5
  v_sub_u32 v4, v4, v6
  v_lshrrev_b32 v6, 2, v5
  v_and_b32 v6, 2, v6
  v_xor_b32 v4, v4, v6
  v_mul_u32_u24 v5, 7168, v5
  v_lshl_add_u32 v22, v4, 4, v5
  s_add_u32 s72, s6, 3145728
  s_addc_u32 s73, s7, 0
  s_mov_b32 s74, 4259840
  s_mov_b32 s75, 0x20000
  s_lshl_b32 s76, s18, 11
  s_lshr_b32 s20, s18, 2
  s_lshl_b32 s20, s20, 6
  s_add_u32 s76, s76, s20
  s_add_u32 s76, s76, 65536
  s_cmp_ge_u32 s18, 4
  s_cselect_b32 s77, 1.0, 0
  s_lshl_b32 s78, s37, 2
  s_and_b32 s78, s78, 48
  s_lshl_b32 s79, s37, 6
  v_add_u32 v148, s76, v12
  v_lshl_add_u32 v149, v1, 2, s76
  v_and_b32 v4, 1, v0
  v_lshlrev_b32 v4, 10, v4
  v_bfe_u32 v5, v0, 1, 6
  v_lshl_add_u32 v4, v5, 4, v4
  s_lshr_b32 s20, s18, 1
  s_lshl_b32 s20, s20, 11
  s_add_u32 s20, s20, 100608
  v_add_u32 v150, s20, v4
  v_and_b32 v5, 7, v1
  v_xor_b32 v4, v3, v5
  v_lshl_add_u32 v4, v2, 3, v4
  v_lshl_add_u32 v152, v4, 4, s76
  v_xor_b32 v4, 4, v4
  v_lshl_add_u32 v153, v4, 4, s76
  s_mov_b32 s28, s8
  s_mov_b32 s29, s9
  s_mov_b32 s30, 7340032
  s_mov_b32 s31, 0x20000
  v_bfe_u32 v4, v0, 6, 2
  v_sub_u32 v4, 0, v4
  v_and_b32 v4, 3, v4
  v_lshlrev_b32 v4, 2, v4
  v_and_b32 v5, 255, v0
  v_xor_b32 v4, v4, v5
  v_lshlrev_b32 v4, 2, v4
  s_lshl_b32 s20, s54, 3
  s_add_u32 s20, s20, 110592
  v_add_u32 v36, s20, v4
  v_subrev_u32 v4, 256, v0
  v_and_b32 v5, -5, v4
  v_cmp_eq_u32 vcc, 0, v5
  v_mov_b32 v5, 1073741816
  s_nop 0
  v_cndmask_b32 v154, v5, v4, vcc
  v_and_b32 v4, 1, v3
  v_lshlrev_b32 v4, 3, v4
  v_lshrrev_b32 v5, 1, v3
  v_lshl_add_u32 v4, v5, 2, v4
  s_lshr_b32 s20, s78, 2
  v_xor_b32 v4, s20, v4
  v_and_b32 v5, 3, v0
  v_lshlrev_b32 v5, 2, v5
  s_mov_b32 s49, 0x00010001
  v_mov_b32 v161, s36
  v_lshlrev_b32 v154, 1, v154
  v_add_u32 v6, 0, v4
  v_lshrrev_b32 v156, v6, s36
  v_add_u32 v6, 0, v5
  v_lshrrev_b32 v24, v6, s36
  v_and_b32 v24, s49, v24
  v_add_u32 v6, 1, v4
  v_lshrrev_b32 v157, v6, s36
  v_add_u32 v6, 1, v5
  v_lshrrev_b32 v25, v6, s36
  v_and_b32 v25, s49, v25
  v_add_u32 v6, 2, v4
  v_lshrrev_b32 v158, v6, s36
  v_add_u32 v6, 2, v5
  v_lshrrev_b32 v26, v6, s36
  v_and_b32 v26, s49, v26
  v_add_u32 v6, 3, v4
  v_lshrrev_b32 v159, v6, s36
  v_add_u32 v6, 3, v5
  v_lshrrev_b32 v27, v6, s36
  v_and_b32 v27, s49, v27
  s_waitcnt vmcnt(9)
  v_lshlrev_b32 v164, 16, v40
  v_and_b32 v165, s19, v40
  v_lshlrev_b32 v166, 16, v41
  v_and_b32 v167, s19, v41
  v_lshlrev_b32 v168, 16, v42
  v_and_b32 v169, s19, v42
  v_lshlrev_b32 v170, 16, v43
  v_and_b32 v171, s19, v43
  v_lshlrev_b32 v172, 16, v44
  v_and_b32 v173, s19, v44
  v_lshlrev_b32 v174, 16, v45
  v_and_b32 v175, s19, v45
  v_lshlrev_b32 v176, 16, v46
  v_and_b32 v177, s19, v46
  v_lshlrev_b32 v178, 16, v47
  v_and_b32 v179, s19, v47
  s_cmp_lg_u32 s18, 3
  s_nop 0
  s_cbranch_scc1 ZC_n
  v_mov_b32 v8, 0
  buffer_load_dword v184, v8, s[68:71], 0 offen offset:192 sc1
ZC_n:
  v_readfirstlane_b32 s80, v164
  s_nop 1
  v_pk_add_f32 v[164:165], v[164:165], s[80:81] op_sel_hi:[1,0] neg_lo:[0,1] neg_hi:[0,1]
  v_pk_add_f32 v[166:167], v[166:167], s[80:81] op_sel_hi:[1,0] neg_lo:[0,1] neg_hi:[0,1]
  v_pk_add_f32 v[168:169], v[168:169], s[80:81] op_sel_hi:[1,0] neg_lo:[0,1] neg_hi:[0,1]
  v_pk_add_f32 v[170:171], v[170:171], s[80:81] op_sel_hi:[1,0] neg_lo:[0,1] neg_hi:[0,1]
  v_pk_add_f32 v[172:173], v[172:173], s[80:81] op_sel_hi:[1,0] neg_lo:[0,1] neg_hi:[0,1]
  v_pk_add_f32 v[174:175], v[174:175], s[80:81] op_sel_hi:[1,0] neg_lo:[0,1] neg_hi:[0,1]
  v_pk_add_f32 v[176:177], v[176:177], s[80:81] op_sel_hi:[1,0] neg_lo:[0,1] neg_hi:[0,1]
  v_pk_add_f32 v[178:179], v[178:179], s[80:81] op_sel_hi:[1,0] neg_lo:[0,1] neg_hi:[0,1]
  v_pk_add_f32 v[4:5], v[164:165], v[166:167]
  v_pk_mul_f32 v[6:7], v[164:165], v[164:165]
  v_pk_fma_f32 v[6:7], v[166:167], v[166:167], v[6:7]
  v_pk_add_f32 v[4:5], v[4:5], v[168:169]
  v_pk_fma_f32 v[6:7], v[168:169], v[168:169], v[6:7]
  v_pk_add_f32 v[4:5], v[4:5], v[170:171]
  v_pk_fma_f32 v[6:7], v[170:171], v[170:171], v[6:7]
  v_pk_add_f32 v[4:5], v[4:5], v[172:173]
  v_pk_fma_f32 v[6:7], v[172:173], v[172:173], v[6:7]
  v_pk_add_f32 v[4:5], v[4:5], v[174:175]
  v_pk_fma_f32 v[6:7], v[174:175], v[174:175], v[6:7]
  v_pk_add_f32 v[4:5], v[4:5], v[176:177]
  v_pk_fma_f32 v[6:7], v[176:177], v[176:177], v[6:7]
  v_pk_add_f32 v[4:5], v[4:5], v[178:179]
  v_pk_fma_f32 v[6:7], v[178:179], v[178:179], v[6:7]
  v_add_f32 v4, v4, v5
  v_add_f32 v6, v6, v7
  s_nop 0
  v_add_f32_dpp v4, v4, v4 row_ror:1 row_mask:0xf bank_mask:0xf
  v_add_f32_dpp v6, v6, v6 row_ror:1 row_mask:0xf bank_mask:0xf
  s_nop 0
  v_add_f32_dpp v4, v4, v4 row_ror:2 row_mask:0xf bank_mask:0xf
  v_add_f32_dpp v6, v6, v6 row_ror:2 row_mask:0xf bank_mask:0xf
  s_nop 0
  v_add_f32_dpp v4, v4, v4 row_ror:4 row_mask:0xf bank_mask:0xf
  v_add_f32_dpp v6, v6, v6 row_ror:4 row_mask:0xf bank_mask:0xf
  s_nop 0
  v_add_f32_dpp v4, v4, v4 row_ror:8 row_mask:0xf bank_mask:0xf
  v_add_f32_dpp v6, v6, v6 row_ror:8 row_mask:0xf bank_mask:0xf
  s_nop 0
  v_add_f32_dpp v4, v4, v4 row_bcast:15 row_mask:0xa bank_mask:0xf
  v_add_f32_dpp v6, v6, v6 row_bcast:15 row_mask:0xa bank_mask:0xf
  s_nop 0
  v_add_f32_dpp v4, v4, v4 row_bcast:31 row_mask:0xc bank_mask:0xf
  v_add_f32_dpp v6, v6, v6 row_bcast:31 row_mask:0xc bank_mask:0xf
  v_readlane_b32 s82, v4, 63
  v_readlane_b32 s83, v6, 63
  v_mov_b32 v4, 0x3a800000
  v_mul_f32 v181, s82, v4
  v_mul_f32 v180, s83, v4
  v_fma_f32 v180, -v181, v181, v180
  v_max_f32 v180, 0, v180
  v_cvt_pk_bf16_f32 v180, v180, v180
  v_lshlrev_b32 v180, 16, v180
  v_add_f32 v180, 0x3727c5ac, v180
  v_cvt_pk_bf16_f32 v180, v180, v180
  v_lshlrev_b32 v180, 16, v180
  v_sqrt_f32 v180, v180
  s_nop 0
  v_cvt_pk_bf16_f32 v180, v180, v180
  v_lshlrev_b32 v180, 16, v180
  v_rcp_f32 v180, v180
  s_nop 0
  v_mul_f32 v181, v181, v180
  v_pk_fma_f32 v[164:165], v[164:165], v[180:181], v[180:181] op_sel:[0,0,1] op_sel_hi:[1,0,1] neg_lo:[0,0,1] neg_hi:[0,0,1]
  v_pk_fma_f32 v[166:167], v[166:167], v[180:181], v[180:181] op_sel:[0,0,1] op_sel_hi:[1,0,1] neg_lo:[0,0,1] neg_hi:[0,0,1]
  v_pk_fma_f32 v[168:169], v[168:169], v[180:181], v[180:181] op_sel:[0,0,1] op_sel_hi:[1,0,1] neg_lo:[0,0,1] neg_hi:[0,0,1]
  v_pk_fma_f32 v[170:171], v[170:171], v[180:181], v[180:181] op_sel:[0,0,1] op_sel_hi:[1,0,1] neg_lo:[0,0,1] neg_hi:[0,0,1]
  v_pk_fma_f32 v[172:173], v[172:173], v[180:181], v[180:181] op_sel:[0,0,1] op_sel_hi:[1,0,1] neg_lo:[0,0,1] neg_hi:[0,0,1]
  v_pk_fma_f32 v[174:175], v[174:175], v[180:181], v[180:181] op_sel:[0,0,1] op_sel_hi:[1,0,1] neg_lo:[0,0,1] neg_hi:[0,0,1]
  v_pk_fma_f32 v[176:177], v[176:177], v[180:181], v[180:181] op_sel:[0,0,1] op_sel_hi:[1,0,1] neg_lo:[0,0,1] neg_hi:[0,0,1]
  v_pk_fma_f32 v[178:179], v[178:179], v[180:181], v[180:181] op_sel:[0,0,1] op_sel_hi:[1,0,1] neg_lo:[0,0,1] neg_hi:[0,0,1]
  s_waitcnt vmcnt(0)
  s_mov_b32 s40, 0x7fff7fff
  v_lshlrev_b32 v11, 4, v0
  s_mov_b32 s20, 0
  buffer_load_dwordx4 v[48:51], v11, s[44:47], s20 offen
  s_mov_b32 s20, 8192
  buffer_load_dwordx4 v[52:55], v11, s[44:47], s20 offen
  s_mov_b32 s20, 16384
  buffer_load_dwordx4 v[56:59], v11, s[44:47], s20 offen
  s_mov_b32 s20, 24576
  buffer_load_dwordx4 v[60:63], v11, s[44:47], s20 offen
  s_mov_b32 s20, 32768
  buffer_load_dwordx4 v[64:67], v11, s[44:47], s20 offen
  s_mov_b32 s20, 40960
  buffer_load_dwordx4 v[68:71], v11, s[44:47], s20 offen
  s_mov_b32 s20, 49152
  buffer_load_dwordx4 v[72:75], v11, s[44:47], s20 offen
  s_mov_b32 s20, 57344
  buffer_load_dwordx4 v[76:79], v11, s[44:47], s20 offen
  v_lshlrev_b32 v4, 16, v108
  v_and_b32 v5, s19, v108
  v_pk_mul_f32 v[124:125], v[4:5], v[96:97] op_sel_hi:[1,0]
  v_lshlrev_b32 v6, 16, v109
  v_and_b32 v7, s19, v109
  v_pk_mul_f32 v[126:127], v[6:7], v[96:97] op_sel_hi:[1,0]
  v_lshlrev_b32 v4, 16, v110
  v_and_b32 v5, s19, v110
  v_pk_mul_f32 v[128:129], v[4:5], v[96:97] op_sel_hi:[1,0]
  v_lshlrev_b32 v6, 16, v111
  v_and_b32 v7, s19, v111
  v_pk_mul_f32 v[130:131], v[6:7], v[96:97] op_sel_hi:[1,0]
  v_lshlrev_b32 v4, 16, v112
  v_and_b32 v5, s19, v112
  v_pk_fma_f32 v[124:125], v[4:5], v[96:97], v[124:125] op_sel:[0,1,0] op_sel_hi:[1,1,1]
  v_lshlrev_b32 v6, 16, v113
  v_and_b32 v7, s19, v113
  v_pk_fma_f32 v[126:127], v[6:7], v[96:97], v[126:127] op_sel:[0,1,0] op_sel_hi:[1,1,1]
  v_lshlrev_b32 v4, 16, v114
  v_and_b32 v5, s19, v114
  v_pk_fma_f32 v[128:129], v[4:5], v[96:97], v[128:129] op_sel:[0,1,0] op_sel_hi:[1,1,1]
  v_lshlrev_b32 v6, 16, v115
  v_and_b32 v7, s19, v115
  v_pk_fma_f32 v[130:131], v[6:7], v[96:97], v[130:131] op_sel:[0,1,0] op_sel_hi:[1,1,1]
  v_permlane16_swap_b32 v124, v125
  v_permlane16_swap_b32 v126, v127
  v_permlane16_swap_b32 v128, v129
  v_permlane16_swap_b32 v130, v131
  v_add_f32 v124, v124, v125
  v_add_f32 v126, v126, v127
  v_add_f32 v128, v128, v129
  v_add_f32 v130, v130, v131
  v_permlane32_swap_b32 v124, v126
  s_nop 0
  v_permlane32_swap_b32 v128, v130
  v_add_f32 v124, v124, v126
  v_add_f32 v128, v128, v130
  s_nop 0
  v_add_f32_dpp v124, v124, v124 row_ror:8 row_mask:0xf bank_mask:0xf
  v_add_f32_dpp v128, v128, v128 row_ror:8 row_mask:0xf bank_mask:0xf
  ds_write_b32 v95, v124 offset:2048
  ds_write_b32 v95, v128 offset:2064
  v_lshlrev_b32 v4, 16, v116
  v_and_b32 v5, s19, v116
  v_pk_mul_f32 v[124:125], v[4:5], v[96:97] op_sel_hi:[1,0]
  v_lshlrev_b32 v6, 16, v117
  v_and_b32 v7, s19, v117
  v_pk_mul_f32 v[126:127], v[6:7], v[96:97] op_sel_hi:[1,0]
  v_lshlrev_b32 v4, 16, v118
  v_and_b32 v5, s19, v118
  v_pk_mul_f32 v[128:129], v[4:5], v[96:97] op_sel_hi:[1,0]
  v_lshlrev_b32 v6, 16, v119
  v_and_b32 v7, s19, v119
  v_pk_mul_f32 v[130:131], v[6:7], v[96:97] op_sel_hi:[1,0]
  v_lshlrev_b32 v4, 16, v120
  v_and_b32 v5, s19, v120
  v_pk_fma_f32 v[124:125], v[4:5], v[96:97], v[124:125] op_sel:[0,1,0] op_sel_hi:[1,1,1]
  v_lshlrev_b32 v6, 16, v121
  v_and_b32 v7, s19, v121
  v_pk_fma_f32 v[126:127], v[6:7], v[96:97], v[126:127] op_sel:[0,1,0] op_sel_hi:[1,1,1]
  v_lshlrev_b32 v4, 16, v122
  v_and_b32 v5, s19, v122
  v_pk_fma_f32 v[128:129], v[4:5], v[96:97], v[128:129] op_sel:[0,1,0] op_sel_hi:[1,1,1]
  v_lshlrev_b32 v6, 16, v123
  v_and_b32 v7, s19, v123
  v_pk_fma_f32 v[130:131], v[6:7], v[96:97], v[130:131] op_sel:[0,1,0] op_sel_hi:[1,1,1]
  v_permlane16_swap_b32 v124, v125
  v_permlane16_swap_b32 v126, v127
  v_permlane16_swap_b32 v128, v129
  v_permlane16_swap_b32 v130, v131
  v_add_f32 v124, v124, v125
  v_add_f32 v126, v126, v127
  v_add_f32 v128, v128, v129
  v_add_f32 v130, v130, v131
  v_permlane32_swap_b32 v124, v126
  s_nop 0
  v_permlane32_swap_b32 v128, v130
  v_add_f32 v124, v124, v126
  v_add_f32 v128, v128, v130
  s_nop 0
  v_add_f32_dpp v124, v124, v124 row_ror:8 row_mask:0xf bank_mask:0xf
  v_add_f32_dpp v128, v128, v128 row_ror:8 row_mask:0xf bank_mask:0xf
  ds_write_b32 v95, v124 offset:4096
  ds_write_b32 v95, v128 offset:4112
  v_lshl_or_b32 v88, v89, 16, v88
  v_and_b32 v89, s40, v88
  v_and_b32 v28, s40, v28
  v_pk_max_u16 v89, v89, v28
  v_and_b32 v29, s40, v29
  v_pk_max_u16 v89, v89, v29
  v_and_b32 v30, s40, v30
  v_pk_max_u16 v89, v89, v30
  v_and_b32 v31, s40, v31
  v_pk_max_u16 v89, v89, v31
  v_and_b32 v32, s40, v32
  v_pk_max_u16 v89, v89, v32
  v_and_b32 v33, s40, v33
  v_pk_max_u16 v89, v89, v33
  v_and_b32 v34, s40, v34
  v_pk_max_u16 v89, v89, v34
  v_and_b32 v35, s40, v35
  v_pk_max_u16 v89, v89, v35
  v_lshrrev_b32 v4, 16, v89
  v_and_b32 v89, 0xffff, v89
  v_max_u32 v89, v89, v4
  s_nop 1
  v_max_u32_dpp v89, v89, v89 row_ror:1 row_mask:0xf bank_mask:0xf
  s_nop 1
  v_max_u32_dpp v89, v89, v89 row_ror:2 row_mask:0xf bank_mask:0xf
  s_nop 1
  v_max_u32_dpp v89, v89, v89 row_ror:4 row_mask:0xf bank_mask:0xf
  s_nop 1
  v_max_u32_dpp v89, v89, v89 row_ror:8 row_mask:0xf bank_mask:0xf
  s_nop 1
  v_max_u32_dpp v89, v89, v89 row_bcast:15 row_mask:0xa bank_mask:0xf
  s_nop 1
  v_max_u32_dpp v89, v89, v89 row_bcast:31 row_mask:0xc bank_mask:0xf
  s_nop 0
  v_readlane_b32 s85, v89, 63
  s_lshl_b32 s20, s18, 2
  s_add_u32 s20, s20, 6176
  v_mov_b32 v4, s20
  v_mov_b32 v5, s85
  ds_write_b32 v4, v5
  s_lshl_b32 s20, s2, 2
  s_add_u32 s20, s20, 229376
  buffer_store_dword v88, v91, s[44:47], s20 offen sc1
  s_waitcnt lgkmcnt(0)
  s_barrier
  s_sub_u32 s20, s18, 1
  s_cmp_ge_u32 s20, 2
  s_cbranch_scc1 G2_nf
  s_cmp_eq_u32 s20, 0
  s_cselect_b32 s40, s65, s66
  s_lshl_b32 s20, s20, 11
  v_lshlrev_b32 v9, 2, v1
  v_add_u32 v10, s20, v9
  ds_read2st64_b32 v[40:41], v10 offset0:8 offset1:9
  ds_read2st64_b32 v[42:43], v10 offset0:10 offset1:11
  ds_read2st64_b32 v[44:45], v10 offset0:12 offset1:13
  ds_read2st64_b32 v[46:47], v10 offset0:14 offset1:15
  s_waitcnt lgkmcnt(0)
  v_pk_add_f32 v[40:41], v[40:41], v[44:45]
  v_pk_add_f32 v[42:43], v[42:43], v[46:47]
  v_pk_add_f32 v[40:41], v[40:41], v[42:43]
  v_add_f32 v40, v40, v41
  buffer_store_dword v40, v9, s[44:47], s40 offen sc1
G2_nf:
  s_cmp_lg_u32 s18, 3
  s_cbranch_scc1 G3_nf
  v_cmp_ne_u32 vcc, 1, v184
  s_nop 4
  s_cbranch_vccz ZC_ok
  s_movk_i32 s20, 192
  v_mov_b32 v4, 0
ZC:
  buffer_load_dword v184, v4, s[68:71], s20 offen sc1
  s_waitcnt vmcnt(0)
  v_cmp_ne_u32 vcc, 1, v184
  s_nop 4
  s_cbranch_vccz ZC_ok
  s_sleep 4
  s_branch ZC
ZC_ok:
  v_mov_b32 v4, 6176
  ds_read_b128 v[40:43], v4
  ds_read_b128 v[44:47], v4 offset:16
  s_waitcnt lgkmcnt(0)
  v_max3_u32 v40, v40, v41, v42
  v_max3_u32 v44, v44, v45, v46
  v_max3_u32 v40, v40, v43, v47
  v_max_u32 v40, v40, v44
  s_and_b32 s20, s2, 15
  s_lshl_b32 s20, s20, 7
  s_add_u32 s20, s20, 368640
  v_cmp_eq_u32 vcc, 0, v1
  v_mov_b32 v4, 2147483632
  s_nop 0
  v_cndmask_b32 v4, v4, 0, vcc
  buffer_atomic_umax v40, v4, s[32:35], s20 offen sc1
G3_nf:
  v_lshlrev_b32 v5, 3, v1
  v_and_b32 v5, 24, v5
  v_lshrrev_b32 v5, v5, s36
MP_chk:
  s_waitcnt vmcnt(0)
  v_xor_b32 v6, v5, v48
  v_xor_b32 v7, v5, v52
  v_or_b32 v6, v6, v7
  v_xor_b32 v7, v5, v56
  v_or_b32 v6, v6, v7
  v_xor_b32 v7, v5, v60
  v_or_b32 v6, v6, v7
  v_xor_b32 v7, v5, v64
  v_or_b32 v6, v6, v7
  v_xor_b32 v7, v5, v68
  v_or_b32 v6, v6, v7
  v_xor_b32 v7, v5, v72
  v_or_b32 v6, v6, v7
  v_xor_b32 v7, v5, v76
  v_or_b32 v6, v6, v7
  v_and_b32 v6, 0xff, v6
  v_cmp_ne_u32 vcc, 0, v6
  s_nop 4
  s_cbranch_vccz MP_ok
  s_sleep 4
  s_mov_b32 s20, 0
  buffer_load_dwordx4 v[48:51], v11, s[44:47], s20 offen sc1
  s_mov_b32 s20, 8192
  buffer_load_dwordx4 v[52:55], v11, s[44:47], s20 offen sc1
  s_mov_b32 s20, 16384
  buffer_load_dwordx4 v[56:59], v11, s[44:47], s20 offen sc1
  s_mov_b32 s20, 24576
  buffer_load_dwordx4 v[60:63], v11, s[44:47], s20 offen sc1
  s_mov_b32 s20, 32768
  buffer_load_dwordx4 v[64:67], v11, s[44:47], s20 offen sc1
  s_mov_b32 s20, 40960
  buffer_load_dwordx4 v[68:71], v11, s[44:47], s20 offen sc1
  s_mov_b32 s20, 49152
  buffer_load_dwordx4 v[72:75], v11, s[44:47], s20 offen sc1
  s_mov_b32 s20, 57344
  buffer_load_dwordx4 v[76:79], v11, s[44:47], s20 offen sc1
  s_branch MP_chk
MP_ok:
  v_and_b32 v48, 0xffffff00, v48
  v_and_b32 v52, 0xffffff00, v52
  v_and_b32 v56, 0xffffff00, v56
  v_and_b32 v60, 0xffffff00, v60
  v_and_b32 v64, 0xffffff00, v64
  v_and_b32 v68, 0xffffff00, v68
  v_and_b32 v72, 0xffffff00, v72
  v_and_b32 v76, 0xffffff00, v76
  v_pk_add_f32 v[48:49], v[48:49], v[64:65]
  v_pk_add_f32 v[50:51], v[50:51], v[66:67]
  v_pk_add_f32 v[52:53], v[52:53], v[68:69]
  v_pk_add_f32 v[54:55], v[54:55], v[70:71]
  v_pk_add_f32 v[56:57], v[56:57], v[72:73]
  v_pk_add_f32 v[58:59], v[58:59], v[74:75]
  v_pk_add_f32 v[60:61], v[60:61], v[76:77]
  v_pk_add_f32 v[62:63], v[62:63], v[78:79]
  v_pk_add_f32 v[48:49], v[48:49], v[56:57]
  v_pk_add_f32 v[50:51], v[50:51], v[58:59]
  v_pk_add_f32 v[52:53], v[52:53], v[60:61]
  v_pk_add_f32 v[54:55], v[54:55], v[62:63]
  v_pk_add_f32 v[48:49], v[48:49], v[52:53]
  v_pk_add_f32 v[50:51], v[50:51], v[54:55]
  v_cvt_pk_bf16_f32 v52, v48, v49
  v_cvt_pk_bf16_f32 v53, v50, v51
  v_lshlrev_b32 v48, 16, v52
  v_and_b32 v49, s19, v52
  v_lshlrev_b32 v50, 16, v53
  v_and_b32 v51, s19, v53
  v_add_f32 v48, s77, v48
  v_add_f32 v49, s77, v49
  v_add_f32 v50, s77, v50
  v_add_f32 v51, s77, v51
  v_cvt_pk_bf16_f32 v52, v48, v49
  v_cvt_pk_bf16_f32 v53, v50, v51
  v_lshlrev_b32 v48, 16, v52
  v_and_b32 v49, s19, v52
  v_lshlrev_b32 v50, 16, v53
  v_and_b32 v51, s19, v53
  ds_write_b128 v150, v[48:51]
  v_max3_f32 v184, abs(v48), abs(v49), abs(v50)
  v_max_f32 v184, abs(v51), v184
  s_nop 1
  v_max_f32_dpp v184, v184, v184 row_ror:1 row_mask:0xf bank_mask:0xf
  s_nop 1
  v_max_f32_dpp v184, v184, v184 row_ror:2 row_mask:0xf bank_mask:0xf
  s_nop 1
  v_max_f32_dpp v184, v184, v184 row_ror:4 row_mask:0xf bank_mask:0xf
  s_nop 1
  v_max_f32_dpp v184, v184, v184 row_ror:8 row_mask:0xf bank_mask:0xf
  s_nop 1
  v_max_f32_dpp v184, v184, v184 row_bcast:15 row_mask:0xa bank_mask:0xf
  s_nop 1
  v_max_f32_dpp v184, v184, v184 row_bcast:31 row_mask:0xc bank_mask:0xf
  s_nop 0
  v_readlane_b32 s84, v184, 63
  s_lshl_b32 s20, s18, 2
  s_add_u32 s20, s20, 108800
  v_mov_b32 v9, s20
  v_mov_b32 v184, s84
  ds_write_b32 v9, v184
  s_and_b32 s40, s2, 15
  s_lshl_b32 s40, s40, 7
  s_add_u32 s40, s40, 360448
  v_cmp_eq_u32 vcc, 0, v1
  v_mov_b32 v4, 2147483632
  s_nop 0
  v_cndmask_b32 v4, v4, 0, vcc
  v_mov_b32 v5, 1
  s_cmp_lg_u32 s18, 0
  s_waitcnt lgkmcnt(0)
  s_barrier
  s_cbranch_scc1 ARR0
  buffer_atomic_add v5, v4, s[32:35], s40 offen sc1
ARR0:
  v_mov_b32 v4, 108800
  ds_read_b128 v[48:51], v4
  ds_read_b128 v[52:55], v4 offset:16
  ds_read_b128 v[116:119], v23 offset:39168
  ds_read_b128 v[100:103], v23 offset:35072
  ds_read_b128 v[120:123], v23 offset:40192
  ds_read_b128 v[104:107], v23 offset:36096
  ds_read_b128 v[124:127], v23 offset:41216
  ds_read_b128 v[108:111], v23 offset:37120
  ds_read_b128 v[128:131], v23 offset:42240
  ds_read_b128 v[112:115], v23 offset:38144
  ds_read_b128 v[132:135], v23 offset:16640
  ds_read_b128 v[136:139], v23 offset:17664
  ds_read_b128 v[140:143], v23 offset:20736
  ds_read_b128 v[144:147], v23 offset:21760
  buffer_load_dwordx4 v[28:31], v92, s[56:59], s53 offen
  s_waitcnt lgkmcnt(12)
  v_max3_f32 v48, v48, v49, v50
  v_max3_f32 v52, v52, v53, v54
  v_max3_f32 v48, v48, v51, v55
  v_max_f32 v48, v48, v52
  v_frexp_exp_i32_f32 v182, v48
  v_sub_u32 v182, 3, v182
  v_min_i32 v182, 60, v182
  v_max_i32 v182, 4294967236, v182
  v_ldexp_f32 v180, 1.0, v182
  v_readfirstlane_b32 s39, v182
  s_waitcnt lgkmcnt(10)
  v_pk_fma_f32 v[164:165], v[164:165], v[116:117], v[100:101]
  v_pk_fma_f32 v[166:167], v[166:167], v[118:119], v[102:103]
  v_pk_mul_f32 v[164:165], v[164:165], v[180:181] op_sel_hi:[1,0]
  v_pk_mul_f32 v[166:167], v[166:167], v[180:181] op_sel_hi:[1,0]
  v_cvt_pk_f16_f32 v40, v164, v165
  v_cvt_pk_f16_f32 v41, v166, v167
  s_waitcnt lgkmcnt(8)
  v_pk_fma_f32 v[168:169], v[168:169], v[120:121], v[104:105]
  v_pk_fma_f32 v[170:171], v[170:171], v[122:123], v[106:107]
  v_pk_mul_f32 v[168:169], v[168:169], v[180:181] op_sel_hi:[1,0]
  v_pk_mul_f32 v[170:171], v[170:171], v[180:181] op_sel_hi:[1,0]
  v_cvt_pk_f16_f32 v42, v168, v169
  v_cvt_pk_f16_f32 v43, v170, v171
  ds_write_b128 v148, v[40:43]
  s_waitcnt lgkmcnt(7)
  v_pk_fma_f32 v[172:173], v[172:173], v[124:125], v[108:109]
  v_pk_fma_f32 v[174:175], v[174:175], v[126:127], v[110:111]
  v_pk_mul_f32 v[172:173], v[172:173], v[180:181] op_sel_hi:[1,0]
  v_pk_mul_f32 v[174:175], v[174:175], v[180:181] op_sel_hi:[1,0]
  v_cvt_pk_f16_f32 v44, v172, v173
  v_cvt_pk_f16_f32 v45, v174, v175
  s_waitcnt lgkmcnt(5)
  v_pk_fma_f32 v[176:177], v[176:177], v[128:129], v[112:113]
  v_pk_fma_f32 v[178:179], v[178:179], v[130:131], v[114:115]
  v_pk_mul_f32 v[176:177], v[176:177], v[180:181] op_sel_hi:[1,0]
  v_pk_mul_f32 v[178:179], v[178:179], v[180:181] op_sel_hi:[1,0]
  v_cvt_pk_f16_f32 v46, v176, v177
  v_cvt_pk_f16_f32 v47, v178, v179
  ds_write_b128 v148, v[44:47] offset:1024
  ds_read2st64_b32 v[48:49], v149 offset0:0 offset1:1
  ds_read2st64_b32 v[50:51], v149 offset0:2 offset1:3
  ds_read2st64_b32 v[52:53], v149 offset0:4 offset1:5
  ds_read2st64_b32 v[54:55], v149 offset0:6 offset1:7
  ds_read_b128 v[188:191], v23 offset:18688
  ds_read_b128 v[192:195], v23 offset:19712
  ds_read_b128 v[196:199], v23 offset:22784
  ds_read_b128 v[200:203], v23 offset:23808
  ds_read_b128 v[100:103], v23 offset:24832
  ds_read_b128 v[104:107], v23 offset:25856
  ds_read_b128 v[108:111], v23 offset:26880
  ds_read_b128 v[112:115], v23 offset:27904
  ds_read_b128 v[56:59], v23 offset:28928
  ds_read_b128 v[60:63], v23 offset:29952
  s_waitcnt lgkmcnt(12)
  v_mfma_f32_16x16x32_f16 v[164:167], v[48:51], v[132:135], 0
  v_mfma_f32_16x16x32_f16 v[168:171], v[48:51], v[136:139], 0
  v_mfma_f32_16x16x32_f16 v[172:175], v[48:51], v[140:143], 0
  v_mfma_f32_16x16x32_f16 v[176:179], v[48:51], v[144:147], 0
  s_waitcnt lgkmcnt(6)
  v_mfma_f32_16x16x32_f16 v[164:167], v[52:55], v[188:191], v[164:167]
  v_mfma_f32_16x16x32_f16 v[168:171], v[52:55], v[192:195], v[168:171]
  v_mfma_f32_16x16x32_f16 v[172:175], v[52:55], v[196:199], v[172:175]
  v_mfma_f32_16x16x32_f16 v[176:179], v[52:55], v[200:203], v[176:179]
  ds_read_b128 v[132:135], v23 offset:30976
  ds_read_b128 v[136:139], v23 offset:32000
  ds_read_b128 v[140:143], v23 offset:33024
  ds_read_b128 v[144:147], v23 offset:34048
  v_xor_b32 v84, s78, v84
  v_xor_b32 v85, s78, v85
  v_xor_b32 v86, s78, v86
  v_xor_b32 v87, s78, v87
  s_waitcnt lgkmcnt(4)
  v_pk_mul_f32 v[4:5], v[164:165], v[108:109]
  v_pk_mul_f32 v[164:165], v[164:165], v[100:101]
  v_pk_fma_f32 v[164:165], v[168:169], v[108:109], v[164:165]
  v_pk_fma_f32 v[168:169], v[168:169], v[100:101], v[4:5] neg_lo:[0,0,1] neg_hi:[0,0,1]
  v_pk_mul_f32 v[6:7], v[166:167], v[110:111]
  v_pk_mul_f32 v[166:167], v[166:167], v[102:103]
  v_pk_fma_f32 v[166:167], v[170:171], v[110:111], v[166:167]
  v_pk_fma_f32 v[170:171], v[170:171], v[102:103], v[6:7] neg_lo:[0,0,1] neg_hi:[0,0,1]
  v_cvt_pk_f16_f32 v48, v164, v168
  v_cvt_pk_f16_f32 v49, v165, v169
  v_cvt_pk_f16_f32 v50, v166, v170
  v_cvt_pk_f16_f32 v51, v167, v171
  s_nop 1
  v_mfma_f32_16x16x32_f16 v[116:119], v[48:51], v[56:59], 0
  v_mfma_f32_16x16x32_f16 v[120:123], v[48:51], v[60:63], 0
  v_pk_mul_f32 v[4:5], v[172:173], v[112:113]
  v_pk_mul_f32 v[172:173], v[172:173], v[104:105]
  v_pk_fma_f32 v[172:173], v[176:177], v[112:113], v[172:173]
  v_pk_fma_f32 v[176:177], v[176:177], v[104:105], v[4:5] neg_lo:[0,0,1] neg_hi:[0,0,1]
  v_pk_mul_f32 v[6:7], v[174:175], v[114:115]
  v_pk_mul_f32 v[174:175], v[174:175], v[106:107]
  v_pk_fma_f32 v[174:175], v[178:179], v[114:115], v[174:175]
  v_pk_fma_f32 v[178:179], v[178:179], v[106:107], v[6:7] neg_lo:[0,0,1] neg_hi:[0,0,1]
  v_cvt_pk_f16_f32 v52, v172, v176
  v_cvt_pk_f16_f32 v53, v173, v177
  v_cvt_pk_f16_f32 v54, v174, v178
  v_cvt_pk_f16_f32 v55, v175, v179
  s_nop 1
  v_mfma_f32_16x16x32_f16 v[124:127], v[52:55], v[56:59], 0
  v_mfma_f32_16x16x32_f16 v[128:131], v[52:55], v[60:63], 0
  v_cvt_pk_f16_f32 v40, v116, v120
  v_cvt_pk_f16_f32 v41, v117, v121
  v_cvt_pk_f16_f32 v42, v118, v122
  v_cvt_pk_f16_f32 v43, v119, v123
  ds_write_b128 v152, v[40:43]
  s_nop 2
  v_cvt_pk_f16_f32 v44, v124, v128
  v_cvt_pk_f16_f32 v45, v125, v129
  v_cvt_pk_f16_f32 v46, v126, v130
  v_cvt_pk_f16_f32 v47, v127, v131
  ds_write_b128 v153, v[44:47]
  s_waitcnt lgkmcnt(0)
  s_barrier
  ds_read2st64_b32 v[164:165], v80 offset0:0 offset1:8
  ds_read2st64_b32 v[166:167], v80 offset0:16 offset1:24
  ds_read2st64_b32 v[168:169], v81 offset0:0 offset1:8
  ds_read2st64_b32 v[170:171], v81 offset0:16 offset1:24
  ds_read2st64_b32 v[172:173], v82 offset0:0 offset1:8
  ds_read2st64_b32 v[174:175], v82 offset0:16 offset1:24
  ds_read2st64_b32 v[176:177], v83 offset0:0 offset1:8
  ds_read2st64_b32 v[178:179], v83 offset0:16 offset1:24
  s_waitcnt lgkmcnt(6)
  v_mfma_f32_16x16x32_f16 v[100:103], v[164:167], v[132:135], 0
  v_mfma_f32_16x16x32_f16 v[104:107], v[164:167], v[136:139], 0
  s_waitcnt lgkmcnt(4)
  v_mfma_f32_16x16x32_f16 v[108:111], v[168:171], v[140:143], 0
  v_mfma_f32_16x16x32_f16 v[112:115], v[168:171], v[144:147], 0
  s_waitcnt lgkmcnt(2)
  v_mfma_f32_16x16x32_f16 v[116:119], v[172:175], v[132:135], 0
  v_mfma_f32_16x16x32_f16 v[120:123], v[172:175], v[136:139], 0
  s_waitcnt lgkmcnt(0)
  v_mfma_f32_16x16x32_f16 v[124:127], v[176:179], v[140:143], 0
  v_mfma_f32_16x16x32_f16 v[128:131], v[176:179], v[144:147], 0
  s_lshl_b32 s20, s37, 4
  s_add_u32 s20, s20, 253952
  v_cvt_pk_f16_f32 v48, v100, v104
  v_cvt_pk_f16_f32 v49, v108, v112
  v_cvt_pk_f16_f32 v50, v101, v105
  v_cvt_pk_f16_f32 v51, v109, v113
  v_cvt_pk_f16_f32 v52, v102, v106
  v_cvt_pk_f16_f32 v53, v110, v114
  v_cvt_pk_f16_f32 v54, v103, v107
  v_cvt_pk_f16_f32 v55, v111, v115
  v_permlane32_swap_b32 v48, v52
  v_permlane32_swap_b32 v49, v53
  v_permlane32_swap_b32 v50, v54
  v_permlane32_swap_b32 v51, v55
  v_mov_b32 v160, v49
  v_bfi_b32 v48, s49, v156, v48
  v_bfi_b32 v49, s49, v157, v49
  v_bfi_b32 v50, s49, v158, v50
  v_bfi_b32 v51, s49, v159, v51
  buffer_store_dwordx4 v[48:51], v84, s[72:75], s79 offen sc1
  v_bfi_b32 v52, s49, v156, v52
  v_bfi_b32 v53, s49, v157, v53
  v_bfi_b32 v54, s49, v158, v54
  v_bfi_b32 v55, s49, v159, v55
  buffer_store_dwordx4 v[52:55], v85, s[72:75], s79 offen sc1
  v_cvt_pk_f16_f32 v56, v116, v120
  v_cvt_pk_f16_f32 v57, v124, v128
  v_cvt_pk_f16_f32 v58, v117, v121
  v_cvt_pk_f16_f32 v59, v125, v129
  v_cvt_pk_f16_f32 v60, v118, v122
  v_cvt_pk_f16_f32 v61, v126, v130
  v_cvt_pk_f16_f32 v62, v119, v123
  v_cvt_pk_f16_f32 v63, v127, v131
  v_permlane32_swap_b32 v56, v60
  v_permlane32_swap_b32 v57, v61
  v_permlane32_swap_b32 v58, v62
  v_permlane32_swap_b32 v59, v63
  v_bfi_b32 v56, s49, v156, v56
  v_bfi_b32 v57, s49, v157, v57
  v_bfi_b32 v58, s49, v158, v58
  v_bfi_b32 v59, s49, v159, v59
  buffer_store_dwordx4 v[56:59], v86, s[72:75], s79 offen sc1
  v_bfi_b32 v60, s49, v156, v60
  v_bfi_b32 v61, s49, v157, v61
  v_bfi_b32 v62, s49, v158, v62
  v_bfi_b32 v63, s49, v159, v63
  buffer_store_dwordx4 v[60:63], v87, s[72:75], s79 offen sc1
  buffer_store_dwordx2 v[160:161], v154, s[44:47], s20 offen sc1
  buffer_load_dwordx4 v[32:35], v92, s[60:63], s53 offen
  s_lshl_b32 s20, s51, 3
  s_add_u32 s20, s20, s18
  s_add_u32 s20, s20, 256
  v_mov_b32 v4, s20
  v_cvt_f32_u32 v5, v4
  v_mul_f32 v5, 0x3a000000, v5
  v_cos_f32 v37, v5
  v_sin_f32 v38, v5
  v_mul_f32 v37, 0x3e800000, v37
  v_mul_f32 v38, 0x3e800000, v38
  v_lshl_add_u32 v6, v3, 2, 0
  v_mul_u32_u24 v6, v6, v2
  v_cvt_f32_u32 v7, v6
  v_mul_f32 v7, 0x3b800000, v7
  v_cos_f32 v224, v7
  v_sin_f32 v228, v7
  v_lshl_add_u32 v6, v3, 2, 1
  v_mul_u32_u24 v6, v6, v2
  v_cvt_f32_u32 v7, v6
  v_mul_f32 v7, 0x3b800000, v7
  v_cos_f32 v225, v7
  v_sin_f32 v229, v7
  v_lshl_add_u32 v6, v3, 2, 2
  v_mul_u32_u24 v6, v6, v2
  v_cvt_f32_u32 v7, v6
  v_mul_f32 v7, 0x3b800000, v7
  v_cos_f32 v226, v7
  v_sin_f32 v230, v7
  v_lshl_add_u32 v6, v3, 2, 3
  v_mul_u32_u24 v6, v6, v2
  v_cvt_f32_u32 v7, v6
  v_mul_f32 v7, 0x3b800000, v7
  v_cos_f32 v227, v7
  v_sin_f32 v231, v7
  v_lshl_add_u32 v4, v3, 1, 0
  v_mul_u32_u24 v4, v4, v2
  v_cvt_f32_u32 v7, v4
  v_mul_f32 v7, 0x3d800000, v7
  v_cos_f32 v5, v7
  v_sin_f32 v6, v7
  v_mul_f32 v8, v37, v5
  v_mul_f32 v9, v37, v6
  v_mul_f32 v10, v38, v5
  v_mul_f32 v11, v38, v6
  v_cvt_pk_f16_f32 v176, v8, v9
  v_cvt_pk_f16_f32 v177, v11, -v10
  v_cvt_pk_f16_f32 v180, -v9, v8
  v_cvt_pk_f16_f32 v181, v10, v11
  v_cvt_pk_f16_f32 v184, v11, -v10
  v_cvt_pk_f16_f32 v185, v8, v9
  v_cvt_pk_f16_f32 v188, v10, v11
  v_cvt_pk_f16_f32 v189, -v9, v8
  v_lshl_add_u32 v4, v3, 1, 1
  v_mul_u32_u24 v4, v4, v2
  v_cvt_f32_u32 v7, v4
  v_mul_f32 v7, 0x3d800000, v7
  v_cos_f32 v5, v7
  v_sin_f32 v6, v7
  v_mul_f32 v8, v37, v5
  v_mul_f32 v9, v37, v6
  v_mul_f32 v10, v38, v5
  v_mul_f32 v11, v38, v6
  v_cvt_pk_f16_f32 v178, v8, v9
  v_cvt_pk_f16_f32 v179, v11, -v10
  v_cvt_pk_f16_f32 v182, -v9, v8
  v_cvt_pk_f16_f32 v183, v10, v11
  v_cvt_pk_f16_f32 v186, v11, -v10
  v_cvt_pk_f16_f32 v187, v8, v9
  v_cvt_pk_f16_f32 v190, v10, v11
  v_cvt_pk_f16_f32 v191, -v9, v8
  s_mov_b32 s20, 0x80008000
  v_and_b32 v4, 1, v2
  v_mul_lo_u32 v4, v4, s20
  v_xor_b32 v192, v4, v176
  v_xor_b32 v193, v4, v177
  v_xor_b32 v194, v4, v178
  v_xor_b32 v195, v4, v179
  v_xor_b32 v196, v4, v180
  v_xor_b32 v197, v4, v181
  v_xor_b32 v198, v4, v182
  v_xor_b32 v199, v4, v183
  v_xor_b32 v200, v4, v184
  v_xor_b32 v201, v4, v185
  v_xor_b32 v202, v4, v186
  v_xor_b32 v203, v4, v187
  v_xor_b32 v204, v4, v188
  v_xor_b32 v205, v4, v189
  v_xor_b32 v206, v4, v190
  v_xor_b32 v207, v4, v191
  v_lshl_add_u32 v4, v3, 2, 0
  v_mul_u32_u24 v4, v4, v2
  v_cvt_f32_u32 v7, v4
  v_mul_f32 v7, 0x3d800000, v7
  v_cos_f32 v5, v7
  v_sin_f32 v6, v7
  v_mul_f32 v8, v37, v5
  v_mul_f32 v9, v37, v6
  v_mul_f32 v10, v38, v5
  v_mul_f32 v11, v38, v6
  v_cvt_pk_f16_f32 v208, v8, -v9
  v_cvt_pk_f16_f32 v212, v9, v8
  v_cvt_pk_f16_f32 v216, v11, v10
  v_cvt_pk_f16_f32 v220, -v10, v11
  v_mul_f32 v5, 0x3e800000, v5
  v_mul_f32 v6, 0x3e800000, v6
  v_cvt_pk_f16_f32 v128, v5, v6
  v_cvt_pk_f16_f32 v132, -v6, v5
  v_cvt_pk_f16_f32 v136, v5, -v6
  v_cvt_pk_f16_f32 v140, v6, v5
  v_lshl_add_u32 v4, v3, 2, 1
  v_mul_u32_u24 v4, v4, v2
  v_cvt_f32_u32 v7, v4
  v_mul_f32 v7, 0x3d800000, v7
  v_cos_f32 v5, v7
  v_sin_f32 v6, v7
  v_mul_f32 v8, v37, v5
  v_mul_f32 v9, v37, v6
  v_mul_f32 v10, v38, v5
  v_mul_f32 v11, v38, v6
  v_cvt_pk_f16_f32 v209, v8, -v9
  v_cvt_pk_f16_f32 v213, v9, v8
  v_cvt_pk_f16_f32 v217, v11, v10
  v_cvt_pk_f16_f32 v221, -v10, v11
  v_mul_f32 v5, 0x3e800000, v5
  v_mul_f32 v6, 0x3e800000, v6
  v_cvt_pk_f16_f32 v129, v5, v6
  v_cvt_pk_f16_f32 v133, -v6, v5
  v_cvt_pk_f16_f32 v137, v5, -v6
  v_cvt_pk_f16_f32 v141, v6, v5
  v_lshl_add_u32 v4, v3, 2, 2
  v_mul_u32_u24 v4, v4, v2
  v_cvt_f32_u32 v7, v4
  v_mul_f32 v7, 0x3d800000, v7
  v_cos_f32 v5, v7
  v_sin_f32 v6, v7
  v_mul_f32 v8, v37, v5
  v_mul_f32 v9, v37, v6
  v_mul_f32 v10, v38, v5
  v_mul_f32 v11, v38, v6
  v_cvt_pk_f16_f32 v210, v8, -v9
  v_cvt_pk_f16_f32 v214, v9, v8
  v_cvt_pk_f16_f32 v218, v11, v10
  v_cvt_pk_f16_f32 v222, -v10, v11
  v_mul_f32 v5, 0x3e800000, v5
  v_mul_f32 v6, 0x3e800000, v6
  v_cvt_pk_f16_f32 v130, v5, v6
  v_cvt_pk_f16_f32 v134, -v6, v5
  v_cvt_pk_f16_f32 v138, v5, -v6
  v_cvt_pk_f16_f32 v142, v6, v5
  v_lshl_add_u32 v4, v3, 2, 3
  v_mul_u32_u24 v4, v4, v2
  v_cvt_f32_u32 v7, v4
  v_mul_f32 v7, 0x3d800000, v7
  v_cos_f32 v5, v7
  v_sin_f32 v6, v7
  v_mul_f32 v8, v37, v5
  v_mul_f32 v9, v37, v6
  v_mul_f32 v10, v38, v5
  v_mul_f32 v11, v38, v6
  v_cvt_pk_f16_f32 v211, v8, -v9
  v_cvt_pk_f16_f32 v215, v9, v8
  v_cvt_pk_f16_f32 v219, v11, v10
  v_cvt_pk_f16_f32 v223, -v10, v11
  v_mul_f32 v5, 0x3e800000, v5
  v_mul_f32 v6, 0x3e800000, v6
  v_cvt_pk_f16_f32 v131, v5, v6
  v_cvt_pk_f16_f32 v135, -v6, v5
  v_cvt_pk_f16_f32 v139, v5, -v6
  v_cvt_pk_f16_f32 v143, v6, v5
  s_lshr_b32 s20, s18, 1
  v_lshrrev_b32 v4, 2, v2
  v_xor_b32 v4, s20, v4
  v_lshlrev_b32 v4, 4, v4
  v_lshl_add_u32 v4, v2, 6, v4
  s_and_b32 s20, s18, 1
  s_lshl_b32 s20, s20, 3
  v_add_u32 v4, s20, v4
  v_lshl_add_u32 v60, v3, 11, v4
  v_lshl_add_u32 v61, v3, 12, v4
  v_lshlrev_b32 v62, 4, v0
  v_lshrrev_b32 v4, 2, v0
  v_mul_u32_u24 v4, 16640, v4
  v_lshrrev_b32 v5, 4, v0
  v_xor_b32 v5, v5, v0
  v_and_b32 v5, 3, v5
  v_lshl_add_u32 v63, v5, 4, v4
  v_lshrrev_b32 v4, 2, v2
  v_sub_u32 v4, 0, v4
  v_and_b32 v4, 3, v4
  v_xor_b32 v4, v4, v3
  v_lshlrev_b32 v4, 4, v4
  v_lshl_add_u32 v4, v2, 6, v4
  s_lshl_b32 s20, s18, 10
  s_add_u32 s20, s20, 110592
  v_add_u32 v64, s20, v4
  s_mov_b32 s60, 0x05040100
  s_mov_b32 s61, 0x07060302
  s_or_b32 s59, s51, s18
  s_mul_i32 s54, s52, 16640
  s_lshl_b32 s53, s18, 11
  s_add_u32 s54, s54, s53
  s_add_u32 s64, s6, 3145728
  s_addc_u32 s65, s7, 0
  s_mov_b32 s66, 4259840
  s_mov_b32 s67, 0x20000
  s_add_u32 s68, s6, 8388608
  s_addc_u32 s69, s7, 0
  s_mov_b32 s70, 4259840
  s_mov_b32 s71, 0x20000
  s_waitcnt vmcnt(0)
  v_perm_b32 v72, v32, v28, s60
  v_perm_b32 v73, v32, v28, s61
  v_perm_b32 v74, v33, v29, s60
  v_perm_b32 v75, v33, v29, s61
  v_perm_b32 v76, v34, v30, s60
  v_perm_b32 v77, v34, v30, s61
  v_perm_b32 v78, v35, v31, s60
  v_perm_b32 v79, v35, v31, s61
  s_cmp_ge_u32 s18, 4
  s_nop 0
  s_cbranch_scc1 B_wrev
  ds_write2st64_b32 v36, v72, v73 offset0:0 offset1:4
  ds_write2st64_b32 v36, v74, v75 offset0:8 offset1:12
  ds_write2st64_b32 v36, v76, v77 offset0:16 offset1:20
  ds_write2st64_b32 v36, v78, v79 offset0:24 offset1:28
  s_branch B_wdone
B_wrev:
  ds_write2st64_b32 v36, v72, v73 offset0:28 offset1:24
  ds_write2st64_b32 v36, v74, v75 offset0:20 offset1:16
  ds_write2st64_b32 v36, v76, v77 offset0:12 offset1:8
  ds_write2st64_b32 v36, v78, v79 offset0:4 offset1:0
B_wdone:
  v_lshrrev_b32 v4, 4, v0
  v_xor_b32 v4, v4, v0
  v_and_b32 v4, 3, v4
  v_lshlrev_b32 v4, 2, v4
  v_add_u32 v6, 0, v4
  v_lshrrev_b32 v120, v6, s36
  v_add_u32 v6, 1, v4
  v_lshrrev_b32 v121, v6, s36
  v_add_u32 v6, 2, v4
  v_lshrrev_b32 v122, v6, s36
  v_add_u32 v6, 3, v4
  v_lshrrev_b32 v123, v6, s36
  s_waitcnt lgkmcnt(0)
  s_cmp_lg_u32 s18, 0
  s_cbranch_scc1 AW0
  s_mov_b32 s40, 360448
  v_lshlrev_b32 v6, 7, v2
AWP0:
  buffer_load_dword v7, v6, s[32:35], s40 offen sc1
  s_waitcnt vmcnt(0)
  v_cmp_ne_u32 vcc, 16, v7
  s_nop 4
  s_cbranch_vccz AWP0_ok
  s_sleep 6
  s_branch AWP0
AWP0_ok:
AW0:
  s_barrier
  ds_read_b128 v[104:107], v64
  ds_read_b128 v[108:111], v64 offset:8192
  s_cmp_lg_u32 s18, 1
  s_cbranch_scc1 B_nol1
  v_lshlrev_b32 v4, 8, v3
  v_lshl_add_u32 v4, v2, 2, v4
  s_mov_b32 s20, 237568
  buffer_load_dword v28, v4, s[44:47], s20 offen offset:0 sc1
  buffer_load_dword v29, v4, s[44:47], s20 offen offset:64 sc1
  buffer_load_dword v30, v4, s[44:47], s20 offen offset:128 sc1
  buffer_load_dword v31, v4, s[44:47], s20 offen offset:192 sc1
  s_mov_b32 s20, 241664
  buffer_load_dword v32, v4, s[44:47], s20 offen offset:0 sc1
  buffer_load_dword v33, v4, s[44:47], s20 offen offset:64 sc1
  buffer_load_dword v34, v4, s[44:47], s20 offen offset:128 sc1
  buffer_load_dword v35, v4, s[44:47], s20 offen offset:192 sc1
B_nol1:
  s_mov_b32 s20, 368640
  v_lshlrev_b32 v4, 7, v2
  buffer_load_dword v68, v4, s[32:35], s20 offen sc1
  s_or_b32 s59, s51, s18
  s_cmp_lg_u32 s59, 0
  s_cbranch_scc1 B_nox
  s_mov_b32 s60, 229376
  s_mov_b32 s61, 245760
  v_lshl_add_u32 v4, v3, 2, 0
  v_lshl_add_u32 v4, v4, 4, v2
  v_lshl_add_u32 v4, v4, 3, s50
  v_sub_u32 v5, 2048, v4
  v_and_b32 v6, 7, v4
  v_bfe_u32 v4, v4, 3, 8
  v_lshlrev_b32 v4, 2, v4
  v_lshl_add_u32 v4, v6, 10, v4
  v_and_b32 v6, 7, v5
  v_bfe_u32 v5, v5, 3, 8
  v_lshlrev_b32 v5, 2, v5
  v_lshl_add_u32 v5, v6, 10, v5
  buffer_load_dword v72, v5, s[44:47], s60 offen sc1
  buffer_load_dword v76, v4, s[44:47], s61 offen sc1
  v_lshl_add_u32 v4, v3, 2, 1
  v_lshl_add_u32 v4, v4, 4, v2
  v_lshl_add_u32 v4, v4, 3, s50
  v_sub_u32 v5, 2048, v4
  v_and_b32 v6, 7, v4
  v_bfe_u32 v4, v4, 3, 8
  v_lshlrev_b32 v4, 2, v4
  v_lshl_add_u32 v4, v6, 10, v4
  v_and_b32 v6, 7, v5
  v_bfe_u32 v5, v5, 3, 8
  v_lshlrev_b32 v5, 2, v5
  v_lshl_add_u32 v5, v6, 10, v5
  buffer_load_dword v73, v5, s[44:47], s60 offen sc1
  buffer_load_dword v77, v4, s[44:47], s61 offen sc1
  v_lshl_add_u32 v4, v3, 2, 2
  v_lshl_add_u32 v4, v4, 4, v2
  v_lshl_add_u32 v4, v4, 3, s50
  v_sub_u32 v5, 2048, v4
  v_and_b32 v6, 7, v4
  v_bfe_u32 v4, v4, 3, 8
  v_lshlrev_b32 v4, 2, v4
  v_lshl_add_u32 v4, v6, 10, v4
  v_and_b32 v6, 7, v5
  v_bfe_u32 v5, v5, 3, 8
  v_lshlrev_b32 v5, 2, v5
  v_lshl_add_u32 v5, v6, 10, v5
  buffer_load_dword v74, v5, s[44:47], s60 offen sc1
  buffer_load_dword v78, v4, s[44:47], s61 offen sc1
  v_lshl_add_u32 v4, v3, 2, 3
  v_lshl_add_u32 v4, v4, 4, v2
  v_lshl_add_u32 v4, v4, 3, s50
  v_sub_u32 v5, 2048, v4
  v_and_b32 v6, 7, v4
  v_bfe_u32 v4, v4, 3, 8
  v_lshlrev_b32 v4, 2, v4
  v_lshl_add_u32 v4, v6, 10, v4
  v_and_b32 v6, 7, v5
  v_bfe_u32 v5, v5, 3, 8
  v_lshlrev_b32 v5, 2, v5
  v_lshl_add_u32 v5, v6, 10, v5
  buffer_load_dword v75, v5, s[44:47], s60 offen sc1
  buffer_load_dword v79, v4, s[44:47], s61 offen sc1
B_nox:
  s_cmp_lg_u32 s18, 2
  s_cbranch_scc1 B_nofl
  v_lshlrev_b32 v4, 14, v3
  v_lshl_add_u32 v4, v2, 2, v4
  s_lshl_b32 s20, s2, 6
  s_add_u32 s20, s20, 655360
  s_add_u32 s60, s20, 65536
  buffer_load_dword v70, v4, s[44:47], s20 offen sc1
  buffer_load_dword v71, v4, s[44:47], s60 offen sc1
B_nofl:
  s_waitcnt lgkmcnt(0)
  v_lshlrev_b32 v80, 16, v104
  v_and_b32 v84, s19, v104
  v_lshlrev_b32 v81, 16, v105
  v_and_b32 v85, s19, v105
  v_lshlrev_b32 v82, 16, v106
  v_and_b32 v86, s19, v106
  v_lshlrev_b32 v83, 16, v107
  v_and_b32 v87, s19, v107
  v_lshlrev_b32 v88, 16, v108
  v_and_b32 v92, s19, v108
  v_lshlrev_b32 v89, 16, v109
  v_and_b32 v93, s19, v109
  v_lshlrev_b32 v90, 16, v110
  v_and_b32 v94, s19, v110
  v_lshlrev_b32 v91, 16, v111
  v_and_b32 v95, s19, v111
  v_add_u32 v124, s53, v12
ZA_a:
  buffer_load_dwordx4 v[104:107], v12, s[64:67], s54 offen offset:0 sc1
  buffer_load_dwordx4 v[108:111], v12, s[64:67], s54 offen offset:1024 sc1
  s_waitcnt vmcnt(0)
  v_xor_b32 v104, v24, v104
  v_xor_b32 v105, v25, v105
  v_xor_b32 v106, v26, v106
  v_xor_b32 v107, v27, v107
  v_xor_b32 v108, v24, v108
  v_xor_b32 v109, v25, v109
  v_xor_b32 v110, v26, v110
  v_xor_b32 v111, v27, v111
  v_or_b32 v4, v104, v105
  v_or3_b32 v4, v4, v106, v107
  v_or3_b32 v4, v4, v108, v109
  v_or3_b32 v4, v4, v110, v111
  v_and_b32 v4, s49, v4
  v_cmp_ne_u32 vcc, 0, v4
  s_nop 4
  s_cbranch_vccz ZA_a_ok
  s_sleep 8
  s_branch ZA_a
ZA_a_ok:
  ds_write_b128 v124, v[104:107] offset:0
  ds_write_b128 v124, v[108:111] offset:1024
  s_waitcnt lgkmcnt(0)
  s_barrier
  s_cmp_lg_u32 s18, 2
  s_cbranch_scc1 B_nofin
  v_add_f32 v70, v70, v71
  v_mov_b32 v71, v70
  s_nop 1
  v_permlane16_swap_b32 v70, v71
  v_add_f32 v70, v70, v71
  v_mov_b32 v71, v70
  s_nop 1
  v_permlane32_swap_b32 v70, v71
  v_add_f32 v70, v70, v71
  v_cvt_pk_bf16_f32 v70, v70, v70
  v_lshlrev_b32 v70, 16, v70
  s_lshr_b32 s20, s2, 6
  s_cmp_eq_u32 s20, 2
  s_cselect_b32 s60, 1.0, 0
  v_add_f32 v70, s60, v70
  v_cvt_pk_bf16_f32 v70, v70, v70
  s_cmp_eq_u32 s20, 3
  s_nop 0
  s_cbranch_scc1 B_fgb
  v_lshlrev_b32 v70, 16, v70
  v_and_b32 v4, 1, v2
  v_lshlrev_b32 v4, 10, v4
  v_lshrrev_b32 v5, 3, v2
  v_lshl_add_u32 v4, v5, 8, v4
  v_and_b32 v5, 6, v2
  v_lshl_add_u32 v4, v5, 1, v4
  s_lshr_b32 s20, s2, 5
  s_lshl_b32 s20, s20, 11
  s_and_b32 s60, s2, 1
  s_lshl_b32 s60, s60, 9
  s_add_u32 s20, s20, s60
  s_bfe_u32 s60, s2, 0x40001
  s_lshl_b32 s60, s60, 4
  s_add_u32 s20, s20, s60
  s_add_u32 s20, s20, 589824
  buffer_store_dword v70, v4, s[44:47], s20 offen sc1
  s_branch B_nofin
B_fgb:
  v_lshlrev_b32 v4, 1, v2
  s_lshl_b32 s20, s2, 5
  s_add_u32 s20, s20, 92160
  buffer_store_short v70, v4, s[44:47], s20 offen sc1
B_nofin:
  ds_read_b64 v[96:97], v60 offset:0
  ds_read_b64 v[98:99], v60 offset:1024
  ds_read_b64 v[100:101], v60 offset:8192
  ds_read_b64 v[102:103], v60 offset:9216
  v_max_u32_dpp v68, v68, v68 row_ror:1 row_mask:0xf bank_mask:0xf
  s_nop 1
  v_max_u32_dpp v68, v68, v68 row_ror:2 row_mask:0xf bank_mask:0xf
  s_nop 1
  v_max_u32_dpp v68, v68, v68 row_ror:4 row_mask:0xf bank_mask:0xf
  s_nop 1
  v_max_u32_dpp v68, v68, v68 row_ror:8 row_mask:0xf bank_mask:0xf
  s_nop 1
  v_max_u32_dpp v68, v68, v68 row_bcast:15 row_mask:0xa bank_mask:0xf
  s_nop 1
  v_max_u32_dpp v68, v68, v68 row_bcast:31 row_mask:0xc bank_mask:0xf
  s_nop 0
  v_readlane_b32 s58, v68, 63
  s_nop 0
  s_lshr_b32 s58, s58, 7
  s_sub_i32 s58, 125, s58
  s_min_i32 s58, s58, 60
  s_max_i32 s58, s58, -60
  s_add_u32 s56, s58, 127
  s_lshl_b32 s56, s56, 23
  s_add_i32 s39, s39, s58
  s_sub_i32 s39, 0, s39
  s_waitcnt lgkmcnt(2)
  v_mfma_f32_16x16x32_f16 v[104:107], v[96:99], v[176:179], 0
  v_mfma_f32_16x16x32_f16 v[108:111], v[96:99], v[180:183], 0
  v_mfma_f32_16x16x32_f16 v[112:115], v[96:99], v[184:187], 0
  v_mfma_f32_16x16x32_f16 v[116:119], v[96:99], v[188:191], 0
  s_waitcnt lgkmcnt(0)
  v_mfma_f32_16x16x32_f16 v[104:107], v[100:103], v[192:195], v[104:107]
  v_mfma_f32_16x16x32_f16 v[108:111], v[100:103], v[196:199], v[108:111]
  v_mfma_f32_16x16x32_f16 v[112:115], v[100:103], v[200:203], v[112:115]
  v_mfma_f32_16x16x32_f16 v[116:119], v[100:103], v[204:207], v[116:119]
  s_nop 4
  v_pk_mul_f32 v[4:5], v[104:105], v[228:229]
  v_pk_mul_f32 v[104:105], v[104:105], v[224:225]
  v_pk_fma_f32 v[104:105], v[108:109], v[228:229], v[104:105]
  v_pk_fma_f32 v[108:109], v[108:109], v[224:225], v[4:5] neg_lo:[0,0,1] neg_hi:[0,0,1]
  v_pk_mul_f32 v[6:7], v[106:107], v[230:231]
  v_pk_mul_f32 v[106:107], v[106:107], v[226:227]
  v_pk_fma_f32 v[106:107], v[110:111], v[230:231], v[106:107]
  v_pk_fma_f32 v[110:111], v[110:111], v[226:227], v[6:7] neg_lo:[0,0,1] neg_hi:[0,0,1]
  v_cvt_pk_f16_f32 v96, v104, v108
  v_cvt_pk_f16_f32 v97, v105, v109
  v_cvt_pk_f16_f32 v98, v106, v110
  v_cvt_pk_f16_f32 v99, v107, v111
  s_nop 1
  v_mfma_f32_16x16x32_f16 v[104:107], v[128:131], v[96:99], 0
  v_mfma_f32_16x16x32_f16 v[108:111], v[132:135], v[96:99], 0
  v_pk_mul_f32 v[4:5], v[112:113], v[228:229]
  v_pk_mul_f32 v[112:113], v[112:113], v[224:225]
  v_pk_fma_f32 v[112:113], v[116:117], v[228:229], v[112:113]
  v_pk_fma_f32 v[116:117], v[116:117], v[224:225], v[4:5] neg_lo:[0,0,1] neg_hi:[0,0,1]
  v_pk_mul_f32 v[6:7], v[114:115], v[230:231]
  v_pk_mul_f32 v[114:115], v[114:115], v[226:227]
  v_pk_fma_f32 v[114:115], v[118:119], v[230:231], v[114:115]
  v_pk_fma_f32 v[118:119], v[118:119], v[226:227], v[6:7] neg_lo:[0,0,1] neg_hi:[0,0,1]
  v_cvt_pk_f16_f32 v100, v112, v116
  v_cvt_pk_f16_f32 v101, v113, v117
  v_cvt_pk_f16_f32 v102, v114, v118
  v_cvt_pk_f16_f32 v103, v115, v119
  s_nop 1
  v_mfma_f32_16x16x32_f16 v[112:115], v[128:131], v[100:103], 0
  v_mfma_f32_16x16x32_f16 v[116:119], v[132:135], v[100:103], 0
  s_cmp_lg_u32 s59, 0
  s_nop 6
  s_cbranch_scc1 B_nospec
  v_lshlrev_b32 v176, 16, v72
  v_and_b32 v180, s19, v72
  v_lshlrev_b32 v177, 16, v73
  v_and_b32 v181, s19, v73
  v_lshlrev_b32 v178, 16, v74
  v_and_b32 v182, s19, v74
  v_lshlrev_b32 v179, 16, v75
  v_and_b32 v183, s19, v75
  v_lshlrev_b32 v184, 16, v76
  v_and_b32 v188, s19, v76
  v_lshlrev_b32 v185, 16, v77
  v_and_b32 v189, s19, v77
  v_lshlrev_b32 v186, 16, v78
  v_and_b32 v190, s19, v78
  v_lshlrev_b32 v187, 16, v79
  v_and_b32 v191, s19, v79
  s_sub_u32 s56, s56, 8388608
  v_add_f32 v80, v80, v176
  v_sub_f32 v84, v84, v180
  v_add_f32 v81, v81, v177
  v_sub_f32 v85, v85, v181
  v_add_f32 v82, v82, v178
  v_sub_f32 v86, v86, v182
  v_add_f32 v83, v83, v179
  v_sub_f32 v87, v87, v183
  v_add_f32 v88, v88, v184
  v_sub_f32 v92, v92, v188
  v_add_f32 v89, v89, v185
  v_sub_f32 v93, v93, v189
  v_add_f32 v90, v90, v186
  v_sub_f32 v94, v94, v190
  v_add_f32 v91, v91, v187
  v_sub_f32 v95, v95, v191
B_nospec:
  v_pk_mul_f32 v[80:81], v[80:81], s[56:57] op_sel_hi:[1,0]
  v_pk_mul_f32 v[82:83], v[82:83], s[56:57] op_sel_hi:[1,0]
  v_pk_mul_f32 v[84:85], v[84:85], s[56:57] op_sel_hi:[1,0]
  v_pk_mul_f32 v[86:87], v[86:87], s[56:57] op_sel_hi:[1,0]
  v_pk_mul_f32 v[88:89], v[88:89], s[56:57] op_sel_hi:[1,0]
  v_pk_mul_f32 v[90:91], v[90:91], s[56:57] op_sel_hi:[1,0]
  v_pk_mul_f32 v[92:93], v[92:93], s[56:57] op_sel_hi:[1,0]
  v_pk_mul_f32 v[94:95], v[94:95], s[56:57] op_sel_hi:[1,0]
  v_pk_mul_f32 v[4:5], v[104:105], v[84:85]
  v_pk_mul_f32 v[104:105], v[104:105], v[80:81]
  v_pk_fma_f32 v[104:105], v[108:109], v[84:85], v[104:105] neg_lo:[1,0,0] neg_hi:[1,0,0]
  v_pk_fma_f32 v[108:109], v[108:109], v[80:81], v[4:5]
  v_pk_mul_f32 v[6:7], v[106:107], v[86:87]
  v_pk_mul_f32 v[106:107], v[106:107], v[82:83]
  v_pk_fma_f32 v[106:107], v[110:111], v[86:87], v[106:107] neg_lo:[1,0,0] neg_hi:[1,0,0]
  v_pk_fma_f32 v[110:111], v[110:111], v[82:83], v[6:7]
  v_cvt_pk_f16_f32 v96, v104, v108
  v_cvt_pk_f16_f32 v97, v105, v109
  v_cvt_pk_f16_f32 v98, v106, v110
  v_cvt_pk_f16_f32 v99, v107, v111
  s_nop 1
  v_mfma_f32_16x16x32_f16 v[104:107], v[96:99], v[136:139], 0
  v_mfma_f32_16x16x32_f16 v[108:111], v[96:99], v[140:143], 0
  v_pk_mul_f32 v[4:5], v[112:113], v[92:93]
  v_pk_mul_f32 v[112:113], v[112:113], v[88:89]
  v_pk_fma_f32 v[112:113], v[116:117], v[92:93], v[112:113]
  v_pk_fma_f32 v[116:117], v[116:117], v[88:89], v[4:5] neg_lo:[0,0,1] neg_hi:[0,0,1]
  v_pk_mul_f32 v[6:7], v[114:115], v[94:95]
  v_pk_mul_f32 v[114:115], v[114:115], v[90:91]
  v_pk_fma_f32 v[114:115], v[118:119], v[94:95], v[114:115]
  v_pk_fma_f32 v[118:119], v[118:119], v[90:91], v[6:7] neg_lo:[0,0,1] neg_hi:[0,0,1]
  v_cvt_pk_f16_f32 v100, v112, v116
  v_cvt_pk_f16_f32 v101, v113, v117
  v_cvt_pk_f16_f32 v102, v114, v118
  v_cvt_pk_f16_f32 v103, v115, v119
  s_nop 1
  v_mfma_f32_16x16x32_f16 v[112:115], v[100:103], v[136:139], 0
  v_mfma_f32_16x16x32_f16 v[116:119], v[100:103], v[140:143], 0
  v_pk_mul_f32 v[4:5], v[104:105], v[228:229]
  v_pk_mul_f32 v[104:105], v[104:105], v[224:225]
  v_pk_fma_f32 v[104:105], v[108:109], v[228:229], v[104:105] neg_lo:[1,0,0] neg_hi:[1,0,0]
  v_pk_fma_f32 v[108:109], v[108:109], v[224:225], v[4:5]
  v_pk_mul_f32 v[6:7], v[106:107], v[230:231]
  v_pk_mul_f32 v[106:107], v[106:107], v[226:227]
  v_pk_fma_f32 v[106:107], v[110:111], v[230:231], v[106:107] neg_lo:[1,0,0] neg_hi:[1,0,0]
  v_pk_fma_f32 v[110:111], v[110:111], v[226:227], v[6:7]
  v_cvt_pk_f16_f32 v96, v104, v108
  v_cvt_pk_f16_f32 v97, v105, v109
  v_cvt_pk_f16_f32 v98, v106, v110
  v_cvt_pk_f16_f32 v99, v107, v111
  s_nop 1
  v_mfma_f32_16x16x32_f16 v[80:83], v[208:211], v[96:99], 0
  v_mfma_f32_16x16x32_f16 v[84:87], v[212:215], v[96:99], 0
  v_mfma_f32_16x16x32_f16 v[88:91], v[216:219], v[96:99], 0
  v_mfma_f32_16x16x32_f16 v[92:95], v[220:223], v[96:99], 0
  v_pk_mul_f32 v[4:5], v[112:113], v[228:229]
  v_pk_mul_f32 v[112:113], v[112:113], v[224:225]
  v_pk_fma_f32 v[112:113], v[116:117], v[228:229], v[112:113] neg_lo:[1,0,0] neg_hi:[1,0,0]
  v_pk_fma_f32 v[116:117], v[116:117], v[224:225], v[4:5]
  v_pk_mul_f32 v[6:7], v[114:115], v[230:231]
  v_pk_mul_f32 v[114:115], v[114:115], v[226:227]
  v_pk_fma_f32 v[114:115], v[118:119], v[230:231], v[114:115] neg_lo:[1,0,0] neg_hi:[1,0,0]
  v_pk_fma_f32 v[118:119], v[118:119], v[226:227], v[6:7]
  v_cvt_pk_f16_f32 v100, v112, v116
  v_cvt_pk_f16_f32 v101, v113, v117
  v_cvt_pk_f16_f32 v102, v114, v118
  v_cvt_pk_f16_f32 v103, v115, v119
  s_nop 1
  v_mfma_f32_16x16x32_f16 v[80:83], v[216:219], v[100:103], v[80:83]
  v_mfma_f32_16x16x32_f16 v[84:87], v[220:223], v[100:103], v[84:87]
  v_mfma_f32_16x16x32_f16 v[88:91], v[208:211], v[100:103], v[88:91]
  v_mfma_f32_16x16x32_f16 v[92:95], v[212:215], v[100:103], v[92:95]
  s_nop 5
  v_cvt_pk_f16_f32 v72, v80, v84
  s_nop 0
  v_cvt_pk_f16_f32 v73, v88, v92
  v_cvt_pk_f16_f32 v74, v81, v85
  v_cvt_pk_f16_f32 v75, v89, v93
  v_cvt_pk_f16_f32 v76, v82, v86
  v_cvt_pk_f16_f32 v77, v90, v94
  v_cvt_pk_f16_f32 v78, v83, v87
  v_cvt_pk_f16_f32 v79, v91, v95
  ds_write_b64 v61, v[72:73] offset:17408
  ds_write_b64 v61, v[74:75] offset:18432
  ds_write_b64 v61, v[76:77] offset:19456
  ds_write_b64 v61, v[78:79] offset:20480
  s_cmp_lg_u32 s18, 1
  s_cbranch_scc1 LC_n
  v_lshlrev_b32 v60, 10, v3
  v_lshl_add_u32 v60, v2, 4, v60
  s_mov_b32 s61, 253952
  buffer_load_dwordx4 v[176:179], v60, s[44:47], s61 offen offset:0
  buffer_load_dwordx4 v[180:183], v60, s[44:47], s61 offen offset:256
  buffer_load_dwordx4 v[184:187], v60, s[44:47], s61 offen offset:512
  buffer_load_dwordx4 v[188:191], v60, s[44:47], s61 offen offset:768
LC_n:
  s_cmp_lg_u32 s18, 2
  s_cbranch_scc1 F_na
  s_waitcnt vmcnt(0)
F_na:
  s_waitcnt lgkmcnt(0)
  s_barrier
  ds_read_b128 v[104:107], v62 offset:17408
  ds_read_b128 v[108:111], v62 offset:25600
  s_lshl_b32 s54, s52, 6
  s_add_u32 s20, s54, 2129920
  s_waitcnt lgkmcnt(1)
  v_bfi_b32 v104, s49, v120, v104
  v_bfi_b32 v105, s49, v121, v105
  v_bfi_b32 v106, s49, v122, v106
  v_bfi_b32 v107, s49, v123, v107
  buffer_store_dwordx4 v[104:107], v63, s[68:71], s54 offen sc1
  s_waitcnt lgkmcnt(0)
  v_bfi_b32 v108, s49, v120, v108
  v_bfi_b32 v109, s49, v121, v109
  v_bfi_b32 v110, s49, v122, v110
  v_bfi_b32 v111, s49, v123, v111
  buffer_store_dwordx4 v[108:111], v63, s[68:71], s20 offen sc1
  s_cmp_lg_u32 s18, 1
  s_nop 0
  s_cbranch_scc1 B_nolight
LC_chk:
  s_waitcnt vmcnt(0)
  v_xor_b32 v4, s36, v177
  v_xor_b32 v5, s36, v179
  v_or_b32 v4, v4, v5
  v_xor_b32 v5, s36, v181
  v_or_b32 v4, v4, v5
  v_xor_b32 v5, s36, v183
  v_or_b32 v4, v4, v5
  v_xor_b32 v5, s36, v185
  v_or_b32 v4, v4, v5
  v_xor_b32 v5, s36, v187
  v_or_b32 v4, v4, v5
  v_xor_b32 v5, s36, v189
  v_or_b32 v4, v4, v5
  v_xor_b32 v5, s36, v191
  v_or_b32 v4, v4, v5
  v_cmp_ne_u32 vcc, 0, v4
  s_nop 4
  s_cbranch_vccz LC_ok
  s_sleep 4
  v_lshlrev_b32 v60, 10, v3
  v_lshl_add_u32 v60, v2, 4, v60
  s_mov_b32 s61, 253952
  buffer_load_dwordx4 v[176:179], v60, s[44:47], s61 offen offset:0 sc1
  buffer_load_dwordx4 v[180:183], v60, s[44:47], s61 offen offset:256 sc1
  buffer_load_dwordx4 v[184:187], v60, s[44:47], s61 offen offset:512 sc1
  buffer_load_dwordx4 v[188:191], v60, s[44:47], s61 offen offset:768 sc1
  s_branch LC_chk
LC_ok:
  v_mov_b32 v96, v176
  v_mov_b32 v100, v178
  v_mov_b32 v97, v180
  v_mov_b32 v101, v182
  v_mov_b32 v98, v184
  v_mov_b32 v102, v186
  v_mov_b32 v99, v188
  v_mov_b32 v103, v190
  v_lshlrev_b32 v80, 16, v28
  v_and_b32 v84, s19, v28
  v_lshlrev_b32 v81, 16, v29
  v_and_b32 v85, s19, v29
  v_lshlrev_b32 v82, 16, v30
  v_and_b32 v86, s19, v30
  v_lshlrev_b32 v83, 16, v31
  v_and_b32 v87, s19, v31
  v_lshlrev_b32 v88, 16, v32
  v_and_b32 v92, s19, v32
  v_lshlrev_b32 v89, 16, v33
  v_and_b32 v93, s19, v33
  v_lshlrev_b32 v90, 16, v34
  v_and_b32 v94, s19, v34
  v_lshlrev_b32 v91, 16, v35
  v_and_b32 v95, s19, v35
  v_pk_mul_f32 v[80:81], v[80:81], s[56:57] op_sel_hi:[1,0]
  v_pk_mul_f32 v[82:83], v[82:83], s[56:57] op_sel_hi:[1,0]
  v_pk_mul_f32 v[84:85], v[84:85], s[56:57] op_sel_hi:[1,0]
  v_pk_mul_f32 v[86:87], v[86:87], s[56:57] op_sel_hi:[1,0]
  v_pk_mul_f32 v[88:89], v[88:89], s[56:57] op_sel_hi:[1,0]
  v_pk_mul_f32 v[90:91], v[90:91], s[56:57] op_sel_hi:[1,0]
  v_pk_mul_f32 v[92:93], v[92:93], s[56:57] op_sel_hi:[1,0]
  v_pk_mul_f32 v[94:95], v[94:95], s[56:57] op_sel_hi:[1,0]
  v_mfma_f32_16x16x32_f16 v[104:107], v[96:99], v[128:131], 0
  v_mfma_f32_16x16x32_f16 v[108:111], v[96:99], v[132:135], 0
  v_mfma_f32_16x16x32_f16 v[112:115], v[100:103], v[128:131], 0
  v_mfma_f32_16x16x32_f16 v[116:119], v[100:103], v[132:135], 0
  s_nop 4
  v_pk_mul_f32 v[4:5], v[104:105], v[228:229]
  v_pk_mul_f32 v[104:105], v[104:105], v[224:225]
  v_pk_fma_f32 v[104:105], v[108:109], v[228:229], v[104:105]
  v_pk_fma_f32 v[108:109], v[108:109], v[224:225], v[4:5] neg_lo:[0,0,1] neg_hi:[0,0,1]
  v_pk_mul_f32 v[6:7], v[106:107], v[230:231]
  v_pk_mul_f32 v[106:107], v[106:107], v[226:227]
  v_pk_fma_f32 v[106:107], v[110:111], v[230:231], v[106:107]
  v_pk_fma_f32 v[110:111], v[110:111], v[226:227], v[6:7] neg_lo:[0,0,1] neg_hi:[0,0,1]
  v_cvt_pk_f16_f32 v96, v104, v108
  v_cvt_pk_f16_f32 v97, v105, v109
  v_cvt_pk_f16_f32 v98, v106, v110
  v_cvt_pk_f16_f32 v99, v107, v111
  s_nop 1
  v_mfma_f32_16x16x32_f16 v[104:107], v[128:131], v[96:99], 0
  v_mfma_f32_16x16x32_f16 v[108:111], v[132:135], v[96:99], 0
  v_pk_mul_f32 v[4:5], v[112:113], v[228:229]
  v_pk_mul_f32 v[112:113], v[112:113], v[224:225]
  v_pk_fma_f32 v[112:113], v[116:117], v[228:229], v[112:113]
  v_pk_fma_f32 v[116:117], v[116:117], v[224:225], v[4:5] neg_lo:[0,0,1] neg_hi:[0,0,1]
  v_pk_mul_f32 v[6:7], v[114:115], v[230:231]
  v_pk_mul_f32 v[114:115], v[114:115], v[226:227]
  v_pk_fma_f32 v[114:115], v[118:119], v[230:231], v[114:115]
  v_pk_fma_f32 v[118:119], v[118:119], v[226:227], v[6:7] neg_lo:[0,0,1] neg_hi:[0,0,1]
  v_cvt_pk_f16_f32 v100, v112, v116
  v_cvt_pk_f16_f32 v101, v113, v117
  v_cvt_pk_f16_f32 v102, v114, v118
  v_cvt_pk_f16_f32 v103, v115, v119
  s_nop 1
  v_mfma_f32_16x16x32_f16 v[112:115], v[128:131], v[100:103], 0
  v_mfma_f32_16x16x32_f16 v[116:119], v[132:135], v[100:103], 0
  v_pk_mul_f32 v[4:5], v[104:105], v[84:85]
  v_pk_mul_f32 v[104:105], v[104:105], v[80:81]
  v_pk_fma_f32 v[104:105], v[108:109], v[84:85], v[104:105] neg_lo:[1,0,0] neg_hi:[1,0,0]
  v_pk_fma_f32 v[108:109], v[108:109], v[80:81], v[4:5]
  v_pk_mul_f32 v[6:7], v[106:107], v[86:87]
  v_pk_mul_f32 v[106:107], v[106:107], v[82:83]
  v_pk_fma_f32 v[106:107], v[110:111], v[86:87], v[106:107] neg_lo:[1,0,0] neg_hi:[1,0,0]
  v_pk_fma_f32 v[110:111], v[110:111], v[82:83], v[6:7]
  v_cvt_pk_f16_f32 v96, v104, v108
  v_cvt_pk_f16_f32 v97, v105, v109
  v_cvt_pk_f16_f32 v98, v106, v110
  v_cvt_pk_f16_f32 v99, v107, v111
  s_nop 1
  v_mfma_f32_16x16x32_f16 v[104:107], v[96:99], v[136:139], 0
  v_mfma_f32_16x16x32_f16 v[108:111], v[96:99], v[140:143], 0
  v_pk_mul_f32 v[4:5], v[112:113], v[92:93]
  v_pk_mul_f32 v[112:113], v[112:113], v[88:89]
  v_pk_fma_f32 v[112:113], v[116:117], v[92:93], v[112:113] neg_lo:[1,0,0] neg_hi:[1,0,0]
  v_pk_fma_f32 v[116:117], v[116:117], v[88:89], v[4:5]
  v_pk_mul_f32 v[6:7], v[114:115], v[94:95]
  v_pk_mul_f32 v[114:115], v[114:115], v[90:91]
  v_pk_fma_f32 v[114:115], v[118:119], v[94:95], v[114:115] neg_lo:[1,0,0] neg_hi:[1,0,0]
  v_pk_fma_f32 v[118:119], v[118:119], v[90:91], v[6:7]
  v_cvt_pk_f16_f32 v100, v112, v116
  v_cvt_pk_f16_f32 v101, v113, v117
  v_cvt_pk_f16_f32 v102, v114, v118
  v_cvt_pk_f16_f32 v103, v115, v119
  s_nop 1
  v_mfma_f32_16x16x32_f16 v[112:115], v[100:103], v[136:139], 0
  v_mfma_f32_16x16x32_f16 v[116:119], v[100:103], v[140:143], 0
  v_pk_mul_f32 v[4:5], v[104:105], v[228:229]
  v_pk_mul_f32 v[104:105], v[104:105], v[224:225]
  v_pk_fma_f32 v[104:105], v[108:109], v[228:229], v[104:105] neg_lo:[1,0,0] neg_hi:[1,0,0]
  v_pk_fma_f32 v[108:109], v[108:109], v[224:225], v[4:5]
  v_pk_mul_f32 v[6:7], v[106:107], v[230:231]
  v_pk_mul_f32 v[106:107], v[106:107], v[226:227]
  v_pk_fma_f32 v[106:107], v[110:111], v[230:231], v[106:107] neg_lo:[1,0,0] neg_hi:[1,0,0]
  v_pk_fma_f32 v[110:111], v[110:111], v[226:227], v[6:7]
  v_cvt_pk_f16_f32 v96, v104, v108
  v_cvt_pk_f16_f32 v97, v105, v109
  v_cvt_pk_f16_f32 v98, v106, v110
  v_cvt_pk_f16_f32 v99, v107, v111
  s_nop 1
  v_mfma_f32_16x16x32_f16 v[104:107], v[136:139], v[96:99], 0
  v_mfma_f32_16x16x32_f16 v[108:111], v[140:143], v[96:99], 0
  v_pk_mul_f32 v[4:5], v[112:113], v[228:229]
  v_pk_mul_f32 v[112:113], v[112:113], v[224:225]
  v_pk_fma_f32 v[112:113], v[116:117], v[228:229], v[112:113] neg_lo:[1,0,0] neg_hi:[1,0,0]
  v_pk_fma_f32 v[116:117], v[116:117], v[224:225], v[4:5]
  v_pk_mul_f32 v[6:7], v[114:115], v[230:231]
  v_pk_mul_f32 v[114:115], v[114:115], v[226:227]
  v_pk_fma_f32 v[114:115], v[118:119], v[230:231], v[114:115] neg_lo:[1,0,0] neg_hi:[1,0,0]
  v_pk_fma_f32 v[118:119], v[118:119], v[226:227], v[6:7]
  v_cvt_pk_f16_f32 v100, v112, v116
  v_cvt_pk_f16_f32 v101, v113, v117
  v_cvt_pk_f16_f32 v102, v114, v118
  v_cvt_pk_f16_f32 v103, v115, v119
  s_nop 1
  v_mfma_f32_16x16x32_f16 v[112:115], v[136:139], v[100:103], 0
  v_mfma_f32_16x16x32_f16 v[116:119], v[140:143], v[100:103], 0
  v_cvt_pk_f16_f32 v72, v104, v108
  s_nop 6
  v_cvt_pk_f16_f32 v73, v112, v116
  v_cvt_pk_f16_f32 v74, v105, v109
  v_cvt_pk_f16_f32 v75, v113, v117
  v_cvt_pk_f16_f32 v76, v106, v110
  v_cvt_pk_f16_f32 v77, v114, v118
  v_cvt_pk_f16_f32 v78, v107, v111
  v_cvt_pk_f16_f32 v79, v115, v119
  v_lshl_add_u32 v4, v3, 6, v2
  v_mov_b32 v6, 16384
  v_mov_b32 v7, 16448
  v_add_u32 v5, 0, v4
  v_cmp_eq_u32 vcc, s37, v5
  s_nop 1
  v_cndmask_b32 v8, v7, v6, vcc
  ds_write_b64 v8, v[72:73]
  v_add_u32 v5, 16, v4
  v_cmp_eq_u32 vcc, s37, v5
  s_nop 1
  v_cndmask_b32 v9, v7, v6, vcc
  ds_write_b64 v9, v[74:75]
  v_add_u32 v5, 32, v4
  v_cmp_eq_u32 vcc, s37, v5
  s_nop 1
  v_cndmask_b32 v10, v7, v6, vcc
  ds_write_b64 v10, v[76:77]
  v_add_u32 v5, 48, v4
  v_cmp_eq_u32 vcc, s37, v5
  s_nop 1
  v_cndmask_b32 v11, v7, v6, vcc
  ds_write_b64 v11, v[78:79]
B_nolight:
  v_lshlrev_b32 v60, 6, v2
  v_lshl_add_u32 v60, v3, 4, v60
  s_mul_i32 s53, s37, 16640
  s_lshl_b32 s54, s18, 11
  s_add_u32 s53, s53, s54
  s_add_u32 s56, s6, 8388608
  s_addc_u32 s57, s7, 0
  s_mov_b32 s58, 4259840
  s_mov_b32 s59, 0x20000
  s_mov_b32 s60, s4
  s_mov_b32 s61, s5
  s_mov_b32 s62, 4194304
  s_mov_b32 s63, 0x20000
  buffer_load_dwordx4 v[52:55], v60, s[60:63], s38 offen
  buffer_load_dwordx4 v[56:59], v60, s[60:63], s38 offen offset:1024
  s_add_u32 s64, s6, 19922944
  s_addc_u32 s65, s7, 0
  s_mov_b32 s66, 4194304
  s_mov_b32 s67, 0x20000
  s_add_u32 s68, s6, 24117248
  s_addc_u32 s69, s7, 0
  s_mov_b32 s70, 4194304
  s_mov_b32 s71, 0x20000
  s_lshl_b32 s72, s37, 3
  s_add_u32 s72, s72, s18
  s_lshl_b32 s73, s21, 18
  s_and_b32 s20, s72, 127
  s_lshl_b32 s20, s20, 7
  s_add_u32 s73, s73, s20
  s_bfe_u32 s20, s72, 0x30001
  v_and_b32 v4, 1, v2
  v_lshl_add_u32 v4, v4, 2, v3
  v_xor_b32 v4, s20, v4
  v_lshlrev_b32 v4, 4, v4
  v_lshrrev_b32 v5, 1, v2
  v_lshl_add_u32 v61, v5, 14, v4
  s_lshl_b32 s72, s72, 11
  s_and_b32 s55, s18, 3
  s_mul_i32 s25, s22, 448
  s_mul_i32 s20, s55, 114688
  s_add_u32 s25, s25, s20
  s_mul_i32 s26, s55, 7168
  s_add_u32 s26, s26, 65536
  s_lshr_b32 s20, s18, 2
  s_mul_i32 s74, s20, 458752
  s_add_u32 s74, s74, 5963776
  s_add_u32 s74, s74, s25
  s_mul_i32 s75, s20, 28672
  s_add_u32 s75, s75, s26
  v_lshrrev_b32 v10, 1, v3
  v_and_b32 v11, 1, v3
  s_lshl_b32 s20, s18, 5
  s_add_u32 s20, s20, 0
  v_lshl_add_u32 v4, v10, 8, v2
  v_add_u32 v4, s20, v4
  v_sub_u32 v5, 512, v4
  v_and_b32 v5, 511, v5
  v_lshlrev_b32 v4, 3, v4
  v_lshl_add_u32 v5, v5, 3, 4
  v_xor_b32 v8, v10, v11
  v_cmp_eq_u32 vcc, 0, v8
  v_add_u32 v6, 0, v11
  v_lshlrev_b32 v6, 6, v6
  v_subrev_u32 v6, 32, v6
  v_max_i32 v6, 0, v6
  v_cndmask_b32 v7, v5, v4, vcc
  v_lshl_add_u32 v40, v6, 6, v7
  v_lshl_add_u32 v8, v11, 16, v4
  v_cmp_eq_u32 vcc, 2048, v8
  v_mov_b32 v9, 16384
  s_nop 0
  v_cndmask_b32 v40, v40, v9, vcc
  v_xor_b32 v8, v10, v11
  v_cmp_eq_u32 vcc, 0, v8
  v_add_u32 v6, 1, v11
  v_lshlrev_b32 v6, 6, v6
  v_subrev_u32 v6, 32, v6
  v_max_i32 v6, 0, v6
  v_cndmask_b32 v7, v5, v4, vcc
  v_lshl_add_u32 v41, v6, 6, v7
  v_xor_b32 v8, v10, v11
  v_cmp_eq_u32 vcc, 0, v8
  v_add_u32 v6, 2, v11
  v_lshlrev_b32 v6, 6, v6
  v_subrev_u32 v6, 32, v6
  v_max_i32 v6, 0, v6
  v_cndmask_b32 v7, v5, v4, vcc
  v_lshl_add_u32 v42, v6, 6, v7
  v_mov_b32 v8, v10
  v_cmp_eq_u32 vcc, 0, v8
  v_add_u32 v6, 3, v11
  v_lshlrev_b32 v6, 6, v6
  v_subrev_u32 v6, 32, v6
  v_max_i32 v6, 0, v6
  v_cndmask_b32 v7, v5, v4, vcc
  v_lshl_add_u32 v43, v6, 6, v7
  v_lshl_add_u32 v8, v11, 16, v4
  v_cmp_eq_u32 vcc, 67584, v8
  v_mov_b32 v9, 16388
  s_nop 0
  v_cndmask_b32 v43, v43, v9, vcc
  s_lshl_b32 s20, s18, 5
  s_add_u32 s20, s20, 16
  v_lshl_add_u32 v4, v10, 8, v2
  v_add_u32 v4, s20, v4
  v_sub_u32 v5, 512, v4
  v_and_b32 v5, 511, v5
  v_lshlrev_b32 v4, 3, v4
  v_lshl_add_u32 v5, v5, 3, 4
  v_xor_b32 v8, v10, v11
  v_cmp_eq_u32 vcc, 0, v8
  v_add_u32 v6, 0, v11
  v_lshlrev_b32 v6, 6, v6
  v_subrev_u32 v6, 32, v6
  v_max_i32 v6, 0, v6
  v_cndmask_b32 v7, v5, v4, vcc
  v_lshl_add_u32 v44, v6, 6, v7
  v_lshl_add_u32 v8, v11, 16, v4
  v_cmp_eq_u32 vcc, 2048, v8
  v_mov_b32 v9, 16384
  s_nop 0
  v_cndmask_b32 v44, v44, v9, vcc
  v_xor_b32 v8, v10, v11
  v_cmp_eq_u32 vcc, 0, v8
  v_add_u32 v6, 1, v11
  v_lshlrev_b32 v6, 6, v6
  v_subrev_u32 v6, 32, v6
  v_max_i32 v6, 0, v6
  v_cndmask_b32 v7, v5, v4, vcc
  v_lshl_add_u32 v45, v6, 6, v7
  v_xor_b32 v8, v10, v11
  v_cmp_eq_u32 vcc, 0, v8
  v_add_u32 v6, 2, v11
  v_lshlrev_b32 v6, 6, v6
  v_subrev_u32 v6, 32, v6
  v_max_i32 v6, 0, v6
  v_cndmask_b32 v7, v5, v4, vcc
  v_lshl_add_u32 v46, v6, 6, v7
  v_mov_b32 v8, v10
  v_cmp_eq_u32 vcc, 0, v8
  v_add_u32 v6, 3, v11
  v_lshlrev_b32 v6, 6, v6
  v_subrev_u32 v6, 32, v6
  v_max_i32 v6, 0, v6
  v_cndmask_b32 v7, v5, v4, vcc
  v_lshl_add_u32 v47, v6, 6, v7
  v_lshl_add_u32 v8, v11, 16, v4
  v_cmp_eq_u32 vcc, 67584, v8
  v_mov_b32 v9, 16388
  s_nop 0
  v_cndmask_b32 v47, v47, v9, vcc
  s_and_b32 s20, s18, 1
  s_xor_b32 s20, s20, 0
  s_lshl_b32 s20, s20, 6
  s_lshl_b32 s76, s18, 7
  s_add_u32 s20, s20, s76
  s_add_u32 s20, s20, 17408
  v_and_b32 v4, 7, v2
  v_mul_u32_u24 v4, 2064, v4
  v_lshrrev_b32 v5, 3, v2
  v_lshl_add_u32 v4, v5, 10, v4
  v_lshl_add_u32 v4, v3, 4, v4
  v_add_u32 v48, s20, v4
  s_and_b32 s20, s18, 1
  s_xor_b32 s20, s20, 1
  s_lshl_b32 s20, s20, 6
  s_lshl_b32 s76, s18, 7
  s_add_u32 s20, s20, s76
  s_add_u32 s20, s20, 17408
  v_and_b32 v4, 7, v2
  v_mul_u32_u24 v4, 2064, v4
  v_lshrrev_b32 v5, 3, v2
  v_lshl_add_u32 v4, v5, 10, v4
  v_lshl_add_u32 v4, v3, 4, v4
  v_add_u32 v49, s20, v4
  s_mul_i32 s20, s18, 2064
  s_add_u32 s20, s20, 17408
  v_xor_b32 v4, 0, v11
  v_lshl_add_u32 v4, v4, 4, v2
  v_lshl_add_u32 v4, v3, 5, v4
  v_lshl_add_u32 v50, v4, 2, s20
  v_xor_b32 v4, 1, v11
  v_lshl_add_u32 v4, v4, 4, v2
  v_lshl_add_u32 v4, v3, 5, v4
  v_lshl_add_u32 v51, v4, 2, s20
  v_add_u32 v80, s54, v12
  s_cmp_eq_u32 s18, 1
  s_nop 0
  s_cbranch_scc1 ZB_done
  s_cmp_eq_u32 s18, 0
  s_cbranch_scc1 ZB_w0
  s_waitcnt vmcnt(0)
ZB_a:
  buffer_load_dwordx4 v[64:67], v12, s[56:59], s53 offen offset:0 sc1
  buffer_load_dwordx4 v[68:71], v12, s[56:59], s53 offen offset:1024 sc1
  s_waitcnt vmcnt(0)
  v_xor_b32 v64, v24, v64
  v_xor_b32 v65, v25, v65
  v_xor_b32 v66, v26, v66
  v_xor_b32 v67, v27, v67
  v_xor_b32 v68, v24, v68
  v_xor_b32 v69, v25, v69
  v_xor_b32 v70, v26, v70
  v_xor_b32 v71, v27, v71
  v_or_b32 v4, v64, v65
  v_or3_b32 v4, v4, v66, v67
  v_or3_b32 v4, v4, v68, v69
  v_or3_b32 v4, v4, v70, v71
  v_and_b32 v4, s49, v4
  v_cmp_ne_u32 vcc, 0, v4
  s_nop 4
  s_cbranch_vccz ZB_a_ok
  s_sleep 8
  s_branch ZB_a
ZB_a_ok:
  ds_write_b128 v80, v[64:67] offset:0
  ds_write_b128 v80, v[68:71] offset:1024
  s_branch ZB_done
ZB_w0:
  s_waitcnt vmcnt(0)
ZB_b:
  buffer_load_dwordx4 v[64:67], v12, s[56:59], s53 offen offset:0 sc1
  buffer_load_dwordx4 v[68:71], v12, s[56:59], s53 offen offset:1024 sc1
  buffer_load_dwordx4 v[72:75], v12, s[56:59], s53 offen offset:2048 sc1
  buffer_load_dwordx4 v[76:79], v12, s[56:59], s53 offen offset:3072 sc1
  s_waitcnt vmcnt(0)
  v_xor_b32 v64, v24, v64
  v_xor_b32 v65, v25, v65
  v_xor_b32 v66, v26, v66
  v_xor_b32 v67, v27, v67
  v_xor_b32 v68, v24, v68
  v_xor_b32 v69, v25, v69
  v_xor_b32 v70, v26, v70
  v_xor_b32 v71, v27, v71
  v_xor_b32 v72, v24, v72
  v_xor_b32 v73, v25, v73
  v_xor_b32 v74, v26, v74
  v_xor_b32 v75, v27, v75
  v_xor_b32 v76, v24, v76
  v_xor_b32 v77, v25, v77
  v_xor_b32 v78, v26, v78
  v_xor_b32 v79, v27, v79
  v_or_b32 v4, v64, v65
  v_or3_b32 v4, v4, v66, v67
  v_or3_b32 v4, v4, v68, v69
  v_or3_b32 v4, v4, v70, v71
  v_or3_b32 v4, v4, v72, v73
  v_or3_b32 v4, v4, v74, v75
  v_or3_b32 v4, v4, v76, v77
  v_or3_b32 v4, v4, v78, v79
  v_and_b32 v4, s49, v4
  v_cmp_ne_u32 vcc, 0, v4
  s_nop 4
  s_cbranch_vccz ZB_b_ok
  s_sleep 8
  s_branch ZB_b
ZB_b_ok:
  ds_write_b128 v80, v[64:67] offset:0
  ds_write_b128 v80, v[68:71] offset:1024
  ds_write_b128 v80, v[72:75] offset:2048
  ds_write_b128 v80, v[76:79] offset:3072
ZB_done:
  s_waitcnt vmcnt(0)
  s_waitcnt lgkmcnt(0)
  s_barrier
  s_min_u32 s20, s54, 10240
  s_add_u32 m0, s20, 50304
  s_add_u32 s20, s20, 589824
  buffer_load_dwordx4 v12, s[44:47], s20 offen sc1 lds
  buffer_load_dwordx4 v12, s[44:47], s20 offen offset:1024 sc1 lds
  ds_read_b128 v[108:111], v12 offset:48256
  ds_read_b128 v[112:115], v12 offset:49280
  ds_read_b32 v84, v40
  ds_read_b32 v85, v41
  ds_read_b32 v86, v42
  ds_read_b32 v87, v43
  ds_read_b32 v88, v44
  ds_read_b32 v89, v45
  ds_read_b32 v90, v46
  ds_read_b32 v91, v47
  s_add_u32 m0, s75, 0
  s_nop 0
  buffer_load_dwordx4 v16, s[28:31], s74 offen lds
  s_add_u32 m0, s75, 1024
  s_nop 0
  buffer_load_dwordx4 v17, s[28:31], s74 offen lds
  s_add_u32 m0, s75, 2048
  s_nop 0
  buffer_load_dwordx4 v18, s[28:31], s74 offen lds
  s_waitcnt lgkmcnt(4)
  v_mfma_f32_16x16x32_f16 v[92:95], v[84:87], v[108:111], 0
  v_mfma_f32_16x16x32_f16 v[96:99], v[84:87], v[112:115], 0
  s_waitcnt lgkmcnt(0)
  v_mfma_f32_16x16x32_f16 v[100:103], v[88:91], v[108:111], 0
  v_mfma_f32_16x16x32_f16 v[104:107], v[88:91], v[112:115], 0
  ds_read_b128 v[116:119], v12 offset:35968
  ds_read_b128 v[120:123], v12 offset:36992
  ds_read_b128 v[124:127], v12 offset:38016
  ds_read_b128 v[128:131], v12 offset:39040
  s_nop 0
  v_cvt_pk_f16_f32 v84, v92, v96
  v_cvt_pk_f16_f32 v85, v93, v97
  v_cvt_pk_f16_f32 v86, v94, v98
  v_cvt_pk_f16_f32 v87, v95, v99
  ds_write_b128 v48, v[84:87]
  v_cvt_pk_f16_f32 v88, v100, v104
  v_cvt_pk_f16_f32 v89, v101, v105
  v_cvt_pk_f16_f32 v90, v102, v106
  v_cvt_pk_f16_f32 v91, v103, v107
  ds_write_b128 v49, v[88:91]
  ds_read_b128 v[108:111], v12 offset:33920
  ds_read_b128 v[112:115], v12 offset:34944
  s_waitcnt lgkmcnt(0)
  s_barrier
  ds_read2st64_b32 v[84:85], v50 offset0:0 offset1:2
  ds_read2st64_b32 v[86:87], v50 offset0:4 offset1:6
  ds_read2st64_b32 v[88:89], v51 offset0:0 offset1:2
  ds_read2st64_b32 v[90:91], v51 offset0:4 offset1:6
  ds_read_b128 v[132:135], v12 offset:40064
  ds_read_b128 v[136:139], v12 offset:41088
  ds_read_b128 v[148:151], v12 offset:44160
  ds_read_b128 v[152:155], v12 offset:45184
  ds_read_b128 v[140:143], v12 offset:42112
  ds_read_b128 v[144:147], v12 offset:43136
  ds_read_b128 v[156:159], v12 offset:46208
  ds_read_b128 v[160:163], v12 offset:47232
  s_add_u32 m0, s75, 3072
  s_nop 0
  buffer_load_dwordx4 v19, s[28:31], s74 offen lds
  s_add_u32 m0, s75, 4096
  s_nop 0
  buffer_load_dwordx4 v20, s[28:31], s74 offen lds
  s_add_u32 m0, s75, 5120
  s_nop 0
  buffer_load_dwordx4 v21, s[28:31], s74 offen lds
  s_waitcnt lgkmcnt(10)
  v_mfma_f32_16x16x32_f16 v[92:95], v[84:87], v[108:111], 0
  v_mfma_f32_16x16x32_f16 v[96:99], v[84:87], v[112:115], 0
  s_waitcnt lgkmcnt(8)
  v_mfma_f32_16x16x32_f16 v[100:103], v[88:91], v[108:111], 0
  v_mfma_f32_16x16x32_f16 v[104:107], v[88:91], v[112:115], 0
  v_lshlrev_b32 v164, 16, v52
  v_and_b32 v168, s19, v52
  v_lshlrev_b32 v165, 16, v53
  v_and_b32 v169, s19, v53
  v_lshlrev_b32 v166, 16, v54
  v_and_b32 v170, s19, v54
  v_lshlrev_b32 v167, 16, v55
  v_and_b32 v171, s19, v55
  v_lshlrev_b32 v172, 16, v56
  v_and_b32 v176, s19, v56
  v_lshlrev_b32 v173, 16, v57
  v_and_b32 v177, s19, v57
  v_lshlrev_b32 v174, 16, v58
  v_and_b32 v178, s19, v58
  v_lshlrev_b32 v175, 16, v59
  v_and_b32 v179, s19, v59
  v_ldexp_f32 v212, 1.0, s39
  v_pk_mul_f32 v[4:5], v[92:93], v[124:125]
  v_pk_mul_f32 v[92:93], v[92:93], v[116:117]
  v_pk_fma_f32 v[92:93], v[96:97], v[124:125], v[92:93] neg_lo:[1,0,0] neg_hi:[1,0,0]
  v_pk_fma_f32 v[96:97], v[96:97], v[116:117], v[4:5]
  v_pk_mul_f32 v[6:7], v[94:95], v[126:127]
  v_pk_mul_f32 v[94:95], v[94:95], v[118:119]
  v_pk_fma_f32 v[94:95], v[98:99], v[126:127], v[94:95] neg_lo:[1,0,0] neg_hi:[1,0,0]
  v_pk_fma_f32 v[98:99], v[98:99], v[118:119], v[6:7]
  v_cvt_pk_f16_f32 v84, v92, v96
  v_cvt_pk_f16_f32 v85, v93, v97
  v_cvt_pk_f16_f32 v86, v94, v98
  v_cvt_pk_f16_f32 v87, v95, v99
  s_waitcnt lgkmcnt(4)
  s_nop 0
  v_mfma_f32_16x16x32_f16 v[180:183], v[84:87], v[132:135], 0
  v_mfma_f32_16x16x32_f16 v[184:187], v[84:87], v[136:139], 0
  v_mfma_f32_16x16x32_f16 v[188:191], v[84:87], v[148:151], 0
  v_mfma_f32_16x16x32_f16 v[192:195], v[84:87], v[152:155], 0
  v_pk_mul_f32 v[4:5], v[100:101], v[128:129]
  v_pk_mul_f32 v[100:101], v[100:101], v[120:121]
  v_pk_fma_f32 v[100:101], v[104:105], v[128:129], v[100:101] neg_lo:[1,0,0] neg_hi:[1,0,0]
  v_pk_fma_f32 v[104:105], v[104:105], v[120:121], v[4:5]
  v_pk_mul_f32 v[6:7], v[102:103], v[130:131]
  v_pk_mul_f32 v[102:103], v[102:103], v[122:123]
  v_pk_fma_f32 v[102:103], v[106:107], v[130:131], v[102:103] neg_lo:[1,0,0] neg_hi:[1,0,0]
  v_pk_fma_f32 v[106:107], v[106:107], v[122:123], v[6:7]
  v_cvt_pk_f16_f32 v88, v100, v104
  v_cvt_pk_f16_f32 v89, v101, v105
  v_cvt_pk_f16_f32 v90, v102, v106
  v_cvt_pk_f16_f32 v91, v103, v107
  s_waitcnt lgkmcnt(0)
  s_nop 0
  v_mfma_f32_16x16x32_f16 v[180:183], v[88:91], v[140:143], v[180:183]
  v_mfma_f32_16x16x32_f16 v[184:187], v[88:91], v[144:147], v[184:187]
  v_mfma_f32_16x16x32_f16 v[188:191], v[88:91], v[156:159], v[188:191]
  v_mfma_f32_16x16x32_f16 v[192:195], v[88:91], v[160:163], v[192:195]
  s_waitcnt vmcnt(6)
  s_barrier
  ds_read_b128 v[196:199], v12 offset:50304
  ds_read_b128 v[200:203], v12 offset:51328
  ds_read_b128 v[204:207], v12 offset:52352
  ds_read_b128 v[208:211], v12 offset:53376
  ds_read_b128 v[92:95], v12 offset:58496
  ds_read_b128 v[96:99], v12 offset:59520
  ds_read_b128 v[100:103], v12 offset:60544
  ds_read_b128 v[104:107], v12 offset:61568
  ds_read_b128 v[116:119], v12 offset:54400
  ds_read_b128 v[120:123], v12 offset:55424
  ds_read_b128 v[124:127], v12 offset:56448
  ds_read_b128 v[128:131], v12 offset:57472
  s_add_u32 m0, s75, 6144
  s_nop 0
  buffer_load_dwordx4 v22, s[28:31], s74 offen lds
  v_pk_mul_f32 v[180:181], v[180:181], v[212:213] op_sel_hi:[1,0]
  v_pk_mul_f32 v[182:183], v[182:183], v[212:213] op_sel_hi:[1,0]
  v_pk_mul_f32 v[184:185], v[184:185], v[212:213] op_sel_hi:[1,0]
  v_pk_mul_f32 v[186:187], v[186:187], v[212:213] op_sel_hi:[1,0]
  v_pk_mul_f32 v[188:189], v[188:189], v[212:213] op_sel_hi:[1,0]
  v_pk_mul_f32 v[190:191], v[190:191], v[212:213] op_sel_hi:[1,0]
  v_pk_mul_f32 v[192:193], v[192:193], v[212:213] op_sel_hi:[1,0]
  v_pk_mul_f32 v[194:195], v[194:195], v[212:213] op_sel_hi:[1,0]
  s_waitcnt lgkmcnt(8)
  v_pk_fma_f32 v[164:165], v[180:181], v[196:197], v[164:165]
  v_pk_fma_f32 v[166:167], v[182:183], v[198:199], v[166:167]
  v_pk_fma_f32 v[168:169], v[184:185], v[200:201], v[168:169]
  v_pk_fma_f32 v[170:171], v[186:187], v[202:203], v[170:171]
  v_pk_fma_f32 v[172:173], v[188:189], v[204:205], v[172:173]
  v_pk_fma_f32 v[174:175], v[190:191], v[206:207], v[174:175]
  v_pk_fma_f32 v[176:177], v[192:193], v[208:209], v[176:177]
  v_pk_fma_f32 v[178:179], v[194:195], v[210:211], v[178:179]
  v_cvt_pk_bf16_f32 v52, v164, v168
  v_cvt_pk_bf16_f32 v53, v165, v169
  v_cvt_pk_bf16_f32 v54, v166, v170
  v_cvt_pk_bf16_f32 v55, v167, v171
  v_cvt_pk_bf16_f32 v56, v172, v176
  v_cvt_pk_bf16_f32 v57, v173, v177
  v_cvt_pk_bf16_f32 v58, v174, v178
  v_cvt_pk_bf16_f32 v59, v175, v179
  buffer_store_dwordx4 v[52:55], v60, s[64:67], s72 offen sc1
  buffer_store_dwordx4 v[56:59], v60, s[64:67], s72 offen offset:1024 sc1
  v_readfirstlane_b32 s76, v164
  s_nop 1
  v_pk_add_f32 v[164:165], v[164:165], s[76:77] op_sel_hi:[1,0] neg_lo:[0,1] neg_hi:[0,1]
  v_pk_add_f32 v[166:167], v[166:167], s[76:77] op_sel_hi:[1,0] neg_lo:[0,1] neg_hi:[0,1]
  v_pk_add_f32 v[168:169], v[168:169], s[76:77] op_sel_hi:[1,0] neg_lo:[0,1] neg_hi:[0,1]
  v_pk_add_f32 v[170:171], v[170:171], s[76:77] op_sel_hi:[1,0] neg_lo:[0,1] neg_hi:[0,1]
  v_pk_add_f32 v[172:173], v[172:173], s[76:77] op_sel_hi:[1,0] neg_lo:[0,1] neg_hi:[0,1]
  v_pk_add_f32 v[174:175], v[174:175], s[76:77] op_sel_hi:[1,0] neg_lo:[0,1] neg_hi:[0,1]
  v_pk_add_f32 v[176:177], v[176:177], s[76:77] op_sel_hi:[1,0] neg_lo:[0,1] neg_hi:[0,1]
  v_pk_add_f32 v[178:179], v[178:179], s[76:77] op_sel_hi:[1,0] neg_lo:[0,1] neg_hi:[0,1]
  v_pk_add_f32 v[4:5], v[164:165], v[166:167]
  v_pk_mul_f32 v[6:7], v[164:165], v[164:165]
  v_pk_fma_f32 v[6:7], v[166:167], v[166:167], v[6:7]
  v_pk_add_f32 v[4:5], v[4:5], v[168:169]
  v_pk_fma_f32 v[6:7], v[168:169], v[168:169], v[6:7]
  v_pk_add_f32 v[4:5], v[4:5], v[170:171]
  v_pk_fma_f32 v[6:7], v[170:171], v[170:171], v[6:7]
  v_pk_add_f32 v[4:5], v[4:5], v[172:173]
  v_pk_fma_f32 v[6:7], v[172:173], v[172:173], v[6:7]
  v_pk_add_f32 v[4:5], v[4:5], v[174:175]
  v_pk_fma_f32 v[6:7], v[174:175], v[174:175], v[6:7]
  v_pk_add_f32 v[4:5], v[4:5], v[176:177]
  v_pk_fma_f32 v[6:7], v[176:177], v[176:177], v[6:7]
  v_pk_add_f32 v[4:5], v[4:5], v[178:179]
  v_pk_fma_f32 v[6:7], v[178:179], v[178:179], v[6:7]
  v_add_f32 v4, v4, v5
  v_add_f32 v6, v6, v7
  s_nop 0
  v_add_f32_dpp v4, v4, v4 row_ror:1 row_mask:0xf bank_mask:0xf
  v_add_f32_dpp v6, v6, v6 row_ror:1 row_mask:0xf bank_mask:0xf
  s_nop 0
  v_add_f32_dpp v4, v4, v4 row_ror:2 row_mask:0xf bank_mask:0xf
  v_add_f32_dpp v6, v6, v6 row_ror:2 row_mask:0xf bank_mask:0xf
  s_nop 0
  v_add_f32_dpp v4, v4, v4 row_ror:4 row_mask:0xf bank_mask:0xf
  v_add_f32_dpp v6, v6, v6 row_ror:4 row_mask:0xf bank_mask:0xf
  s_nop 0
  v_add_f32_dpp v4, v4, v4 row_ror:8 row_mask:0xf bank_mask:0xf
  v_add_f32_dpp v6, v6, v6 row_ror:8 row_mask:0xf bank_mask:0xf
  s_nop 0
  v_add_f32_dpp v4, v4, v4 row_bcast:15 row_mask:0xa bank_mask:0xf
  v_add_f32_dpp v6, v6, v6 row_bcast:15 row_mask:0xa bank_mask:0xf
  s_nop 0
  v_add_f32_dpp v4, v4, v4 row_bcast:31 row_mask:0xc bank_mask:0xf
  v_add_f32_dpp v6, v6, v6 row_bcast:31 row_mask:0xc bank_mask:0xf
  v_readlane_b32 s78, v4, 63
  v_readlane_b32 s79, v6, 63
  v_mov_b32 v4, 0x3a800000
  v_mul_f32 v213, s78, v4
  v_mul_f32 v212, s79, v4
  v_fma_f32 v212, -v213, v213, v212
  v_max_f32 v212, 0, v212
  v_cvt_pk_bf16_f32 v212, v212, v212
  v_lshlrev_b32 v212, 16, v212
  v_add_f32 v212, 0x3727c5ac, v212
  v_cvt_pk_bf16_f32 v212, v212, v212
  v_lshlrev_b32 v212, 16, v212
  v_sqrt_f32 v212, v212
  s_nop 0
  v_cvt_pk_bf16_f32 v212, v212, v212
  v_lshlrev_b32 v212, 16, v212
  v_rcp_f32 v212, v212
  s_nop 0
  v_mul_f32 v213, v213, v212
  v_pk_fma_f32 v[164:165], v[164:165], v[212:213], v[212:213] op_sel:[0,0,1] op_sel_hi:[1,0,1] neg_lo:[0,0,1] neg_hi:[0,0,1]
  v_pk_fma_f32 v[166:167], v[166:167], v[212:213], v[212:213] op_sel:[0,0,1] op_sel_hi:[1,0,1] neg_lo:[0,0,1] neg_hi:[0,0,1]
  v_pk_fma_f32 v[168:169], v[168:169], v[212:213], v[212:213] op_sel:[0,0,1] op_sel_hi:[1,0,1] neg_lo:[0,0,1] neg_hi:[0,0,1]
  v_pk_fma_f32 v[170:171], v[170:171], v[212:213], v[212:213] op_sel:[0,0,1] op_sel_hi:[1,0,1] neg_lo:[0,0,1] neg_hi:[0,0,1]
  v_pk_fma_f32 v[172:173], v[172:173], v[212:213], v[212:213] op_sel:[0,0,1] op_sel_hi:[1,0,1] neg_lo:[0,0,1] neg_hi:[0,0,1]
  v_pk_fma_f32 v[174:175], v[174:175], v[212:213], v[212:213] op_sel:[0,0,1] op_sel_hi:[1,0,1] neg_lo:[0,0,1] neg_hi:[0,0,1]
  v_pk_fma_f32 v[176:177], v[176:177], v[212:213], v[212:213] op_sel:[0,0,1] op_sel_hi:[1,0,1] neg_lo:[0,0,1] neg_hi:[0,0,1]
  v_pk_fma_f32 v[178:179], v[178:179], v[212:213], v[212:213] op_sel:[0,0,1] op_sel_hi:[1,0,1] neg_lo:[0,0,1] neg_hi:[0,0,1]
  s_waitcnt lgkmcnt(0)
  v_pk_fma_f32 v[164:165], v[164:165], v[92:93], v[116:117]
  v_pk_fma_f32 v[166:167], v[166:167], v[94:95], v[118:119]
  v_pk_fma_f32 v[168:169], v[168:169], v[96:97], v[120:121]
  v_pk_fma_f32 v[170:171], v[170:171], v[98:99], v[122:123]
  v_pk_fma_f32 v[172:173], v[172:173], v[100:101], v[124:125]
  v_pk_fma_f32 v[174:175], v[174:175], v[102:103], v[126:127]
  v_pk_fma_f32 v[176:177], v[176:177], v[104:105], v[128:129]
  v_pk_fma_f32 v[178:179], v[178:179], v[106:107], v[130:131]
  v_readfirstlane_b32 s76, v164
  s_nop 1
  v_pk_add_f32 v[164:165], v[164:165], s[76:77] op_sel_hi:[1,0] neg_lo:[0,1] neg_hi:[0,1]
  v_pk_add_f32 v[166:167], v[166:167], s[76:77] op_sel_hi:[1,0] neg_lo:[0,1] neg_hi:[0,1]
  v_pk_add_f32 v[168:169], v[168:169], s[76:77] op_sel_hi:[1,0] neg_lo:[0,1] neg_hi:[0,1]
  v_pk_add_f32 v[170:171], v[170:171], s[76:77] op_sel_hi:[1,0] neg_lo:[0,1] neg_hi:[0,1]
  v_pk_add_f32 v[172:173], v[172:173], s[76:77] op_sel_hi:[1,0] neg_lo:[0,1] neg_hi:[0,1]
  v_pk_add_f32 v[174:175], v[174:175], s[76:77] op_sel_hi:[1,0] neg_lo:[0,1] neg_hi:[0,1]
  v_pk_add_f32 v[176:177], v[176:177], s[76:77] op_sel_hi:[1,0] neg_lo:[0,1] neg_hi:[0,1]
  v_pk_add_f32 v[178:179], v[178:179], s[76:77] op_sel_hi:[1,0] neg_lo:[0,1] neg_hi:[0,1]
  v_pk_add_f32 v[4:5], v[164:165], v[166:167]
  v_pk_mul_f32 v[6:7], v[164:165], v[164:165]
  v_pk_fma_f32 v[6:7], v[166:167], v[166:167], v[6:7]
  v_pk_add_f32 v[4:5], v[4:5], v[168:169]
  v_pk_fma_f32 v[6:7], v[168:169], v[168:169], v[6:7]
  v_pk_add_f32 v[4:5], v[4:5], v[170:171]
  v_pk_fma_f32 v[6:7], v[170:171], v[170:171], v[6:7]
  v_pk_add_f32 v[4:5], v[4:5], v[172:173]
  v_pk_fma_f32 v[6:7], v[172:173], v[172:173], v[6:7]
  v_pk_add_f32 v[4:5], v[4:5], v[174:175]
  v_pk_fma_f32 v[6:7], v[174:175], v[174:175], v[6:7]
  v_pk_add_f32 v[4:5], v[4:5], v[176:177]
  v_pk_fma_f32 v[6:7], v[176:177], v[176:177], v[6:7]
  v_pk_add_f32 v[4:5], v[4:5], v[178:179]
  v_pk_fma_f32 v[6:7], v[178:179], v[178:179], v[6:7]
  v_add_f32 v4, v4, v5
  v_add_f32 v6, v6, v7
  s_nop 0
  v_add_f32_dpp v4, v4, v4 row_ror:1 row_mask:0xf bank_mask:0xf
  v_add_f32_dpp v6, v6, v6 row_ror:1 row_mask:0xf bank_mask:0xf
  s_nop 0
  v_add_f32_dpp v4, v4, v4 row_ror:2 row_mask:0xf bank_mask:0xf
  v_add_f32_dpp v6, v6, v6 row_ror:2 row_mask:0xf bank_mask:0xf
  s_nop 0
  v_add_f32_dpp v4, v4, v4 row_ror:4 row_mask:0xf bank_mask:0xf
  v_add_f32_dpp v6, v6, v6 row_ror:4 row_mask:0xf bank_mask:0xf
  s_nop 0
  v_add_f32_dpp v4, v4, v4 row_ror:8 row_mask:0xf bank_mask:0xf
  v_add_f32_dpp v6, v6, v6 row_ror:8 row_mask:0xf bank_mask:0xf
  s_nop 0
  v_add_f32_dpp v4, v4, v4 row_bcast:15 row_mask:0xa bank_mask:0xf
  v_add_f32_dpp v6, v6, v6 row_bcast:15 row_mask:0xa bank_mask:0xf
  s_nop 0
  v_add_f32_dpp v4, v4, v4 row_bcast:31 row_mask:0xc bank_mask:0xf
  v_add_f32_dpp v6, v6, v6 row_bcast:31 row_mask:0xc bank_mask:0xf
  v_readlane_b32 s78, v4, 63
  v_readlane_b32 s79, v6, 63
  v_mov_b32 v4, 0x3a800000
  v_mul_f32 v213, s78, v4
  v_mul_f32 v212, s79, v4
  v_fma_f32 v212, -v213, v213, v212
  v_max_f32 v212, 0, v212
  v_cvt_pk_bf16_f32 v212, v212, v212
  v_lshlrev_b32 v212, 16, v212
  v_add_f32 v212, 0x3727c5ac, v212
  v_cvt_pk_bf16_f32 v212, v212, v212
  v_lshlrev_b32 v212, 16, v212
  v_sqrt_f32 v212, v212
  s_nop 0
  v_cvt_pk_bf16_f32 v212, v212, v212
  v_lshlrev_b32 v212, 16, v212
  v_rcp_f32 v212, v212
  s_nop 0
  v_mul_f32 v213, v213, v212
  v_pk_fma_f32 v[164:165], v[164:165], v[212:213], v[212:213] op_sel:[0,0,1] op_sel_hi:[1,0,1] neg_lo:[0,0,1] neg_hi:[0,0,1]
  v_pk_fma_f32 v[166:167], v[166:167], v[212:213], v[212:213] op_sel:[0,0,1] op_sel_hi:[1,0,1] neg_lo:[0,0,1] neg_hi:[0,0,1]
  v_pk_fma_f32 v[168:169], v[168:169], v[212:213], v[212:213] op_sel:[0,0,1] op_sel_hi:[1,0,1] neg_lo:[0,0,1] neg_hi:[0,0,1]
  v_pk_fma_f32 v[170:171], v[170:171], v[212:213], v[212:213] op_sel:[0,0,1] op_sel_hi:[1,0,1] neg_lo:[0,0,1] neg_hi:[0,0,1]
  v_pk_fma_f32 v[172:173], v[172:173], v[212:213], v[212:213] op_sel:[0,0,1] op_sel_hi:[1,0,1] neg_lo:[0,0,1] neg_hi:[0,0,1]
  v_pk_fma_f32 v[174:175], v[174:175], v[212:213], v[212:213] op_sel:[0,0,1] op_sel_hi:[1,0,1] neg_lo:[0,0,1] neg_hi:[0,0,1]
  v_pk_fma_f32 v[176:177], v[176:177], v[212:213], v[212:213] op_sel:[0,0,1] op_sel_hi:[1,0,1] neg_lo:[0,0,1] neg_hi:[0,0,1]
  v_pk_fma_f32 v[178:179], v[178:179], v[212:213], v[212:213] op_sel:[0,0,1] op_sel_hi:[1,0,1] neg_lo:[0,0,1] neg_hi:[0,0,1]
  v_cvt_pk_bf16_f32 v84, v164, v168
  v_cvt_pk_bf16_f32 v85, v165, v169
  v_cvt_pk_bf16_f32 v86, v166, v170
  v_cvt_pk_bf16_f32 v87, v167, v171
  v_cvt_pk_bf16_f32 v88, v172, v176
  v_cvt_pk_bf16_f32 v89, v173, v177
  v_cvt_pk_bf16_f32 v90, v174, v178
  v_cvt_pk_bf16_f32 v91, v175, v179
  s_add_u32 s20, s73, 131072
  buffer_store_dwordx4 v[84:87], v61, s[68:71], s73 offen sc1
  buffer_store_dwordx4 v[88:91], v61, s[68:71], s20 offen sc1
  s_lshl_b32 s37, s21, 11
  s_lshl_b32 s20, s22, 7
  s_add_u32 s20, s20, s37
  s_add_u32 s20, s20, 32768
  v_and_b32 v4, 31, v1
  v_lshlrev_b32 v4, 2, v4
  v_mov_b32 v5, s36
  s_cmp_lg_u32 s18, 4
  s_waitcnt vmcnt(0)
  s_barrier
  s_cbranch_scc1 CG_nf1
  buffer_store_dword v5, v4, s[32:35], s20 offen sc1
CG_nf1:
  s_cmp_ge_u32 s18, 4
  s_cbranch_scc1 CG_loader
  v_lshlrev_b32 v23, 3, v3
  s_mul_i32 s37, s22, 448
  s_lshl_b32 s20, s24, 5
  s_add_u32 s38, s37, s20
  s_mul_i32 s20, s24, 192
  s_add_u32 s37, s37, s20
  s_mov_b32 s40, s10
  s_mov_b32 s41, s11
  s_mov_b32 s42, 7168
  s_mov_b32 s43, 0x20000
  buffer_load_dwordx2 v[180:181], v23, s[40:43], s37 offen offset:0
  buffer_load_dwordx2 v[182:183], v23, s[40:43], s37 offen offset:32
  buffer_load_dwordx2 v[184:185], v23, s[40:43], s37 offen offset:64
  buffer_load_dwordx2 v[186:187], v23, s[40:43], s37 offen offset:96
  buffer_load_dwordx2 v[188:189], v23, s[40:43], s37 offen offset:128
  buffer_load_dwordx2 v[190:191], v23, s[40:43], s37 offen offset:160
  buffer_load_dwordx2 v[192:193], v23, s[40:43], s38 offen offset:384
  s_add_u32 s20, s25, 6881280
  s_add_u32 m0, s26, 57344
  s_nop 0
  buffer_load_dwordx4 v16, s[28:31], s20 offen lds
  s_add_u32 m0, s26, 58368
  s_nop 0
  buffer_load_dwordx4 v17, s[28:31], s20 offen lds
  s_add_u32 m0, s26, 59392
  s_nop 0
  buffer_load_dwordx4 v18, s[28:31], s20 offen lds
  s_add_u32 m0, s26, 60416
  s_nop 0
  buffer_load_dwordx4 v19, s[28:31], s20 offen lds
  s_add_u32 m0, s26, 61440
  s_nop 0
  buffer_load_dwordx4 v20, s[28:31], s20 offen lds
  s_add_u32 m0, s26, 62464
  s_nop 0
  buffer_load_dwordx4 v21, s[28:31], s20 offen lds
  s_add_u32 m0, s26, 63488
  s_nop 0
  buffer_load_dwordx4 v22, s[28:31], s20 offen lds
  s_mov_b32 s48, s12
  s_mov_b32 s49, s13
  s_mov_b32 s50, 7340032
  s_mov_b32 s51, 0x20000
  v_lshlrev_b32 v16, 7, v1
  v_cmp_gt_u32 vcc, 28, v1
  v_mov_b32 v4, 2147483632
  s_nop 0
  v_cndmask_b32 v16, v4, v16, vcc
  s_lshl_b32 s44, s2, 2
  s_add_u32 s44, s44, s18
  s_mul_i32 s44, s44, 3584
  s_add_u32 s44, s44, 0
  v_lshrrev_b32 v4, 1, v2
  v_xor_b32 v4, v4, v3
  v_lshlrev_b32 v4, 4, v4
  v_lshl_add_u32 v4, v2, 7, v4
  s_lshl_b32 s20, s23, 13
  v_add_u32 v224, s20, v4
  v_xor_b32 v225, 64, v224
  v_lshrrev_b32 v4, 2, v2
  v_lshl_add_u32 v4, v3, 3, v4
  v_mul_u32_u24 v4, 448, v4
  v_and_b32 v5, 3, v2
  v_lshl_add_u32 v4, v5, 3, v4
  v_and_b32 v5, 1, v3
  v_lshlrev_b32 v5, 5, v5
  s_mul_i32 s20, s24, 192
  v_add_u32 v6, s20, v4
  v_add_u32 v7, 65536, v6
  v_add_u32 v228, v7, v5
  v_sub_u32 v229, v7, v5
  v_add_u32 v7, 94208, v6
  v_add_u32 v231, v7, v5
  v_sub_u32 v232, v7, v5
  v_add_u32 v7, 122880, v6
  v_add_u32 v234, v7, v5
  v_sub_u32 v235, v7, v5
  s_lshl_b32 s20, s24, 5
  v_xor_b32 v5, s20, v5
  v_add_u32 v6, v4, v5
  v_add_u32 v230, 65920, v6
  v_add_u32 v233, 94592, v6
  v_add_u32 v236, 123264, v6
  s_waitcnt vmcnt(0)
  v_lshlrev_b32 v108, 16, v180
  v_and_b32 v109, s19, v180
  v_lshlrev_b32 v110, 16, v181
  v_and_b32 v111, s19, v181
  v_lshlrev_b32 v112, 16, v182
  v_and_b32 v113, s19, v182
  v_lshlrev_b32 v114, 16, v183
  v_and_b32 v115, s19, v183
  v_lshlrev_b32 v116, 16, v184
  v_and_b32 v117, s19, v184
  v_lshlrev_b32 v118, 16, v185
  v_and_b32 v119, s19, v185
  v_lshlrev_b32 v120, 16, v186
  v_and_b32 v121, s19, v186
  v_lshlrev_b32 v122, 16, v187
  v_and_b32 v123, s19, v187
  v_lshlrev_b32 v124, 16, v188
  v_and_b32 v125, s19, v188
  v_lshlrev_b32 v126, 16, v189
  v_and_b32 v127, s19, v189
  v_lshlrev_b32 v128, 16, v190
  v_and_b32 v129, s19, v190
  v_lshlrev_b32 v130, 16, v191
  v_and_b32 v131, s19, v191
  v_lshlrev_b32 v132, 16, v192
  v_and_b32 v133, s19, v192
  v_lshlrev_b32 v134, 16, v193
  v_and_b32 v135, s19, v193
  s_cmp_lg_u32 s18, 0
  s_nop 0
  s_cbranch_scc1 CG_np1
  s_lshl_b32 s37, s21, 11
  s_add_u32 s37, s37, 32768
  v_lshlrev_b32 v6, 7, v2
CG_p1:
  buffer_load_dword v7, v6, s[32:35], s37 offen sc1
  s_waitcnt vmcnt(0)
  v_cmp_ne_u32 vcc, s36, v7
  s_nop 4
  s_cbranch_vccz CG_p1_ok
  s_sleep 1
  s_branch CG_p1
CG_p1_ok:
CG_np1:
  s_barrier
  s_barrier
  ds_read_b128 v[164:167], v224 offset:0
  ds_read_b64_tr_b16 v[136:137], v228 offset:0
  ds_read_b64_tr_b16 v[138:139], v228 offset:1792
  ds_read_b64_tr_b16 v[140:141], v229 offset:32
  ds_read_b64_tr_b16 v[142:143], v229 offset:1824
  ds_read_b64_tr_b16 v[144:145], v228 offset:64
  ds_read_b64_tr_b16 v[146:147], v228 offset:1856
  ds_read_b64_tr_b16 v[148:149], v229 offset:96
  ds_read_b64_tr_b16 v[150:151], v229 offset:1888
  ds_read_b64_tr_b16 v[152:153], v228 offset:128
  ds_read_b64_tr_b16 v[154:155], v228 offset:1920
  ds_read_b64_tr_b16 v[156:157], v229 offset:160
  ds_read_b64_tr_b16 v[158:159], v229 offset:1952
  ds_read_b64_tr_b16 v[160:161], v230 offset:0
  ds_read_b64_tr_b16 v[162:163], v230 offset:1792
  ds_read_b128 v[168:171], v224 offset:2048
  ds_read_b128 v[172:175], v224 offset:4096
  ds_read_b128 v[176:179], v224 offset:6144
  s_waitcnt lgkmcnt(0)
  v_mfma_f32_16x16x32_bf16 v[24:27], v[136:139], v[164:167], v[108:111]
  ds_read_b128 v[208:211], v225 offset:0
  v_mfma_f32_16x16x32_bf16 v[28:31], v[140:143], v[164:167], v[112:115]
  ds_read_b64_tr_b16 v[180:181], v228 offset:14336
  v_mfma_f32_16x16x32_bf16 v[32:35], v[144:147], v[164:167], v[116:119]
  ds_read_b64_tr_b16 v[182:183], v228 offset:16128
  v_mfma_f32_16x16x32_bf16 v[36:39], v[148:151], v[164:167], v[120:123]
  ds_read_b64_tr_b16 v[184:185], v229 offset:14368
  v_mfma_f32_16x16x32_bf16 v[40:43], v[152:155], v[164:167], v[124:127]
  ds_read_b64_tr_b16 v[186:187], v229 offset:16160
  v_mfma_f32_16x16x32_bf16 v[44:47], v[156:159], v[164:167], v[128:131]
  ds_read_b64_tr_b16 v[188:189], v228 offset:14400
  v_mfma_f32_16x16x32_bf16 v[48:51], v[160:163], v[164:167], v[132:135]
  ds_read_b64_tr_b16 v[190:191], v228 offset:16192
  v_mfma_f32_16x16x32_bf16 v[52:55], v[136:139], v[168:171], v[108:111]
  ds_read_b64_tr_b16 v[192:193], v229 offset:14432
  v_mfma_f32_16x16x32_bf16 v[56:59], v[140:143], v[168:171], v[112:115]
  ds_read_b64_tr_b16 v[194:195], v229 offset:16224
  v_mfma_f32_16x16x32_bf16 v[60:63], v[144:147], v[168:171], v[116:119]
  ds_read_b64_tr_b16 v[196:197], v228 offset:14464
  v_mfma_f32_16x16x32_bf16 v[64:67], v[148:151], v[168:171], v[120:123]
  ds_read_b64_tr_b16 v[198:199], v228 offset:16256
  v_mfma_f32_16x16x32_bf16 v[68:71], v[152:155], v[168:171], v[124:127]
  ds_read_b64_tr_b16 v[200:201], v229 offset:14496
  v_mfma_f32_16x16x32_bf16 v[72:75], v[156:159], v[168:171], v[128:131]
  ds_read_b64_tr_b16 v[202:203], v229 offset:16288
  v_mfma_f32_16x16x32_bf16 v[76:79], v[160:163], v[168:171], v[132:135]
  ds_read_b64_tr_b16 v[204:205], v230 offset:14336
  v_mfma_f32_16x16x32_bf16 v[80:83], v[136:139], v[172:175], v[108:111]
  ds_read_b64_tr_b16 v[206:207], v230 offset:16128
  v_mfma_f32_16x16x32_bf16 v[84:87], v[140:143], v[172:175], v[112:115]
  ds_read_b128 v[212:215], v225 offset:2048
  v_mfma_f32_16x16x32_bf16 v[88:91], v[144:147], v[172:175], v[116:119]
  ds_read_b128 v[216:219], v225 offset:4096
  v_mfma_f32_16x16x32_bf16 v[92:95], v[148:151], v[172:175], v[120:123]
  ds_read_b128 v[220:223], v225 offset:6144
  v_mfma_f32_16x16x32_bf16 v[96:99], v[152:155], v[172:175], v[124:127]
  v_mfma_f32_16x16x32_bf16 v[100:103], v[156:159], v[172:175], v[128:131]
  v_mfma_f32_16x16x32_bf16 v[104:107], v[160:163], v[172:175], v[132:135]
  v_mfma_f32_16x16x32_bf16 v[108:111], v[136:139], v[176:179], v[108:111]
  v_mfma_f32_16x16x32_bf16 v[112:115], v[140:143], v[176:179], v[112:115]
  v_mfma_f32_16x16x32_bf16 v[116:119], v[144:147], v[176:179], v[116:119]
  v_mfma_f32_16x16x32_bf16 v[120:123], v[148:151], v[176:179], v[120:123]
  v_mfma_f32_16x16x32_bf16 v[124:127], v[152:155], v[176:179], v[124:127]
  v_mfma_f32_16x16x32_bf16 v[128:131], v[156:159], v[176:179], v[128:131]
  v_mfma_f32_16x16x32_bf16 v[132:135], v[160:163], v[176:179], v[132:135]
  s_waitcnt lgkmcnt(0)
  s_barrier
  v_mfma_f32_16x16x32_bf16 v[24:27], v[180:183], v[208:211], v[24:27]
  ds_read_b128 v[164:167], v224 offset:16384
  v_mfma_f32_16x16x32_bf16 v[28:31], v[184:187], v[208:211], v[28:31]
  ds_read_b64_tr_b16 v[136:137], v231 offset:0
  v_mfma_f32_16x16x32_bf16 v[32:35], v[188:191], v[208:211], v[32:35]
  ds_read_b64_tr_b16 v[138:139], v231 offset:1792
  v_mfma_f32_16x16x32_bf16 v[36:39], v[192:195], v[208:211], v[36:39]
  ds_read_b64_tr_b16 v[140:141], v232 offset:32
  v_mfma_f32_16x16x32_bf16 v[40:43], v[196:199], v[208:211], v[40:43]
  ds_read_b64_tr_b16 v[142:143], v232 offset:1824
  v_mfma_f32_16x16x32_bf16 v[44:47], v[200:203], v[208:211], v[44:47]
  ds_read_b64_tr_b16 v[144:145], v231 offset:64
  v_mfma_f32_16x16x32_bf16 v[48:51], v[204:207], v[208:211], v[48:51]
  ds_read_b64_tr_b16 v[146:147], v231 offset:1856
  v_mfma_f32_16x16x32_bf16 v[52:55], v[180:183], v[212:215], v[52:55]
  ds_read_b64_tr_b16 v[148:149], v232 offset:96
  v_mfma_f32_16x16x32_bf16 v[56:59], v[184:187], v[212:215], v[56:59]
  ds_read_b64_tr_b16 v[150:151], v232 offset:1888
  v_mfma_f32_16x16x32_bf16 v[60:63], v[188:191], v[212:215], v[60:63]
  ds_read_b64_tr_b16 v[152:153], v231 offset:128
  v_mfma_f32_16x16x32_bf16 v[64:67], v[192:195], v[212:215], v[64:67]
  ds_read_b64_tr_b16 v[154:155], v231 offset:1920
  v_mfma_f32_16x16x32_bf16 v[68:71], v[196:199], v[212:215], v[68:71]
  ds_read_b64_tr_b16 v[156:157], v232 offset:160
  v_mfma_f32_16x16x32_bf16 v[72:75], v[200:203], v[212:215], v[72:75]
  ds_read_b64_tr_b16 v[158:159], v232 offset:1952
  v_mfma_f32_16x16x32_bf16 v[76:79], v[204:207], v[212:215], v[76:79]
  ds_read_b64_tr_b16 v[160:161], v233 offset:0
  v_mfma_f32_16x16x32_bf16 v[80:83], v[180:183], v[216:219], v[80:83]
  ds_read_b64_tr_b16 v[162:163], v233 offset:1792
  v_mfma_f32_16x16x32_bf16 v[84:87], v[184:187], v[216:219], v[84:87]
  ds_read_b128 v[168:171], v224 offset:18432
  v_mfma_f32_16x16x32_bf16 v[88:91], v[188:191], v[216:219], v[88:91]
  ds_read_b128 v[172:175], v224 offset:20480
  v_mfma_f32_16x16x32_bf16 v[92:95], v[192:195], v[216:219], v[92:95]
  ds_read_b128 v[176:179], v224 offset:22528
  v_mfma_f32_16x16x32_bf16 v[96:99], v[196:199], v[216:219], v[96:99]
  v_mfma_f32_16x16x32_bf16 v[100:103], v[200:203], v[216:219], v[100:103]
  v_mfma_f32_16x16x32_bf16 v[104:107], v[204:207], v[216:219], v[104:107]
  v_mfma_f32_16x16x32_bf16 v[108:111], v[180:183], v[220:223], v[108:111]
  v_mfma_f32_16x16x32_bf16 v[112:115], v[184:187], v[220:223], v[112:115]
  v_mfma_f32_16x16x32_bf16 v[116:119], v[188:191], v[220:223], v[116:119]
  v_mfma_f32_16x16x32_bf16 v[120:123], v[192:195], v[220:223], v[120:123]
  v_mfma_f32_16x16x32_bf16 v[124:127], v[196:199], v[220:223], v[124:127]
  v_mfma_f32_16x16x32_bf16 v[128:131], v[200:203], v[220:223], v[128:131]
  v_mfma_f32_16x16x32_bf16 v[132:135], v[204:207], v[220:223], v[132:135]
  s_waitcnt lgkmcnt(0)
  v_mfma_f32_16x16x32_bf16 v[24:27], v[136:139], v[164:167], v[24:27]
  ds_read_b128 v[208:211], v225 offset:16384
  v_mfma_f32_16x16x32_bf16 v[28:31], v[140:143], v[164:167], v[28:31]
  ds_read_b64_tr_b16 v[180:181], v231 offset:14336
  v_mfma_f32_16x16x32_bf16 v[32:35], v[144:147], v[164:167], v[32:35]
  ds_read_b64_tr_b16 v[182:183], v231 offset:16128
  v_mfma_f32_16x16x32_bf16 v[36:39], v[148:151], v[164:167], v[36:39]
  ds_read_b64_tr_b16 v[184:185], v232 offset:14368
  v_mfma_f32_16x16x32_bf16 v[40:43], v[152:155], v[164:167], v[40:43]
  ds_read_b64_tr_b16 v[186:187], v232 offset:16160
  v_mfma_f32_16x16x32_bf16 v[44:47], v[156:159], v[164:167], v[44:47]
  ds_read_b64_tr_b16 v[188:189], v231 offset:14400
  v_mfma_f32_16x16x32_bf16 v[48:51], v[160:163], v[164:167], v[48:51]
  ds_read_b64_tr_b16 v[190:191], v231 offset:16192
  v_mfma_f32_16x16x32_bf16 v[52:55], v[136:139], v[168:171], v[52:55]
  ds_read_b64_tr_b16 v[192:193], v232 offset:14432
  v_mfma_f32_16x16x32_bf16 v[56:59], v[140:143], v[168:171], v[56:59]
  ds_read_b64_tr_b16 v[194:195], v232 offset:16224
  v_mfma_f32_16x16x32_bf16 v[60:63], v[144:147], v[168:171], v[60:63]
  ds_read_b64_tr_b16 v[196:197], v231 offset:14464
  v_mfma_f32_16x16x32_bf16 v[64:67], v[148:151], v[168:171], v[64:67]
  ds_read_b64_tr_b16 v[198:199], v231 offset:16256
  v_mfma_f32_16x16x32_bf16 v[68:71], v[152:155], v[168:171], v[68:71]
  ds_read_b64_tr_b16 v[200:201], v232 offset:14496
  v_mfma_f32_16x16x32_bf16 v[72:75], v[156:159], v[168:171], v[72:75]
  ds_read_b64_tr_b16 v[202:203], v232 offset:16288
  v_mfma_f32_16x16x32_bf16 v[76:79], v[160:163], v[168:171], v[76:79]
  ds_read_b64_tr_b16 v[204:205], v233 offset:14336
  v_mfma_f32_16x16x32_bf16 v[80:83], v[136:139], v[172:175], v[80:83]
  ds_read_b64_tr_b16 v[206:207], v233 offset:16128
  v_mfma_f32_16x16x32_bf16 v[84:87], v[140:143], v[172:175], v[84:87]
  ds_read_b128 v[212:215], v225 offset:18432
  v_mfma_f32_16x16x32_bf16 v[88:91], v[144:147], v[172:175], v[88:91]
  ds_read_b128 v[216:219], v225 offset:20480
  v_mfma_f32_16x16x32_bf16 v[92:95], v[148:151], v[172:175], v[92:95]
  ds_read_b128 v[220:223], v225 offset:22528
  v_mfma_f32_16x16x32_bf16 v[96:99], v[152:155], v[172:175], v[96:99]
  v_mfma_f32_16x16x32_bf16 v[100:103], v[156:159], v[172:175], v[100:103]
  v_mfma_f32_16x16x32_bf16 v[104:107], v[160:163], v[172:175], v[104:107]
  v_mfma_f32_16x16x32_bf16 v[108:111], v[136:139], v[176:179], v[108:111]
  v_mfma_f32_16x16x32_bf16 v[112:115], v[140:143], v[176:179], v[112:115]
  v_mfma_f32_16x16x32_bf16 v[116:119], v[144:147], v[176:179], v[116:119]
  v_mfma_f32_16x16x32_bf16 v[120:123], v[148:151], v[176:179], v[120:123]
  v_mfma_f32_16x16x32_bf16 v[124:127], v[152:155], v[176:179], v[124:127]
  v_mfma_f32_16x16x32_bf16 v[128:131], v[156:159], v[176:179], v[128:131]
  v_mfma_f32_16x16x32_bf16 v[132:135], v[160:163], v[176:179], v[132:135]
  s_waitcnt lgkmcnt(0)
  s_barrier
  v_mfma_f32_16x16x32_bf16 v[24:27], v[180:183], v[208:211], v[24:27]
  ds_read_b128 v[164:167], v224 offset:32768
  v_mfma_f32_16x16x32_bf16 v[28:31], v[184:187], v[208:211], v[28:31]
  ds_read_b64_tr_b16 v[136:137], v234 offset:0
  v_mfma_f32_16x16x32_bf16 v[32:35], v[188:191], v[208:211], v[32:35]
  ds_read_b64_tr_b16 v[138:139], v234 offset:1792
  v_mfma_f32_16x16x32_bf16 v[36:39], v[192:195], v[208:211], v[36:39]
  ds_read_b64_tr_b16 v[140:141], v235 offset:32
  v_mfma_f32_16x16x32_bf16 v[40:43], v[196:199], v[208:211], v[40:43]
  ds_read_b64_tr_b16 v[142:143], v235 offset:1824
  v_mfma_f32_16x16x32_bf16 v[44:47], v[200:203], v[208:211], v[44:47]
  ds_read_b64_tr_b16 v[144:145], v234 offset:64
  v_mfma_f32_16x16x32_bf16 v[48:51], v[204:207], v[208:211], v[48:51]
  ds_read_b64_tr_b16 v[146:147], v234 offset:1856
  v_mfma_f32_16x16x32_bf16 v[52:55], v[180:183], v[212:215], v[52:55]
  ds_read_b64_tr_b16 v[148:149], v235 offset:96
  v_mfma_f32_16x16x32_bf16 v[56:59], v[184:187], v[212:215], v[56:59]
  ds_read_b64_tr_b16 v[150:151], v235 offset:1888
  v_mfma_f32_16x16x32_bf16 v[60:63], v[188:191], v[212:215], v[60:63]
  ds_read_b64_tr_b16 v[152:153], v234 offset:128
  v_mfma_f32_16x16x32_bf16 v[64:67], v[192:195], v[212:215], v[64:67]
  ds_read_b64_tr_b16 v[154:155], v234 offset:1920
  v_mfma_f32_16x16x32_bf16 v[68:71], v[196:199], v[212:215], v[68:71]
  ds_read_b64_tr_b16 v[156:157], v235 offset:160
  v_mfma_f32_16x16x32_bf16 v[72:75], v[200:203], v[212:215], v[72:75]
  ds_read_b64_tr_b16 v[158:159], v235 offset:1952
  v_mfma_f32_16x16x32_bf16 v[76:79], v[204:207], v[212:215], v[76:79]
  ds_read_b64_tr_b16 v[160:161], v236 offset:0
  v_mfma_f32_16x16x32_bf16 v[80:83], v[180:183], v[216:219], v[80:83]
  ds_read_b64_tr_b16 v[162:163], v236 offset:1792
  v_mfma_f32_16x16x32_bf16 v[84:87], v[184:187], v[216:219], v[84:87]
  ds_read_b128 v[168:171], v224 offset:34816
  v_mfma_f32_16x16x32_bf16 v[88:91], v[188:191], v[216:219], v[88:91]
  ds_read_b128 v[172:175], v224 offset:36864
  v_mfma_f32_16x16x32_bf16 v[92:95], v[192:195], v[216:219], v[92:95]
  ds_read_b128 v[176:179], v224 offset:38912
  v_mfma_f32_16x16x32_bf16 v[96:99], v[196:199], v[216:219], v[96:99]
  v_mfma_f32_16x16x32_bf16 v[100:103], v[200:203], v[216:219], v[100:103]
  v_mfma_f32_16x16x32_bf16 v[104:107], v[204:207], v[216:219], v[104:107]
  v_mfma_f32_16x16x32_bf16 v[108:111], v[180:183], v[220:223], v[108:111]
  v_mfma_f32_16x16x32_bf16 v[112:115], v[184:187], v[220:223], v[112:115]
  v_mfma_f32_16x16x32_bf16 v[116:119], v[188:191], v[220:223], v[116:119]
  v_mfma_f32_16x16x32_bf16 v[120:123], v[192:195], v[220:223], v[120:123]
  v_mfma_f32_16x16x32_bf16 v[124:127], v[196:199], v[220:223], v[124:127]
  v_mfma_f32_16x16x32_bf16 v[128:131], v[200:203], v[220:223], v[128:131]
  v_mfma_f32_16x16x32_bf16 v[132:135], v[204:207], v[220:223], v[132:135]
  s_waitcnt lgkmcnt(0)
  v_mfma_f32_16x16x32_bf16 v[24:27], v[136:139], v[164:167], v[24:27]
  ds_read_b128 v[208:211], v225 offset:32768
  v_mfma_f32_16x16x32_bf16 v[28:31], v[140:143], v[164:167], v[28:31]
  ds_read_b64_tr_b16 v[180:181], v234 offset:14336
  v_mfma_f32_16x16x32_bf16 v[32:35], v[144:147], v[164:167], v[32:35]
  ds_read_b64_tr_b16 v[182:183], v234 offset:16128
  v_mfma_f32_16x16x32_bf16 v[36:39], v[148:151], v[164:167], v[36:39]
  ds_read_b64_tr_b16 v[184:185], v235 offset:14368
  v_mfma_f32_16x16x32_bf16 v[40:43], v[152:155], v[164:167], v[40:43]
  ds_read_b64_tr_b16 v[186:187], v235 offset:16160
  v_mfma_f32_16x16x32_bf16 v[44:47], v[156:159], v[164:167], v[44:47]
  ds_read_b64_tr_b16 v[188:189], v234 offset:14400
  v_mfma_f32_16x16x32_bf16 v[48:51], v[160:163], v[164:167], v[48:51]
  ds_read_b64_tr_b16 v[190:191], v234 offset:16192
  v_mfma_f32_16x16x32_bf16 v[52:55], v[136:139], v[168:171], v[52:55]
  ds_read_b64_tr_b16 v[192:193], v235 offset:14432
  v_mfma_f32_16x16x32_bf16 v[56:59], v[140:143], v[168:171], v[56:59]
  ds_read_b64_tr_b16 v[194:195], v235 offset:16224
  v_mfma_f32_16x16x32_bf16 v[60:63], v[144:147], v[168:171], v[60:63]
  ds_read_b64_tr_b16 v[196:197], v234 offset:14464
  v_mfma_f32_16x16x32_bf16 v[64:67], v[148:151], v[168:171], v[64:67]
  ds_read_b64_tr_b16 v[198:199], v234 offset:16256
  v_mfma_f32_16x16x32_bf16 v[68:71], v[152:155], v[168:171], v[68:71]
  ds_read_b64_tr_b16 v[200:201], v235 offset:14496
  v_mfma_f32_16x16x32_bf16 v[72:75], v[156:159], v[168:171], v[72:75]
  ds_read_b64_tr_b16 v[202:203], v235 offset:16288
  v_mfma_f32_16x16x32_bf16 v[76:79], v[160:163], v[168:171], v[76:79]
  ds_read_b64_tr_b16 v[204:205], v236 offset:14336
  v_mfma_f32_16x16x32_bf16 v[80:83], v[136:139], v[172:175], v[80:83]
  ds_read_b64_tr_b16 v[206:207], v236 offset:16128
  v_mfma_f32_16x16x32_bf16 v[84:87], v[140:143], v[172:175], v[84:87]
  ds_read_b128 v[212:215], v225 offset:34816
  v_mfma_f32_16x16x32_bf16 v[88:91], v[144:147], v[172:175], v[88:91]
  ds_read_b128 v[216:219], v225 offset:36864
  v_mfma_f32_16x16x32_bf16 v[92:95], v[148:151], v[172:175], v[92:95]
  ds_read_b128 v[220:223], v225 offset:38912
  v_mfma_f32_16x16x32_bf16 v[96:99], v[152:155], v[172:175], v[96:99]
  v_mfma_f32_16x16x32_bf16 v[100:103], v[156:159], v[172:175], v[100:103]
  v_mfma_f32_16x16x32_bf16 v[104:107], v[160:163], v[172:175], v[104:107]
  v_mfma_f32_16x16x32_bf16 v[108:111], v[136:139], v[176:179], v[108:111]
  v_mfma_f32_16x16x32_bf16 v[112:115], v[140:143], v[176:179], v[112:115]
  v_mfma_f32_16x16x32_bf16 v[116:119], v[144:147], v[176:179], v[116:119]
  v_mfma_f32_16x16x32_bf16 v[120:123], v[148:151], v[176:179], v[120:123]
  v_mfma_f32_16x16x32_bf16 v[124:127], v[152:155], v[176:179], v[124:127]
  v_mfma_f32_16x16x32_bf16 v[128:131], v[156:159], v[176:179], v[128:131]
  v_mfma_f32_16x16x32_bf16 v[132:135], v[160:163], v[176:179], v[132:135]
  s_waitcnt lgkmcnt(0)
  s_barrier
  v_mfma_f32_16x16x32_bf16 v[24:27], v[180:183], v[208:211], v[24:27]
  ds_read_b128 v[164:167], v224 offset:0
  v_mfma_f32_16x16x32_bf16 v[28:31], v[184:187], v[208:211], v[28:31]
  ds_read_b64_tr_b16 v[136:137], v228 offset:0
  v_mfma_f32_16x16x32_bf16 v[32:35], v[188:191], v[208:211], v[32:35]
  ds_read_b64_tr_b16 v[138:139], v228 offset:1792
  v_mfma_f32_16x16x32_bf16 v[36:39], v[192:195], v[208:211], v[36:39]
  ds_read_b64_tr_b16 v[140:141], v229 offset:32
  v_mfma_f32_16x16x32_bf16 v[40:43], v[196:199], v[208:211], v[40:43]
  ds_read_b64_tr_b16 v[142:143], v229 offset:1824
  v_mfma_f32_16x16x32_bf16 v[44:47], v[200:203], v[208:211], v[44:47]
  ds_read_b64_tr_b16 v[144:145], v228 offset:64
  v_mfma_f32_16x16x32_bf16 v[48:51], v[204:207], v[208:211], v[48:51]
  ds_read_b64_tr_b16 v[146:147], v228 offset:1856
  v_mfma_f32_16x16x32_bf16 v[52:55], v[180:183], v[212:215], v[52:55]
  ds_read_b64_tr_b16 v[148:149], v229 offset:96
  v_mfma_f32_16x16x32_bf16 v[56:59], v[184:187], v[212:215], v[56:59]
  ds_read_b64_tr_b16 v[150:151], v229 offset:1888
  v_mfma_f32_16x16x32_bf16 v[60:63], v[188:191], v[212:215], v[60:63]
  ds_read_b64_tr_b16 v[152:153], v228 offset:128
  v_mfma_f32_16x16x32_bf16 v[64:67], v[192:195], v[212:215], v[64:67]
  ds_read_b64_tr_b16 v[154:155], v228 offset:1920
  v_mfma_f32_16x16x32_bf16 v[68:71], v[196:199], v[212:215], v[68:71]
  ds_read_b64_tr_b16 v[156:157], v229 offset:160
  v_mfma_f32_16x16x32_bf16 v[72:75], v[200:203], v[212:215], v[72:75]
  ds_read_b64_tr_b16 v[158:159], v229 offset:1952
  v_mfma_f32_16x16x32_bf16 v[76:79], v[204:207], v[212:215], v[76:79]
  ds_read_b64_tr_b16 v[160:161], v230 offset:0
  v_mfma_f32_16x16x32_bf16 v[80:83], v[180:183], v[216:219], v[80:83]
  ds_read_b64_tr_b16 v[162:163], v230 offset:1792
  v_mfma_f32_16x16x32_bf16 v[84:87], v[184:187], v[216:219], v[84:87]
  ds_read_b128 v[168:171], v224 offset:2048
  v_mfma_f32_16x16x32_bf16 v[88:91], v[188:191], v[216:219], v[88:91]
  ds_read_b128 v[172:175], v224 offset:4096
  v_mfma_f32_16x16x32_bf16 v[92:95], v[192:195], v[216:219], v[92:95]
  ds_read_b128 v[176:179], v224 offset:6144
  v_mfma_f32_16x16x32_bf16 v[96:99], v[196:199], v[216:219], v[96:99]
  v_mfma_f32_16x16x32_bf16 v[100:103], v[200:203], v[216:219], v[100:103]
  v_mfma_f32_16x16x32_bf16 v[104:107], v[204:207], v[216:219], v[104:107]
  v_mfma_f32_16x16x32_bf16 v[108:111], v[180:183], v[220:223], v[108:111]
  v_mfma_f32_16x16x32_bf16 v[112:115], v[184:187], v[220:223], v[112:115]
  v_mfma_f32_16x16x32_bf16 v[116:119], v[188:191], v[220:223], v[116:119]
  v_mfma_f32_16x16x32_bf16 v[120:123], v[192:195], v[220:223], v[120:123]
  v_mfma_f32_16x16x32_bf16 v[124:127], v[196:199], v[220:223], v[124:127]
  v_mfma_f32_16x16x32_bf16 v[128:131], v[200:203], v[220:223], v[128:131]
  v_mfma_f32_16x16x32_bf16 v[132:135], v[204:207], v[220:223], v[132:135]
  s_waitcnt lgkmcnt(0)
  v_mfma_f32_16x16x32_bf16 v[24:27], v[136:139], v[164:167], v[24:27]
  ds_read_b128 v[208:211], v225 offset:0
  v_mfma_f32_16x16x32_bf16 v[28:31], v[140:143], v[164:167], v[28:31]
  ds_read_b64_tr_b16 v[180:181], v228 offset:14336
  v_mfma_f32_16x16x32_bf16 v[32:35], v[144:147], v[164:167], v[32:35]
  ds_read_b64_tr_b16 v[182:183], v228 offset:16128
  v_mfma_f32_16x16x32_bf16 v[36:39], v[148:151], v[164:167], v[36:39]
  ds_read_b64_tr_b16 v[184:185], v229 offset:14368
  v_mfma_f32_16x16x32_bf16 v[40:43], v[152:155], v[164:167], v[40:43]
  ds_read_b64_tr_b16 v[186:187], v229 offset:16160
  v_mfma_f32_16x16x32_bf16 v[44:47], v[156:159], v[164:167], v[44:47]
  ds_read_b64_tr_b16 v[188:189], v228 offset:14400
  v_mfma_f32_16x16x32_bf16 v[48:51], v[160:163], v[164:167], v[48:51]
  ds_read_b64_tr_b16 v[190:191], v228 offset:16192
  v_mfma_f32_16x16x32_bf16 v[52:55], v[136:139], v[168:171], v[52:55]
  ds_read_b64_tr_b16 v[192:193], v229 offset:14432
  v_mfma_f32_16x16x32_bf16 v[56:59], v[140:143], v[168:171], v[56:59]
  ds_read_b64_tr_b16 v[194:195], v229 offset:16224
  v_mfma_f32_16x16x32_bf16 v[60:63], v[144:147], v[168:171], v[60:63]
  ds_read_b64_tr_b16 v[196:197], v228 offset:14464
  v_mfma_f32_16x16x32_bf16 v[64:67], v[148:151], v[168:171], v[64:67]
  ds_read_b64_tr_b16 v[198:199], v228 offset:16256
  v_mfma_f32_16x16x32_bf16 v[68:71], v[152:155], v[168:171], v[68:71]
  ds_read_b64_tr_b16 v[200:201], v229 offset:14496
  v_mfma_f32_16x16x32_bf16 v[72:75], v[156:159], v[168:171], v[72:75]
  ds_read_b64_tr_b16 v[202:203], v229 offset:16288
  v_mfma_f32_16x16x32_bf16 v[76:79], v[160:163], v[168:171], v[76:79]
  ds_read_b64_tr_b16 v[204:205], v230 offset:14336
  v_mfma_f32_16x16x32_bf16 v[80:83], v[136:139], v[172:175], v[80:83]
  ds_read_b64_tr_b16 v[206:207], v230 offset:16128
  v_mfma_f32_16x16x32_bf16 v[84:87], v[140:143], v[172:175], v[84:87]
  ds_read_b128 v[212:215], v225 offset:2048
  v_mfma_f32_16x16x32_bf16 v[88:91], v[144:147], v[172:175], v[88:91]
  ds_read_b128 v[216:219], v225 offset:4096
  v_mfma_f32_16x16x32_bf16 v[92:95], v[148:151], v[172:175], v[92:95]
  ds_read_b128 v[220:223], v225 offset:6144
  v_mfma_f32_16x16x32_bf16 v[96:99], v[152:155], v[172:175], v[96:99]
  v_mfma_f32_16x16x32_bf16 v[100:103], v[156:159], v[172:175], v[100:103]
  v_mfma_f32_16x16x32_bf16 v[104:107], v[160:163], v[172:175], v[104:107]
  v_mfma_f32_16x16x32_bf16 v[108:111], v[136:139], v[176:179], v[108:111]
  v_mfma_f32_16x16x32_bf16 v[112:115], v[140:143], v[176:179], v[112:115]
  v_mfma_f32_16x16x32_bf16 v[116:119], v[144:147], v[176:179], v[116:119]
  v_mfma_f32_16x16x32_bf16 v[120:123], v[148:151], v[176:179], v[120:123]
  v_mfma_f32_16x16x32_bf16 v[124:127], v[152:155], v[176:179], v[124:127]
  v_mfma_f32_16x16x32_bf16 v[128:131], v[156:159], v[176:179], v[128:131]
  v_mfma_f32_16x16x32_bf16 v[132:135], v[160:163], v[176:179], v[132:135]
  s_waitcnt lgkmcnt(0)
  s_barrier
  v_mfma_f32_16x16x32_bf16 v[24:27], v[180:183], v[208:211], v[24:27]
  ds_read_b128 v[164:167], v224 offset:16384
  v_mfma_f32_16x16x32_bf16 v[28:31], v[184:187], v[208:211], v[28:31]
  ds_read_b64_tr_b16 v[136:137], v231 offset:0
  v_mfma_f32_16x16x32_bf16 v[32:35], v[188:191], v[208:211], v[32:35]
  ds_read_b64_tr_b16 v[138:139], v231 offset:1792
  v_mfma_f32_16x16x32_bf16 v[36:39], v[192:195], v[208:211], v[36:39]
  ds_read_b64_tr_b16 v[140:141], v232 offset:32
  v_mfma_f32_16x16x32_bf16 v[40:43], v[196:199], v[208:211], v[40:43]
  ds_read_b64_tr_b16 v[142:143], v232 offset:1824
  v_mfma_f32_16x16x32_bf16 v[44:47], v[200:203], v[208:211], v[44:47]
  ds_read_b64_tr_b16 v[144:145], v231 offset:64
  v_mfma_f32_16x16x32_bf16 v[48:51], v[204:207], v[208:211], v[48:51]
  ds_read_b64_tr_b16 v[146:147], v231 offset:1856
  v_mfma_f32_16x16x32_bf16 v[52:55], v[180:183], v[212:215], v[52:55]
  ds_read_b64_tr_b16 v[148:149], v232 offset:96
  v_mfma_f32_16x16x32_bf16 v[56:59], v[184:187], v[212:215], v[56:59]
  ds_read_b64_tr_b16 v[150:151], v232 offset:1888
  v_mfma_f32_16x16x32_bf16 v[60:63], v[188:191], v[212:215], v[60:63]
  ds_read_b64_tr_b16 v[152:153], v231 offset:128
  v_mfma_f32_16x16x32_bf16 v[64:67], v[192:195], v[212:215], v[64:67]
  ds_read_b64_tr_b16 v[154:155], v231 offset:1920
  v_mfma_f32_16x16x32_bf16 v[68:71], v[196:199], v[212:215], v[68:71]
  ds_read_b64_tr_b16 v[156:157], v232 offset:160
  v_mfma_f32_16x16x32_bf16 v[72:75], v[200:203], v[212:215], v[72:75]
  ds_read_b64_tr_b16 v[158:159], v232 offset:1952
  v_mfma_f32_16x16x32_bf16 v[76:79], v[204:207], v[212:215], v[76:79]
  ds_read_b64_tr_b16 v[160:161], v233 offset:0
  v_mfma_f32_16x16x32_bf16 v[80:83], v[180:183], v[216:219], v[80:83]
  ds_read_b64_tr_b16 v[162:163], v233 offset:1792
  v_mfma_f32_16x16x32_bf16 v[84:87], v[184:187], v[216:219], v[84:87]
  ds_read_b128 v[168:171], v224 offset:18432
  v_mfma_f32_16x16x32_bf16 v[88:91], v[188:191], v[216:219], v[88:91]
  ds_read_b128 v[172:175], v224 offset:20480
  v_mfma_f32_16x16x32_bf16 v[92:95], v[192:195], v[216:219], v[92:95]
  ds_read_b128 v[176:179], v224 offset:22528
  v_mfma_f32_16x16x32_bf16 v[96:99], v[196:199], v[216:219], v[96:99]
  v_mfma_f32_16x16x32_bf16 v[100:103], v[200:203], v[216:219], v[100:103]
  v_mfma_f32_16x16x32_bf16 v[104:107], v[204:207], v[216:219], v[104:107]
  v_mfma_f32_16x16x32_bf16 v[108:111], v[180:183], v[220:223], v[108:111]
  v_mfma_f32_16x16x32_bf16 v[112:115], v[184:187], v[220:223], v[112:115]
  v_mfma_f32_16x16x32_bf16 v[116:119], v[188:191], v[220:223], v[116:119]
  v_mfma_f32_16x16x32_bf16 v[120:123], v[192:195], v[220:223], v[120:123]
  v_mfma_f32_16x16x32_bf16 v[124:127], v[196:199], v[220:223], v[124:127]
  v_mfma_f32_16x16x32_bf16 v[128:131], v[200:203], v[220:223], v[128:131]
  v_mfma_f32_16x16x32_bf16 v[132:135], v[204:207], v[220:223], v[132:135]
  s_waitcnt lgkmcnt(0)
  v_mfma_f32_16x16x32_bf16 v[24:27], v[136:139], v[164:167], v[24:27]
  ds_read_b128 v[208:211], v225 offset:16384
  v_mfma_f32_16x16x32_bf16 v[28:31], v[140:143], v[164:167], v[28:31]
  ds_read_b64_tr_b16 v[180:181], v231 offset:14336
  v_mfma_f32_16x16x32_bf16 v[32:35], v[144:147], v[164:167], v[32:35]
  ds_read_b64_tr_b16 v[182:183], v231 offset:16128
  v_mfma_f32_16x16x32_bf16 v[36:39], v[148:151], v[164:167], v[36:39]
  ds_read_b64_tr_b16 v[184:185], v232 offset:14368
  v_mfma_f32_16x16x32_bf16 v[40:43], v[152:155], v[164:167], v[40:43]
  ds_read_b64_tr_b16 v[186:187], v232 offset:16160
  v_mfma_f32_16x16x32_bf16 v[44:47], v[156:159], v[164:167], v[44:47]
  ds_read_b64_tr_b16 v[188:189], v231 offset:14400
  v_mfma_f32_16x16x32_bf16 v[48:51], v[160:163], v[164:167], v[48:51]
  ds_read_b64_tr_b16 v[190:191], v231 offset:16192
  v_mfma_f32_16x16x32_bf16 v[52:55], v[136:139], v[168:171], v[52:55]
  ds_read_b64_tr_b16 v[192:193], v232 offset:14432
  v_mfma_f32_16x16x32_bf16 v[56:59], v[140:143], v[168:171], v[56:59]
  ds_read_b64_tr_b16 v[194:195], v232 offset:16224
  v_mfma_f32_16x16x32_bf16 v[60:63], v[144:147], v[168:171], v[60:63]
  ds_read_b64_tr_b16 v[196:197], v231 offset:14464
  v_mfma_f32_16x16x32_bf16 v[64:67], v[148:151], v[168:171], v[64:67]
  ds_read_b64_tr_b16 v[198:199], v231 offset:16256
  v_mfma_f32_16x16x32_bf16 v[68:71], v[152:155], v[168:171], v[68:71]
  ds_read_b64_tr_b16 v[200:201], v232 offset:14496
  v_mfma_f32_16x16x32_bf16 v[72:75], v[156:159], v[168:171], v[72:75]
  ds_read_b64_tr_b16 v[202:203], v232 offset:16288
  v_mfma_f32_16x16x32_bf16 v[76:79], v[160:163], v[168:171], v[76:79]
  ds_read_b64_tr_b16 v[204:205], v233 offset:14336
  v_mfma_f32_16x16x32_bf16 v[80:83], v[136:139], v[172:175], v[80:83]
  ds_read_b64_tr_b16 v[206:207], v233 offset:16128
  v_mfma_f32_16x16x32_bf16 v[84:87], v[140:143], v[172:175], v[84:87]
  ds_read_b128 v[212:215], v225 offset:18432
  v_mfma_f32_16x16x32_bf16 v[88:91], v[144:147], v[172:175], v[88:91]
  ds_read_b128 v[216:219], v225 offset:20480
  v_mfma_f32_16x16x32_bf16 v[92:95], v[148:151], v[172:175], v[92:95]
  ds_read_b128 v[220:223], v225 offset:22528
  v_mfma_f32_16x16x32_bf16 v[96:99], v[152:155], v[172:175], v[96:99]
  v_mfma_f32_16x16x32_bf16 v[100:103], v[156:159], v[172:175], v[100:103]
  v_mfma_f32_16x16x32_bf16 v[104:107], v[160:163], v[172:175], v[104:107]
  v_mfma_f32_16x16x32_bf16 v[108:111], v[136:139], v[176:179], v[108:111]
  v_mfma_f32_16x16x32_bf16 v[112:115], v[140:143], v[176:179], v[112:115]
  v_mfma_f32_16x16x32_bf16 v[116:119], v[144:147], v[176:179], v[116:119]
  v_mfma_f32_16x16x32_bf16 v[120:123], v[148:151], v[176:179], v[120:123]
  v_mfma_f32_16x16x32_bf16 v[124:127], v[152:155], v[176:179], v[124:127]
  v_mfma_f32_16x16x32_bf16 v[128:131], v[156:159], v[176:179], v[128:131]
  v_mfma_f32_16x16x32_bf16 v[132:135], v[160:163], v[176:179], v[132:135]
  s_waitcnt lgkmcnt(0)
  s_barrier
  v_mfma_f32_16x16x32_bf16 v[24:27], v[180:183], v[208:211], v[24:27]
  ds_read_b128 v[164:167], v224 offset:32768
  v_mfma_f32_16x16x32_bf16 v[28:31], v[184:187], v[208:211], v[28:31]
  ds_read_b64_tr_b16 v[136:137], v234 offset:0
  v_mfma_f32_16x16x32_bf16 v[32:35], v[188:191], v[208:211], v[32:35]
  ds_read_b64_tr_b16 v[138:139], v234 offset:1792
  v_mfma_f32_16x16x32_bf16 v[36:39], v[192:195], v[208:211], v[36:39]
  ds_read_b64_tr_b16 v[140:141], v235 offset:32
  v_mfma_f32_16x16x32_bf16 v[40:43], v[196:199], v[208:211], v[40:43]
  ds_read_b64_tr_b16 v[142:143], v235 offset:1824
  v_mfma_f32_16x16x32_bf16 v[44:47], v[200:203], v[208:211], v[44:47]
  ds_read_b64_tr_b16 v[144:145], v234 offset:64
  v_mfma_f32_16x16x32_bf16 v[48:51], v[204:207], v[208:211], v[48:51]
  ds_read_b64_tr_b16 v[146:147], v234 offset:1856
  v_mfma_f32_16x16x32_bf16 v[52:55], v[180:183], v[212:215], v[52:55]
  ds_read_b64_tr_b16 v[148:149], v235 offset:96
  v_mfma_f32_16x16x32_bf16 v[56:59], v[184:187], v[212:215], v[56:59]
  ds_read_b64_tr_b16 v[150:151], v235 offset:1888
  v_mfma_f32_16x16x32_bf16 v[60:63], v[188:191], v[212:215], v[60:63]
  ds_read_b64_tr_b16 v[152:153], v234 offset:128
  v_mfma_f32_16x16x32_bf16 v[64:67], v[192:195], v[212:215], v[64:67]
  ds_read_b64_tr_b16 v[154:155], v234 offset:1920
  v_mfma_f32_16x16x32_bf16 v[68:71], v[196:199], v[212:215], v[68:71]
  ds_read_b64_tr_b16 v[156:157], v235 offset:160
  v_mfma_f32_16x16x32_bf16 v[72:75], v[200:203], v[212:215], v[72:75]
  ds_read_b64_tr_b16 v[158:159], v235 offset:1952
  v_mfma_f32_16x16x32_bf16 v[76:79], v[204:207], v[212:215], v[76:79]
  ds_read_b64_tr_b16 v[160:161], v236 offset:0
  v_mfma_f32_16x16x32_bf16 v[80:83], v[180:183], v[216:219], v[80:83]
  ds_read_b64_tr_b16 v[162:163], v236 offset:1792
  v_mfma_f32_16x16x32_bf16 v[84:87], v[184:187], v[216:219], v[84:87]
  ds_read_b128 v[168:171], v224 offset:34816
  v_mfma_f32_16x16x32_bf16 v[88:91], v[188:191], v[216:219], v[88:91]
  ds_read_b128 v[172:175], v224 offset:36864
  v_mfma_f32_16x16x32_bf16 v[92:95], v[192:195], v[216:219], v[92:95]
  ds_read_b128 v[176:179], v224 offset:38912
  v_mfma_f32_16x16x32_bf16 v[96:99], v[196:199], v[216:219], v[96:99]
  v_mfma_f32_16x16x32_bf16 v[100:103], v[200:203], v[216:219], v[100:103]
  v_mfma_f32_16x16x32_bf16 v[104:107], v[204:207], v[216:219], v[104:107]
  v_mfma_f32_16x16x32_bf16 v[108:111], v[180:183], v[220:223], v[108:111]
  v_mfma_f32_16x16x32_bf16 v[112:115], v[184:187], v[220:223], v[112:115]
  v_mfma_f32_16x16x32_bf16 v[116:119], v[188:191], v[220:223], v[116:119]
  v_mfma_f32_16x16x32_bf16 v[120:123], v[192:195], v[220:223], v[120:123]
  v_mfma_f32_16x16x32_bf16 v[124:127], v[196:199], v[220:223], v[124:127]
  v_mfma_f32_16x16x32_bf16 v[128:131], v[200:203], v[220:223], v[128:131]
  v_mfma_f32_16x16x32_bf16 v[132:135], v[204:207], v[220:223], v[132:135]
  s_waitcnt lgkmcnt(0)
  v_mfma_f32_16x16x32_bf16 v[24:27], v[136:139], v[164:167], v[24:27]
  ds_read_b128 v[208:211], v225 offset:32768
  v_mfma_f32_16x16x32_bf16 v[28:31], v[140:143], v[164:167], v[28:31]
  ds_read_b64_tr_b16 v[180:181], v234 offset:14336
  v_mfma_f32_16x16x32_bf16 v[32:35], v[144:147], v[164:167], v[32:35]
  ds_read_b64_tr_b16 v[182:183], v234 offset:16128
  v_mfma_f32_16x16x32_bf16 v[36:39], v[148:151], v[164:167], v[36:39]
  ds_read_b64_tr_b16 v[184:185], v235 offset:14368
  v_mfma_f32_16x16x32_bf16 v[40:43], v[152:155], v[164:167], v[40:43]
  ds_read_b64_tr_b16 v[186:187], v235 offset:16160
  v_mfma_f32_16x16x32_bf16 v[44:47], v[156:159], v[164:167], v[44:47]
  ds_read_b64_tr_b16 v[188:189], v234 offset:14400
  v_mfma_f32_16x16x32_bf16 v[48:51], v[160:163], v[164:167], v[48:51]
  ds_read_b64_tr_b16 v[190:191], v234 offset:16192
  v_mfma_f32_16x16x32_bf16 v[52:55], v[136:139], v[168:171], v[52:55]
  ds_read_b64_tr_b16 v[192:193], v235 offset:14432
  v_mfma_f32_16x16x32_bf16 v[56:59], v[140:143], v[168:171], v[56:59]
  ds_read_b64_tr_b16 v[194:195], v235 offset:16224
  v_mfma_f32_16x16x32_bf16 v[60:63], v[144:147], v[168:171], v[60:63]
  ds_read_b64_tr_b16 v[196:197], v234 offset:14464
  v_mfma_f32_16x16x32_bf16 v[64:67], v[148:151], v[168:171], v[64:67]
  ds_read_b64_tr_b16 v[198:199], v234 offset:16256
  v_mfma_f32_16x16x32_bf16 v[68:71], v[152:155], v[168:171], v[68:71]
  ds_read_b64_tr_b16 v[200:201], v235 offset:14496
  v_mfma_f32_16x16x32_bf16 v[72:75], v[156:159], v[168:171], v[72:75]
  ds_read_b64_tr_b16 v[202:203], v235 offset:16288
  v_mfma_f32_16x16x32_bf16 v[76:79], v[160:163], v[168:171], v[76:79]
  ds_read_b64_tr_b16 v[204:205], v236 offset:14336
  v_mfma_f32_16x16x32_bf16 v[80:83], v[136:139], v[172:175], v[80:83]
  ds_read_b64_tr_b16 v[206:207], v236 offset:16128
  v_mfma_f32_16x16x32_bf16 v[84:87], v[140:143], v[172:175], v[84:87]
  ds_read_b128 v[212:215], v225 offset:34816
  v_mfma_f32_16x16x32_bf16 v[88:91], v[144:147], v[172:175], v[88:91]
  ds_read_b128 v[216:219], v225 offset:36864
  v_mfma_f32_16x16x32_bf16 v[92:95], v[148:151], v[172:175], v[92:95]
  ds_read_b128 v[220:223], v225 offset:38912
  v_mfma_f32_16x16x32_bf16 v[96:99], v[152:155], v[172:175], v[96:99]
  v_mfma_f32_16x16x32_bf16 v[100:103], v[156:159], v[172:175], v[100:103]
  v_mfma_f32_16x16x32_bf16 v[104:107], v[160:163], v[172:175], v[104:107]
  v_mfma_f32_16x16x32_bf16 v[108:111], v[136:139], v[176:179], v[108:111]
  v_mfma_f32_16x16x32_bf16 v[112:115], v[140:143], v[176:179], v[112:115]
  v_mfma_f32_16x16x32_bf16 v[116:119], v[144:147], v[176:179], v[116:119]
  v_mfma_f32_16x16x32_bf16 v[120:123], v[148:151], v[176:179], v[120:123]
  v_mfma_f32_16x16x32_bf16 v[124:127], v[152:155], v[176:179], v[124:127]
  v_mfma_f32_16x16x32_bf16 v[128:131], v[156:159], v[176:179], v[128:131]
  v_mfma_f32_16x16x32_bf16 v[132:135], v[160:163], v[176:179], v[132:135]
  s_waitcnt lgkmcnt(0)
  s_barrier
  v_mfma_f32_16x16x32_bf16 v[24:27], v[180:183], v[208:211], v[24:27]
  ds_read_b128 v[164:167], v224 offset:0
  v_mfma_f32_16x16x32_bf16 v[28:31], v[184:187], v[208:211], v[28:31]
  ds_read_b64_tr_b16 v[136:137], v228 offset:0
  v_mfma_f32_16x16x32_bf16 v[32:35], v[188:191], v[208:211], v[32:35]
  ds_read_b64_tr_b16 v[138:139], v228 offset:1792
  v_mfma_f32_16x16x32_bf16 v[36:39], v[192:195], v[208:211], v[36:39]
  ds_read_b64_tr_b16 v[140:141], v229 offset:32
  v_mfma_f32_16x16x32_bf16 v[40:43], v[196:199], v[208:211], v[40:43]
  ds_read_b64_tr_b16 v[142:143], v229 offset:1824
  v_mfma_f32_16x16x32_bf16 v[44:47], v[200:203], v[208:211], v[44:47]
  ds_read_b64_tr_b16 v[144:145], v228 offset:64
  v_mfma_f32_16x16x32_bf16 v[48:51], v[204:207], v[208:211], v[48:51]
  ds_read_b64_tr_b16 v[146:147], v228 offset:1856
  v_mfma_f32_16x16x32_bf16 v[52:55], v[180:183], v[212:215], v[52:55]
  ds_read_b64_tr_b16 v[148:149], v229 offset:96
  v_mfma_f32_16x16x32_bf16 v[56:59], v[184:187], v[212:215], v[56:59]
  ds_read_b64_tr_b16 v[150:151], v229 offset:1888
  v_mfma_f32_16x16x32_bf16 v[60:63], v[188:191], v[212:215], v[60:63]
  ds_read_b64_tr_b16 v[152:153], v228 offset:128
  v_mfma_f32_16x16x32_bf16 v[64:67], v[192:195], v[212:215], v[64:67]
  ds_read_b64_tr_b16 v[154:155], v228 offset:1920
  v_mfma_f32_16x16x32_bf16 v[68:71], v[196:199], v[212:215], v[68:71]
  ds_read_b64_tr_b16 v[156:157], v229 offset:160
  v_mfma_f32_16x16x32_bf16 v[72:75], v[200:203], v[212:215], v[72:75]
  ds_read_b64_tr_b16 v[158:159], v229 offset:1952
  v_mfma_f32_16x16x32_bf16 v[76:79], v[204:207], v[212:215], v[76:79]
  ds_read_b64_tr_b16 v[160:161], v230 offset:0
  v_mfma_f32_16x16x32_bf16 v[80:83], v[180:183], v[216:219], v[80:83]
  ds_read_b64_tr_b16 v[162:163], v230 offset:1792
  v_mfma_f32_16x16x32_bf16 v[84:87], v[184:187], v[216:219], v[84:87]
  ds_read_b128 v[168:171], v224 offset:2048
  v_mfma_f32_16x16x32_bf16 v[88:91], v[188:191], v[216:219], v[88:91]
  ds_read_b128 v[172:175], v224 offset:4096
  v_mfma_f32_16x16x32_bf16 v[92:95], v[192:195], v[216:219], v[92:95]
  ds_read_b128 v[176:179], v224 offset:6144
  v_mfma_f32_16x16x32_bf16 v[96:99], v[196:199], v[216:219], v[96:99]
  v_mfma_f32_16x16x32_bf16 v[100:103], v[200:203], v[216:219], v[100:103]
  v_mfma_f32_16x16x32_bf16 v[104:107], v[204:207], v[216:219], v[104:107]
  v_mfma_f32_16x16x32_bf16 v[108:111], v[180:183], v[220:223], v[108:111]
  v_mfma_f32_16x16x32_bf16 v[112:115], v[184:187], v[220:223], v[112:115]
  v_mfma_f32_16x16x32_bf16 v[116:119], v[188:191], v[220:223], v[116:119]
  v_mfma_f32_16x16x32_bf16 v[120:123], v[192:195], v[220:223], v[120:123]
  v_mfma_f32_16x16x32_bf16 v[124:127], v[196:199], v[220:223], v[124:127]
  v_mfma_f32_16x16x32_bf16 v[128:131], v[200:203], v[220:223], v[128:131]
  v_mfma_f32_16x16x32_bf16 v[132:135], v[204:207], v[220:223], v[132:135]
  s_waitcnt lgkmcnt(0)
  v_mfma_f32_16x16x32_bf16 v[24:27], v[136:139], v[164:167], v[24:27]
  ds_read_b128 v[208:211], v225 offset:0
  v_mfma_f32_16x16x32_bf16 v[28:31], v[140:143], v[164:167], v[28:31]
  ds_read_b64_tr_b16 v[180:181], v228 offset:14336
  v_mfma_f32_16x16x32_bf16 v[32:35], v[144:147], v[164:167], v[32:35]
  ds_read_b64_tr_b16 v[182:183], v228 offset:16128
  v_mfma_f32_16x16x32_bf16 v[36:39], v[148:151], v[164:167], v[36:39]
  ds_read_b64_tr_b16 v[184:185], v229 offset:14368
  v_mfma_f32_16x16x32_bf16 v[40:43], v[152:155], v[164:167], v[40:43]
  ds_read_b64_tr_b16 v[186:187], v229 offset:16160
  v_mfma_f32_16x16x32_bf16 v[44:47], v[156:159], v[164:167], v[44:47]
  ds_read_b64_tr_b16 v[188:189], v228 offset:14400
  v_mfma_f32_16x16x32_bf16 v[48:51], v[160:163], v[164:167], v[48:51]
  ds_read_b64_tr_b16 v[190:191], v228 offset:16192
  v_mfma_f32_16x16x32_bf16 v[52:55], v[136:139], v[168:171], v[52:55]
  ds_read_b64_tr_b16 v[192:193], v229 offset:14432
  v_mfma_f32_16x16x32_bf16 v[56:59], v[140:143], v[168:171], v[56:59]
  ds_read_b64_tr_b16 v[194:195], v229 offset:16224
  v_mfma_f32_16x16x32_bf16 v[60:63], v[144:147], v[168:171], v[60:63]
  ds_read_b64_tr_b16 v[196:197], v228 offset:14464
  v_mfma_f32_16x16x32_bf16 v[64:67], v[148:151], v[168:171], v[64:67]
  ds_read_b64_tr_b16 v[198:199], v228 offset:16256
  v_mfma_f32_16x16x32_bf16 v[68:71], v[152:155], v[168:171], v[68:71]
  ds_read_b64_tr_b16 v[200:201], v229 offset:14496
  v_mfma_f32_16x16x32_bf16 v[72:75], v[156:159], v[168:171], v[72:75]
  ds_read_b64_tr_b16 v[202:203], v229 offset:16288
  v_mfma_f32_16x16x32_bf16 v[76:79], v[160:163], v[168:171], v[76:79]
  ds_read_b64_tr_b16 v[204:205], v230 offset:14336
  v_mfma_f32_16x16x32_bf16 v[80:83], v[136:139], v[172:175], v[80:83]
  ds_read_b64_tr_b16 v[206:207], v230 offset:16128
  v_mfma_f32_16x16x32_bf16 v[84:87], v[140:143], v[172:175], v[84:87]
  ds_read_b128 v[212:215], v225 offset:2048
  v_mfma_f32_16x16x32_bf16 v[88:91], v[144:147], v[172:175], v[88:91]
  ds_read_b128 v[216:219], v225 offset:4096
  v_mfma_f32_16x16x32_bf16 v[92:95], v[148:151], v[172:175], v[92:95]
  ds_read_b128 v[220:223], v225 offset:6144
  v_mfma_f32_16x16x32_bf16 v[96:99], v[152:155], v[172:175], v[96:99]
  v_mfma_f32_16x16x32_bf16 v[100:103], v[156:159], v[172:175], v[100:103]
  v_mfma_f32_16x16x32_bf16 v[104:107], v[160:163], v[172:175], v[104:107]
  v_mfma_f32_16x16x32_bf16 v[108:111], v[136:139], v[176:179], v[108:111]
  v_mfma_f32_16x16x32_bf16 v[112:115], v[140:143], v[176:179], v[112:115]
  v_mfma_f32_16x16x32_bf16 v[116:119], v[144:147], v[176:179], v[116:119]
  v_mfma_f32_16x16x32_bf16 v[120:123], v[148:151], v[176:179], v[120:123]
  v_mfma_f32_16x16x32_bf16 v[124:127], v[152:155], v[176:179], v[124:127]
  v_mfma_f32_16x16x32_bf16 v[128:131], v[156:159], v[176:179], v[128:131]
  v_mfma_f32_16x16x32_bf16 v[132:135], v[160:163], v[176:179], v[132:135]
  s_waitcnt lgkmcnt(0)
  s_barrier
  v_mfma_f32_16x16x32_bf16 v[24:27], v[180:183], v[208:211], v[24:27]
  ds_read_b128 v[164:167], v224 offset:16384
  v_mfma_f32_16x16x32_bf16 v[28:31], v[184:187], v[208:211], v[28:31]
  ds_read_b64_tr_b16 v[136:137], v231 offset:0
  v_mfma_f32_16x16x32_bf16 v[32:35], v[188:191], v[208:211], v[32:35]
  ds_read_b64_tr_b16 v[138:139], v231 offset:1792
  v_mfma_f32_16x16x32_bf16 v[36:39], v[192:195], v[208:211], v[36:39]
  ds_read_b64_tr_b16 v[140:141], v232 offset:32
  v_mfma_f32_16x16x32_bf16 v[40:43], v[196:199], v[208:211], v[40:43]
  ds_read_b64_tr_b16 v[142:143], v232 offset:1824
  v_mfma_f32_16x16x32_bf16 v[44:47], v[200:203], v[208:211], v[44:47]
  ds_read_b64_tr_b16 v[144:145], v231 offset:64
  v_mfma_f32_16x16x32_bf16 v[48:51], v[204:207], v[208:211], v[48:51]
  ds_read_b64_tr_b16 v[146:147], v231 offset:1856
  v_mfma_f32_16x16x32_bf16 v[52:55], v[180:183], v[212:215], v[52:55]
  ds_read_b64_tr_b16 v[148:149], v232 offset:96
  v_mfma_f32_16x16x32_bf16 v[56:59], v[184:187], v[212:215], v[56:59]
  ds_read_b64_tr_b16 v[150:151], v232 offset:1888
  v_mfma_f32_16x16x32_bf16 v[60:63], v[188:191], v[212:215], v[60:63]
  ds_read_b64_tr_b16 v[152:153], v231 offset:128
  v_mfma_f32_16x16x32_bf16 v[64:67], v[192:195], v[212:215], v[64:67]
  ds_read_b64_tr_b16 v[154:155], v231 offset:1920
  v_mfma_f32_16x16x32_bf16 v[68:71], v[196:199], v[212:215], v[68:71]
  ds_read_b64_tr_b16 v[156:157], v232 offset:160
  v_mfma_f32_16x16x32_bf16 v[72:75], v[200:203], v[212:215], v[72:75]
  ds_read_b64_tr_b16 v[158:159], v232 offset:1952
  v_mfma_f32_16x16x32_bf16 v[76:79], v[204:207], v[212:215], v[76:79]
  ds_read_b64_tr_b16 v[160:161], v233 offset:0
  v_mfma_f32_16x16x32_bf16 v[80:83], v[180:183], v[216:219], v[80:83]
  ds_read_b64_tr_b16 v[162:163], v233 offset:1792
  v_mfma_f32_16x16x32_bf16 v[84:87], v[184:187], v[216:219], v[84:87]
  ds_read_b128 v[168:171], v224 offset:18432
  v_mfma_f32_16x16x32_bf16 v[88:91], v[188:191], v[216:219], v[88:91]
  ds_read_b128 v[172:175], v224 offset:20480
  v_mfma_f32_16x16x32_bf16 v[92:95], v[192:195], v[216:219], v[92:95]
  ds_read_b128 v[176:179], v224 offset:22528
  v_mfma_f32_16x16x32_bf16 v[96:99], v[196:199], v[216:219], v[96:99]
  v_mfma_f32_16x16x32_bf16 v[100:103], v[200:203], v[216:219], v[100:103]
  v_mfma_f32_16x16x32_bf16 v[104:107], v[204:207], v[216:219], v[104:107]
  v_mfma_f32_16x16x32_bf16 v[108:111], v[180:183], v[220:223], v[108:111]
  v_mfma_f32_16x16x32_bf16 v[112:115], v[184:187], v[220:223], v[112:115]
  v_mfma_f32_16x16x32_bf16 v[116:119], v[188:191], v[220:223], v[116:119]
  v_mfma_f32_16x16x32_bf16 v[120:123], v[192:195], v[220:223], v[120:123]
  v_mfma_f32_16x16x32_bf16 v[124:127], v[196:199], v[220:223], v[124:127]
  v_mfma_f32_16x16x32_bf16 v[128:131], v[200:203], v[220:223], v[128:131]
  v_mfma_f32_16x16x32_bf16 v[132:135], v[204:207], v[220:223], v[132:135]
  s_waitcnt lgkmcnt(0)
  v_mfma_f32_16x16x32_bf16 v[24:27], v[136:139], v[164:167], v[24:27]
  ds_read_b128 v[208:211], v225 offset:16384
  v_mfma_f32_16x16x32_bf16 v[28:31], v[140:143], v[164:167], v[28:31]
  ds_read_b64_tr_b16 v[180:181], v231 offset:14336
  v_mfma_f32_16x16x32_bf16 v[32:35], v[144:147], v[164:167], v[32:35]
  ds_read_b64_tr_b16 v[182:183], v231 offset:16128
  v_mfma_f32_16x16x32_bf16 v[36:39], v[148:151], v[164:167], v[36:39]
  ds_read_b64_tr_b16 v[184:185], v232 offset:14368
  v_mfma_f32_16x16x32_bf16 v[40:43], v[152:155], v[164:167], v[40:43]
  ds_read_b64_tr_b16 v[186:187], v232 offset:16160
  v_mfma_f32_16x16x32_bf16 v[44:47], v[156:159], v[164:167], v[44:47]
  ds_read_b64_tr_b16 v[188:189], v231 offset:14400
  v_mfma_f32_16x16x32_bf16 v[48:51], v[160:163], v[164:167], v[48:51]
  ds_read_b64_tr_b16 v[190:191], v231 offset:16192
  v_mfma_f32_16x16x32_bf16 v[52:55], v[136:139], v[168:171], v[52:55]
  ds_read_b64_tr_b16 v[192:193], v232 offset:14432
  v_mfma_f32_16x16x32_bf16 v[56:59], v[140:143], v[168:171], v[56:59]
  ds_read_b64_tr_b16 v[194:195], v232 offset:16224
  v_mfma_f32_16x16x32_bf16 v[60:63], v[144:147], v[168:171], v[60:63]
  ds_read_b64_tr_b16 v[196:197], v231 offset:14464
  v_mfma_f32_16x16x32_bf16 v[64:67], v[148:151], v[168:171], v[64:67]
  ds_read_b64_tr_b16 v[198:199], v231 offset:16256
  v_mfma_f32_16x16x32_bf16 v[68:71], v[152:155], v[168:171], v[68:71]
  ds_read_b64_tr_b16 v[200:201], v232 offset:14496
  v_mfma_f32_16x16x32_bf16 v[72:75], v[156:159], v[168:171], v[72:75]
  ds_read_b64_tr_b16 v[202:203], v232 offset:16288
  v_mfma_f32_16x16x32_bf16 v[76:79], v[160:163], v[168:171], v[76:79]
  ds_read_b64_tr_b16 v[204:205], v233 offset:14336
  v_mfma_f32_16x16x32_bf16 v[80:83], v[136:139], v[172:175], v[80:83]
  ds_read_b64_tr_b16 v[206:207], v233 offset:16128
  v_mfma_f32_16x16x32_bf16 v[84:87], v[140:143], v[172:175], v[84:87]
  ds_read_b128 v[212:215], v225 offset:18432
  v_mfma_f32_16x16x32_bf16 v[88:91], v[144:147], v[172:175], v[88:91]
  ds_read_b128 v[216:219], v225 offset:20480
  v_mfma_f32_16x16x32_bf16 v[92:95], v[148:151], v[172:175], v[92:95]
  ds_read_b128 v[220:223], v225 offset:22528
  v_mfma_f32_16x16x32_bf16 v[96:99], v[152:155], v[172:175], v[96:99]
  v_mfma_f32_16x16x32_bf16 v[100:103], v[156:159], v[172:175], v[100:103]
  v_mfma_f32_16x16x32_bf16 v[104:107], v[160:163], v[172:175], v[104:107]
  v_mfma_f32_16x16x32_bf16 v[108:111], v[136:139], v[176:179], v[108:111]
  v_mfma_f32_16x16x32_bf16 v[112:115], v[140:143], v[176:179], v[112:115]
  v_mfma_f32_16x16x32_bf16 v[116:119], v[144:147], v[176:179], v[116:119]
  v_mfma_f32_16x16x32_bf16 v[120:123], v[148:151], v[176:179], v[120:123]
  v_mfma_f32_16x16x32_bf16 v[124:127], v[152:155], v[176:179], v[124:127]
  v_mfma_f32_16x16x32_bf16 v[128:131], v[156:159], v[176:179], v[128:131]
  v_mfma_f32_16x16x32_bf16 v[132:135], v[160:163], v[176:179], v[132:135]
  s_waitcnt lgkmcnt(0)
  s_barrier
  v_mfma_f32_16x16x32_bf16 v[24:27], v[180:183], v[208:211], v[24:27]
  ds_read_b128 v[164:167], v224 offset:32768
  v_mfma_f32_16x16x32_bf16 v[28:31], v[184:187], v[208:211], v[28:31]
  ds_read_b64_tr_b16 v[136:137], v234 offset:0
  v_mfma_f32_16x16x32_bf16 v[32:35], v[188:191], v[208:211], v[32:35]
  ds_read_b64_tr_b16 v[138:139], v234 offset:1792
  v_mfma_f32_16x16x32_bf16 v[36:39], v[192:195], v[208:211], v[36:39]
  ds_read_b64_tr_b16 v[140:141], v235 offset:32
  v_mfma_f32_16x16x32_bf16 v[40:43], v[196:199], v[208:211], v[40:43]
  ds_read_b64_tr_b16 v[142:143], v235 offset:1824
  v_mfma_f32_16x16x32_bf16 v[44:47], v[200:203], v[208:211], v[44:47]
  ds_read_b64_tr_b16 v[144:145], v234 offset:64
  v_mfma_f32_16x16x32_bf16 v[48:51], v[204:207], v[208:211], v[48:51]
  ds_read_b64_tr_b16 v[146:147], v234 offset:1856
  v_mfma_f32_16x16x32_bf16 v[52:55], v[180:183], v[212:215], v[52:55]
  ds_read_b64_tr_b16 v[148:149], v235 offset:96
  v_mfma_f32_16x16x32_bf16 v[56:59], v[184:187], v[212:215], v[56:59]
  ds_read_b64_tr_b16 v[150:151], v235 offset:1888
  v_mfma_f32_16x16x32_bf16 v[60:63], v[188:191], v[212:215], v[60:63]
  ds_read_b64_tr_b16 v[152:153], v234 offset:128
  v_mfma_f32_16x16x32_bf16 v[64:67], v[192:195], v[212:215], v[64:67]
  ds_read_b64_tr_b16 v[154:155], v234 offset:1920
  v_mfma_f32_16x16x32_bf16 v[68:71], v[196:199], v[212:215], v[68:71]
  ds_read_b64_tr_b16 v[156:157], v235 offset:160
  v_mfma_f32_16x16x32_bf16 v[72:75], v[200:203], v[212:215], v[72:75]
  ds_read_b64_tr_b16 v[158:159], v235 offset:1952
  v_mfma_f32_16x16x32_bf16 v[76:79], v[204:207], v[212:215], v[76:79]
  ds_read_b64_tr_b16 v[160:161], v236 offset:0
  v_mfma_f32_16x16x32_bf16 v[80:83], v[180:183], v[216:219], v[80:83]
  ds_read_b64_tr_b16 v[162:163], v236 offset:1792
  v_mfma_f32_16x16x32_bf16 v[84:87], v[184:187], v[216:219], v[84:87]
  ds_read_b128 v[168:171], v224 offset:34816
  v_mfma_f32_16x16x32_bf16 v[88:91], v[188:191], v[216:219], v[88:91]
  ds_read_b128 v[172:175], v224 offset:36864
  v_mfma_f32_16x16x32_bf16 v[92:95], v[192:195], v[216:219], v[92:95]
  ds_read_b128 v[176:179], v224 offset:38912
  v_mfma_f32_16x16x32_bf16 v[96:99], v[196:199], v[216:219], v[96:99]
  v_mfma_f32_16x16x32_bf16 v[100:103], v[200:203], v[216:219], v[100:103]
  v_mfma_f32_16x16x32_bf16 v[104:107], v[204:207], v[216:219], v[104:107]
  v_mfma_f32_16x16x32_bf16 v[108:111], v[180:183], v[220:223], v[108:111]
  v_mfma_f32_16x16x32_bf16 v[112:115], v[184:187], v[220:223], v[112:115]
  v_mfma_f32_16x16x32_bf16 v[116:119], v[188:191], v[220:223], v[116:119]
  v_mfma_f32_16x16x32_bf16 v[120:123], v[192:195], v[220:223], v[120:123]
  v_mfma_f32_16x16x32_bf16 v[124:127], v[196:199], v[220:223], v[124:127]
  v_mfma_f32_16x16x32_bf16 v[128:131], v[200:203], v[220:223], v[128:131]
  v_mfma_f32_16x16x32_bf16 v[132:135], v[204:207], v[220:223], v[132:135]
  s_waitcnt lgkmcnt(0)
  v_mfma_f32_16x16x32_bf16 v[24:27], v[136:139], v[164:167], v[24:27]
  ds_read_b128 v[208:211], v225 offset:32768
  v_mfma_f32_16x16x32_bf16 v[28:31], v[140:143], v[164:167], v[28:31]
  ds_read_b64_tr_b16 v[180:181], v234 offset:14336
  v_mfma_f32_16x16x32_bf16 v[32:35], v[144:147], v[164:167], v[32:35]
  ds_read_b64_tr_b16 v[182:183], v234 offset:16128
  v_mfma_f32_16x16x32_bf16 v[36:39], v[148:151], v[164:167], v[36:39]
  ds_read_b64_tr_b16 v[184:185], v235 offset:14368
  v_mfma_f32_16x16x32_bf16 v[40:43], v[152:155], v[164:167], v[40:43]
  ds_read_b64_tr_b16 v[186:187], v235 offset:16160
  v_mfma_f32_16x16x32_bf16 v[44:47], v[156:159], v[164:167], v[44:47]
  ds_read_b64_tr_b16 v[188:189], v234 offset:14400
  v_mfma_f32_16x16x32_bf16 v[48:51], v[160:163], v[164:167], v[48:51]
  ds_read_b64_tr_b16 v[190:191], v234 offset:16192
  v_mfma_f32_16x16x32_bf16 v[52:55], v[136:139], v[168:171], v[52:55]
  ds_read_b64_tr_b16 v[192:193], v235 offset:14432
  v_mfma_f32_16x16x32_bf16 v[56:59], v[140:143], v[168:171], v[56:59]
  ds_read_b64_tr_b16 v[194:195], v235 offset:16224
  v_mfma_f32_16x16x32_bf16 v[60:63], v[144:147], v[168:171], v[60:63]
  ds_read_b64_tr_b16 v[196:197], v234 offset:14464
  v_mfma_f32_16x16x32_bf16 v[64:67], v[148:151], v[168:171], v[64:67]
  ds_read_b64_tr_b16 v[198:199], v234 offset:16256
  v_mfma_f32_16x16x32_bf16 v[68:71], v[152:155], v[168:171], v[68:71]
  ds_read_b64_tr_b16 v[200:201], v235 offset:14496
  v_mfma_f32_16x16x32_bf16 v[72:75], v[156:159], v[168:171], v[72:75]
  ds_read_b64_tr_b16 v[202:203], v235 offset:16288
  v_mfma_f32_16x16x32_bf16 v[76:79], v[160:163], v[168:171], v[76:79]
  ds_read_b64_tr_b16 v[204:205], v236 offset:14336
  v_mfma_f32_16x16x32_bf16 v[80:83], v[136:139], v[172:175], v[80:83]
  ds_read_b64_tr_b16 v[206:207], v236 offset:16128
  v_mfma_f32_16x16x32_bf16 v[84:87], v[140:143], v[172:175], v[84:87]
  ds_read_b128 v[212:215], v225 offset:34816
  v_mfma_f32_16x16x32_bf16 v[88:91], v[144:147], v[172:175], v[88:91]
  ds_read_b128 v[216:219], v225 offset:36864
  v_mfma_f32_16x16x32_bf16 v[92:95], v[148:151], v[172:175], v[92:95]
  ds_read_b128 v[220:223], v225 offset:38912
  v_mfma_f32_16x16x32_bf16 v[96:99], v[152:155], v[172:175], v[96:99]
  buffer_load_dword v17, v16, s[48:51], s44 offen
  s_add_u32 s44, s44, 3670016
  v_mfma_f32_16x16x32_bf16 v[100:103], v[156:159], v[172:175], v[100:103]
  v_mfma_f32_16x16x32_bf16 v[104:107], v[160:163], v[172:175], v[104:107]
  v_mfma_f32_16x16x32_bf16 v[108:111], v[136:139], v[176:179], v[108:111]
  v_mfma_f32_16x16x32_bf16 v[112:115], v[140:143], v[176:179], v[112:115]
  v_mfma_f32_16x16x32_bf16 v[116:119], v[144:147], v[176:179], v[116:119]
  v_mfma_f32_16x16x32_bf16 v[120:123], v[148:151], v[176:179], v[120:123]
  v_mfma_f32_16x16x32_bf16 v[124:127], v[152:155], v[176:179], v[124:127]
  v_mfma_f32_16x16x32_bf16 v[128:131], v[156:159], v[176:179], v[128:131]
  v_mfma_f32_16x16x32_bf16 v[132:135], v[160:163], v[176:179], v[132:135]
  s_waitcnt lgkmcnt(0)
  s_barrier
  v_mfma_f32_16x16x32_bf16 v[24:27], v[180:183], v[208:211], v[24:27]
  ds_read_b128 v[164:167], v224 offset:0
  v_mfma_f32_16x16x32_bf16 v[28:31], v[184:187], v[208:211], v[28:31]
  ds_read_b64_tr_b16 v[136:137], v228 offset:0
  v_mfma_f32_16x16x32_bf16 v[32:35], v[188:191], v[208:211], v[32:35]
  ds_read_b64_tr_b16 v[138:139], v228 offset:1792
  v_mfma_f32_16x16x32_bf16 v[36:39], v[192:195], v[208:211], v[36:39]
  ds_read_b64_tr_b16 v[140:141], v229 offset:32
  v_mfma_f32_16x16x32_bf16 v[40:43], v[196:199], v[208:211], v[40:43]
  ds_read_b64_tr_b16 v[142:143], v229 offset:1824
  v_mfma_f32_16x16x32_bf16 v[44:47], v[200:203], v[208:211], v[44:47]
  ds_read_b64_tr_b16 v[144:145], v228 offset:64
  v_mfma_f32_16x16x32_bf16 v[48:51], v[204:207], v[208:211], v[48:51]
  ds_read_b64_tr_b16 v[146:147], v228 offset:1856
  v_mfma_f32_16x16x32_bf16 v[52:55], v[180:183], v[212:215], v[52:55]
  ds_read_b64_tr_b16 v[148:149], v229 offset:96
  v_mfma_f32_16x16x32_bf16 v[56:59], v[184:187], v[212:215], v[56:59]
  ds_read_b64_tr_b16 v[150:151], v229 offset:1888
  v_mfma_f32_16x16x32_bf16 v[60:63], v[188:191], v[212:215], v[60:63]
  ds_read_b64_tr_b16 v[152:153], v228 offset:128
  v_mfma_f32_16x16x32_bf16 v[64:67], v[192:195], v[212:215], v[64:67]
  ds_read_b64_tr_b16 v[154:155], v228 offset:1920
  v_mfma_f32_16x16x32_bf16 v[68:71], v[196:199], v[212:215], v[68:71]
  ds_read_b64_tr_b16 v[156:157], v229 offset:160
  v_mfma_f32_16x16x32_bf16 v[72:75], v[200:203], v[212:215], v[72:75]
  ds_read_b64_tr_b16 v[158:159], v229 offset:1952
  v_mfma_f32_16x16x32_bf16 v[76:79], v[204:207], v[212:215], v[76:79]
  ds_read_b64_tr_b16 v[160:161], v230 offset:0
  v_mfma_f32_16x16x32_bf16 v[80:83], v[180:183], v[216:219], v[80:83]
  ds_read_b64_tr_b16 v[162:163], v230 offset:1792
  v_mfma_f32_16x16x32_bf16 v[84:87], v[184:187], v[216:219], v[84:87]
  ds_read_b128 v[168:171], v224 offset:2048
  v_mfma_f32_16x16x32_bf16 v[88:91], v[188:191], v[216:219], v[88:91]
  ds_read_b128 v[172:175], v224 offset:4096
  v_mfma_f32_16x16x32_bf16 v[92:95], v[192:195], v[216:219], v[92:95]
  ds_read_b128 v[176:179], v224 offset:6144
  v_mfma_f32_16x16x32_bf16 v[96:99], v[196:199], v[216:219], v[96:99]
  v_mfma_f32_16x16x32_bf16 v[100:103], v[200:203], v[216:219], v[100:103]
  v_mfma_f32_16x16x32_bf16 v[104:107], v[204:207], v[216:219], v[104:107]
  v_mfma_f32_16x16x32_bf16 v[108:111], v[180:183], v[220:223], v[108:111]
  v_mfma_f32_16x16x32_bf16 v[112:115], v[184:187], v[220:223], v[112:115]
  v_mfma_f32_16x16x32_bf16 v[116:119], v[188:191], v[220:223], v[116:119]
  v_mfma_f32_16x16x32_bf16 v[120:123], v[192:195], v[220:223], v[120:123]
  v_mfma_f32_16x16x32_bf16 v[124:127], v[196:199], v[220:223], v[124:127]
  v_mfma_f32_16x16x32_bf16 v[128:131], v[200:203], v[220:223], v[128:131]
  v_mfma_f32_16x16x32_bf16 v[132:135], v[204:207], v[220:223], v[132:135]
  s_waitcnt lgkmcnt(0)
  v_mfma_f32_16x16x32_bf16 v[24:27], v[136:139], v[164:167], v[24:27]
  ds_read_b128 v[208:211], v225 offset:0
  v_mfma_f32_16x16x32_bf16 v[28:31], v[140:143], v[164:167], v[28:31]
  ds_read_b64_tr_b16 v[180:181], v228 offset:14336
  v_mfma_f32_16x16x32_bf16 v[32:35], v[144:147], v[164:167], v[32:35]
  ds_read_b64_tr_b16 v[182:183], v228 offset:16128
  v_mfma_f32_16x16x32_bf16 v[36:39], v[148:151], v[164:167], v[36:39]
  ds_read_b64_tr_b16 v[184:185], v229 offset:14368
  v_mfma_f32_16x16x32_bf16 v[40:43], v[152:155], v[164:167], v[40:43]
  ds_read_b64_tr_b16 v[186:187], v229 offset:16160
  v_mfma_f32_16x16x32_bf16 v[44:47], v[156:159], v[164:167], v[44:47]
  ds_read_b64_tr_b16 v[188:189], v228 offset:14400
  v_mfma_f32_16x16x32_bf16 v[48:51], v[160:163], v[164:167], v[48:51]
  ds_read_b64_tr_b16 v[190:191], v228 offset:16192
  v_mfma_f32_16x16x32_bf16 v[52:55], v[136:139], v[168:171], v[52:55]
  ds_read_b64_tr_b16 v[192:193], v229 offset:14432
  v_mfma_f32_16x16x32_bf16 v[56:59], v[140:143], v[168:171], v[56:59]
  ds_read_b64_tr_b16 v[194:195], v229 offset:16224
  v_mfma_f32_16x16x32_bf16 v[60:63], v[144:147], v[168:171], v[60:63]
  ds_read_b64_tr_b16 v[196:197], v228 offset:14464
  v_mfma_f32_16x16x32_bf16 v[64:67], v[148:151], v[168:171], v[64:67]
  ds_read_b64_tr_b16 v[198:199], v228 offset:16256
  v_mfma_f32_16x16x32_bf16 v[68:71], v[152:155], v[168:171], v[68:71]
  ds_read_b64_tr_b16 v[200:201], v229 offset:14496
  v_mfma_f32_16x16x32_bf16 v[72:75], v[156:159], v[168:171], v[72:75]
  ds_read_b64_tr_b16 v[202:203], v229 offset:16288
  v_mfma_f32_16x16x32_bf16 v[76:79], v[160:163], v[168:171], v[76:79]
  ds_read_b64_tr_b16 v[204:205], v230 offset:14336
  v_mfma_f32_16x16x32_bf16 v[80:83], v[136:139], v[172:175], v[80:83]
  ds_read_b64_tr_b16 v[206:207], v230 offset:16128
  v_mfma_f32_16x16x32_bf16 v[84:87], v[140:143], v[172:175], v[84:87]
  ds_read_b128 v[212:215], v225 offset:2048
  v_mfma_f32_16x16x32_bf16 v[88:91], v[144:147], v[172:175], v[88:91]
  ds_read_b128 v[216:219], v225 offset:4096
  v_mfma_f32_16x16x32_bf16 v[92:95], v[148:151], v[172:175], v[92:95]
  ds_read_b128 v[220:223], v225 offset:6144
  v_mfma_f32_16x16x32_bf16 v[96:99], v[152:155], v[172:175], v[96:99]
  v_mfma_f32_16x16x32_bf16 v[100:103], v[156:159], v[172:175], v[100:103]
  v_mfma_f32_16x16x32_bf16 v[104:107], v[160:163], v[172:175], v[104:107]
  v_mfma_f32_16x16x32_bf16 v[108:111], v[136:139], v[176:179], v[108:111]
  v_mfma_f32_16x16x32_bf16 v[112:115], v[140:143], v[176:179], v[112:115]
  v_mfma_f32_16x16x32_bf16 v[116:119], v[144:147], v[176:179], v[116:119]
  v_mfma_f32_16x16x32_bf16 v[120:123], v[148:151], v[176:179], v[120:123]
  v_mfma_f32_16x16x32_bf16 v[124:127], v[152:155], v[176:179], v[124:127]
  v_mfma_f32_16x16x32_bf16 v[128:131], v[156:159], v[176:179], v[128:131]
  v_mfma_f32_16x16x32_bf16 v[132:135], v[160:163], v[176:179], v[132:135]
  s_waitcnt lgkmcnt(0)
  s_barrier
  v_mfma_f32_16x16x32_bf16 v[24:27], v[180:183], v[208:211], v[24:27]
  ds_read_b128 v[164:167], v224 offset:16384
  v_mfma_f32_16x16x32_bf16 v[28:31], v[184:187], v[208:211], v[28:31]
  ds_read_b64_tr_b16 v[136:137], v231 offset:0
  v_mfma_f32_16x16x32_bf16 v[32:35], v[188:191], v[208:211], v[32:35]
  ds_read_b64_tr_b16 v[138:139], v231 offset:1792
  v_mfma_f32_16x16x32_bf16 v[36:39], v[192:195], v[208:211], v[36:39]
  ds_read_b64_tr_b16 v[140:141], v232 offset:32
  v_mfma_f32_16x16x32_bf16 v[40:43], v[196:199], v[208:211], v[40:43]
  ds_read_b64_tr_b16 v[142:143], v232 offset:1824
  v_mfma_f32_16x16x32_bf16 v[44:47], v[200:203], v[208:211], v[44:47]
  ds_read_b64_tr_b16 v[144:145], v231 offset:64
  v_mfma_f32_16x16x32_bf16 v[48:51], v[204:207], v[208:211], v[48:51]
  ds_read_b64_tr_b16 v[146:147], v231 offset:1856
  v_mfma_f32_16x16x32_bf16 v[52:55], v[180:183], v[212:215], v[52:55]
  ds_read_b64_tr_b16 v[148:149], v232 offset:96
  v_mfma_f32_16x16x32_bf16 v[56:59], v[184:187], v[212:215], v[56:59]
  ds_read_b64_tr_b16 v[150:151], v232 offset:1888
  v_mfma_f32_16x16x32_bf16 v[60:63], v[188:191], v[212:215], v[60:63]
  ds_read_b64_tr_b16 v[152:153], v231 offset:128
  v_mfma_f32_16x16x32_bf16 v[64:67], v[192:195], v[212:215], v[64:67]
  ds_read_b64_tr_b16 v[154:155], v231 offset:1920
  v_mfma_f32_16x16x32_bf16 v[68:71], v[196:199], v[212:215], v[68:71]
  ds_read_b64_tr_b16 v[156:157], v232 offset:160
  v_mfma_f32_16x16x32_bf16 v[72:75], v[200:203], v[212:215], v[72:75]
  ds_read_b64_tr_b16 v[158:159], v232 offset:1952
  v_mfma_f32_16x16x32_bf16 v[76:79], v[204:207], v[212:215], v[76:79]
  ds_read_b64_tr_b16 v[160:161], v233 offset:0
  v_mfma_f32_16x16x32_bf16 v[80:83], v[180:183], v[216:219], v[80:83]
  ds_read_b64_tr_b16 v[162:163], v233 offset:1792
  v_mfma_f32_16x16x32_bf16 v[84:87], v[184:187], v[216:219], v[84:87]
  ds_read_b128 v[168:171], v224 offset:18432
  v_mfma_f32_16x16x32_bf16 v[88:91], v[188:191], v[216:219], v[88:91]
  ds_read_b128 v[172:175], v224 offset:20480
  v_mfma_f32_16x16x32_bf16 v[92:95], v[192:195], v[216:219], v[92:95]
  ds_read_b128 v[176:179], v224 offset:22528
  v_mfma_f32_16x16x32_bf16 v[96:99], v[196:199], v[216:219], v[96:99]
  v_mfma_f32_16x16x32_bf16 v[100:103], v[200:203], v[216:219], v[100:103]
  v_mfma_f32_16x16x32_bf16 v[104:107], v[204:207], v[216:219], v[104:107]
  v_mfma_f32_16x16x32_bf16 v[108:111], v[180:183], v[220:223], v[108:111]
  v_mfma_f32_16x16x32_bf16 v[112:115], v[184:187], v[220:223], v[112:115]
  v_mfma_f32_16x16x32_bf16 v[116:119], v[188:191], v[220:223], v[116:119]
  v_mfma_f32_16x16x32_bf16 v[120:123], v[192:195], v[220:223], v[120:123]
  v_mfma_f32_16x16x32_bf16 v[124:127], v[196:199], v[220:223], v[124:127]
  v_mfma_f32_16x16x32_bf16 v[128:131], v[200:203], v[220:223], v[128:131]
  v_mfma_f32_16x16x32_bf16 v[132:135], v[204:207], v[220:223], v[132:135]
  s_waitcnt lgkmcnt(0)
  v_mfma_f32_16x16x32_bf16 v[24:27], v[136:139], v[164:167], v[24:27]
  ds_read_b128 v[208:211], v225 offset:16384
  v_mfma_f32_16x16x32_bf16 v[28:31], v[140:143], v[164:167], v[28:31]
  ds_read_b64_tr_b16 v[180:181], v231 offset:14336
  v_mfma_f32_16x16x32_bf16 v[32:35], v[144:147], v[164:167], v[32:35]
  ds_read_b64_tr_b16 v[182:183], v231 offset:16128
  v_mfma_f32_16x16x32_bf16 v[36:39], v[148:151], v[164:167], v[36:39]
  ds_read_b64_tr_b16 v[184:185], v232 offset:14368
  v_mfma_f32_16x16x32_bf16 v[40:43], v[152:155], v[164:167], v[40:43]
  ds_read_b64_tr_b16 v[186:187], v232 offset:16160
  v_mfma_f32_16x16x32_bf16 v[44:47], v[156:159], v[164:167], v[44:47]
  ds_read_b64_tr_b16 v[188:189], v231 offset:14400
  v_mfma_f32_16x16x32_bf16 v[48:51], v[160:163], v[164:167], v[48:51]
  ds_read_b64_tr_b16 v[190:191], v231 offset:16192
  v_mfma_f32_16x16x32_bf16 v[52:55], v[136:139], v[168:171], v[52:55]
  ds_read_b64_tr_b16 v[192:193], v232 offset:14432
  v_mfma_f32_16x16x32_bf16 v[56:59], v[140:143], v[168:171], v[56:59]
  ds_read_b64_tr_b16 v[194:195], v232 offset:16224
  v_mfma_f32_16x16x32_bf16 v[60:63], v[144:147], v[168:171], v[60:63]
  ds_read_b64_tr_b16 v[196:197], v231 offset:14464
  v_mfma_f32_16x16x32_bf16 v[64:67], v[148:151], v[168:171], v[64:67]
  ds_read_b64_tr_b16 v[198:199], v231 offset:16256
  v_mfma_f32_16x16x32_bf16 v[68:71], v[152:155], v[168:171], v[68:71]
  ds_read_b64_tr_b16 v[200:201], v232 offset:14496
  v_mfma_f32_16x16x32_bf16 v[72:75], v[156:159], v[168:171], v[72:75]
  ds_read_b64_tr_b16 v[202:203], v232 offset:16288
  v_mfma_f32_16x16x32_bf16 v[76:79], v[160:163], v[168:171], v[76:79]
  ds_read_b64_tr_b16 v[204:205], v233 offset:14336
  v_mfma_f32_16x16x32_bf16 v[80:83], v[136:139], v[172:175], v[80:83]
  ds_read_b64_tr_b16 v[206:207], v233 offset:16128
  v_mfma_f32_16x16x32_bf16 v[84:87], v[140:143], v[172:175], v[84:87]
  ds_read_b128 v[212:215], v225 offset:18432
  v_mfma_f32_16x16x32_bf16 v[88:91], v[144:147], v[172:175], v[88:91]
  ds_read_b128 v[216:219], v225 offset:20480
  v_mfma_f32_16x16x32_bf16 v[92:95], v[148:151], v[172:175], v[92:95]
  ds_read_b128 v[220:223], v225 offset:22528
  v_mfma_f32_16x16x32_bf16 v[96:99], v[152:155], v[172:175], v[96:99]
  v_mfma_f32_16x16x32_bf16 v[100:103], v[156:159], v[172:175], v[100:103]
  v_mfma_f32_16x16x32_bf16 v[104:107], v[160:163], v[172:175], v[104:107]
  v_mfma_f32_16x16x32_bf16 v[108:111], v[136:139], v[176:179], v[108:111]
  v_mfma_f32_16x16x32_bf16 v[112:115], v[140:143], v[176:179], v[112:115]
  v_mfma_f32_16x16x32_bf16 v[116:119], v[144:147], v[176:179], v[116:119]
  v_mfma_f32_16x16x32_bf16 v[120:123], v[148:151], v[176:179], v[120:123]
  v_mfma_f32_16x16x32_bf16 v[124:127], v[152:155], v[176:179], v[124:127]
  v_mfma_f32_16x16x32_bf16 v[128:131], v[156:159], v[176:179], v[128:131]
  v_mfma_f32_16x16x32_bf16 v[132:135], v[160:163], v[176:179], v[132:135]
  s_waitcnt lgkmcnt(0)
  s_barrier
  v_mfma_f32_16x16x32_bf16 v[24:27], v[180:183], v[208:211], v[24:27]
  ds_read_b128 v[164:167], v224 offset:32768
  v_mfma_f32_16x16x32_bf16 v[28:31], v[184:187], v[208:211], v[28:31]
  ds_read_b64_tr_b16 v[136:137], v234 offset:0
  v_mfma_f32_16x16x32_bf16 v[32:35], v[188:191], v[208:211], v[32:35]
  ds_read_b64_tr_b16 v[138:139], v234 offset:1792
  v_mfma_f32_16x16x32_bf16 v[36:39], v[192:195], v[208:211], v[36:39]
  ds_read_b64_tr_b16 v[140:141], v235 offset:32
  v_mfma_f32_16x16x32_bf16 v[40:43], v[196:199], v[208:211], v[40:43]
  ds_read_b64_tr_b16 v[142:143], v235 offset:1824
  v_mfma_f32_16x16x32_bf16 v[44:47], v[200:203], v[208:211], v[44:47]
  ds_read_b64_tr_b16 v[144:145], v234 offset:64
  v_mfma_f32_16x16x32_bf16 v[48:51], v[204:207], v[208:211], v[48:51]
  ds_read_b64_tr_b16 v[146:147], v234 offset:1856
  v_mfma_f32_16x16x32_bf16 v[52:55], v[180:183], v[212:215], v[52:55]
  ds_read_b64_tr_b16 v[148:149], v235 offset:96
  v_mfma_f32_16x16x32_bf16 v[56:59], v[184:187], v[212:215], v[56:59]
  ds_read_b64_tr_b16 v[150:151], v235 offset:1888
  v_mfma_f32_16x16x32_bf16 v[60:63], v[188:191], v[212:215], v[60:63]
  ds_read_b64_tr_b16 v[152:153], v234 offset:128
  v_mfma_f32_16x16x32_bf16 v[64:67], v[192:195], v[212:215], v[64:67]
  ds_read_b64_tr_b16 v[154:155], v234 offset:1920
  v_mfma_f32_16x16x32_bf16 v[68:71], v[196:199], v[212:215], v[68:71]
  ds_read_b64_tr_b16 v[156:157], v235 offset:160
  v_mfma_f32_16x16x32_bf16 v[72:75], v[200:203], v[212:215], v[72:75]
  ds_read_b64_tr_b16 v[158:159], v235 offset:1952
  v_mfma_f32_16x16x32_bf16 v[76:79], v[204:207], v[212:215], v[76:79]
  ds_read_b64_tr_b16 v[160:161], v236 offset:0
  v_mfma_f32_16x16x32_bf16 v[80:83], v[180:183], v[216:219], v[80:83]
  ds_read_b64_tr_b16 v[162:163], v236 offset:1792
  v_mfma_f32_16x16x32_bf16 v[84:87], v[184:187], v[216:219], v[84:87]
  ds_read_b128 v[168:171], v224 offset:34816
  v_mfma_f32_16x16x32_bf16 v[88:91], v[188:191], v[216:219], v[88:91]
  ds_read_b128 v[172:175], v224 offset:36864
  v_mfma_f32_16x16x32_bf16 v[92:95], v[192:195], v[216:219], v[92:95]
  ds_read_b128 v[176:179], v224 offset:38912
  v_mfma_f32_16x16x32_bf16 v[96:99], v[196:199], v[216:219], v[96:99]
  v_mfma_f32_16x16x32_bf16 v[100:103], v[200:203], v[216:219], v[100:103]
  v_mfma_f32_16x16x32_bf16 v[104:107], v[204:207], v[216:219], v[104:107]
  v_mfma_f32_16x16x32_bf16 v[108:111], v[180:183], v[220:223], v[108:111]
  v_mfma_f32_16x16x32_bf16 v[112:115], v[184:187], v[220:223], v[112:115]
  v_mfma_f32_16x16x32_bf16 v[116:119], v[188:191], v[220:223], v[116:119]
  v_mfma_f32_16x16x32_bf16 v[120:123], v[192:195], v[220:223], v[120:123]
  v_mfma_f32_16x16x32_bf16 v[124:127], v[196:199], v[220:223], v[124:127]
  v_mfma_f32_16x16x32_bf16 v[128:131], v[200:203], v[220:223], v[128:131]
  v_mfma_f32_16x16x32_bf16 v[132:135], v[204:207], v[220:223], v[132:135]
  s_waitcnt lgkmcnt(0)
  v_mfma_f32_16x16x32_bf16 v[24:27], v[136:139], v[164:167], v[24:27]
  ds_read_b128 v[208:211], v225 offset:32768
  v_mfma_f32_16x16x32_bf16 v[28:31], v[140:143], v[164:167], v[28:31]
  ds_read_b64_tr_b16 v[180:181], v234 offset:14336
  v_mfma_f32_16x16x32_bf16 v[32:35], v[144:147], v[164:167], v[32:35]
  ds_read_b64_tr_b16 v[182:183], v234 offset:16128
  v_mfma_f32_16x16x32_bf16 v[36:39], v[148:151], v[164:167], v[36:39]
  ds_read_b64_tr_b16 v[184:185], v235 offset:14368
  v_mfma_f32_16x16x32_bf16 v[40:43], v[152:155], v[164:167], v[40:43]
  ds_read_b64_tr_b16 v[186:187], v235 offset:16160
  v_mfma_f32_16x16x32_bf16 v[44:47], v[156:159], v[164:167], v[44:47]
  ds_read_b64_tr_b16 v[188:189], v234 offset:14400
  v_mfma_f32_16x16x32_bf16 v[48:51], v[160:163], v[164:167], v[48:51]
  ds_read_b64_tr_b16 v[190:191], v234 offset:16192
  v_mfma_f32_16x16x32_bf16 v[52:55], v[136:139], v[168:171], v[52:55]
  ds_read_b64_tr_b16 v[192:193], v235 offset:14432
  v_mfma_f32_16x16x32_bf16 v[56:59], v[140:143], v[168:171], v[56:59]
  ds_read_b64_tr_b16 v[194:195], v235 offset:16224
  v_mfma_f32_16x16x32_bf16 v[60:63], v[144:147], v[168:171], v[60:63]
  ds_read_b64_tr_b16 v[196:197], v234 offset:14464
  v_mfma_f32_16x16x32_bf16 v[64:67], v[148:151], v[168:171], v[64:67]
  ds_read_b64_tr_b16 v[198:199], v234 offset:16256
  v_mfma_f32_16x16x32_bf16 v[68:71], v[152:155], v[168:171], v[68:71]
  ds_read_b64_tr_b16 v[200:201], v235 offset:14496
  v_mfma_f32_16x16x32_bf16 v[72:75], v[156:159], v[168:171], v[72:75]
  ds_read_b64_tr_b16 v[202:203], v235 offset:16288
  v_mfma_f32_16x16x32_bf16 v[76:79], v[160:163], v[168:171], v[76:79]
  ds_read_b64_tr_b16 v[204:205], v236 offset:14336
  v_mfma_f32_16x16x32_bf16 v[80:83], v[136:139], v[172:175], v[80:83]
  ds_read_b64_tr_b16 v[206:207], v236 offset:16128
  v_mfma_f32_16x16x32_bf16 v[84:87], v[140:143], v[172:175], v[84:87]
  ds_read_b128 v[212:215], v225 offset:34816
  v_mfma_f32_16x16x32_bf16 v[88:91], v[144:147], v[172:175], v[88:91]
  ds_read_b128 v[216:219], v225 offset:36864
  v_mfma_f32_16x16x32_bf16 v[92:95], v[148:151], v[172:175], v[92:95]
  ds_read_b128 v[220:223], v225 offset:38912
  v_mfma_f32_16x16x32_bf16 v[96:99], v[152:155], v[172:175], v[96:99]
  v_mfma_f32_16x16x32_bf16 v[100:103], v[156:159], v[172:175], v[100:103]
  v_mfma_f32_16x16x32_bf16 v[104:107], v[160:163], v[172:175], v[104:107]
  v_mfma_f32_16x16x32_bf16 v[108:111], v[136:139], v[176:179], v[108:111]
  v_mfma_f32_16x16x32_bf16 v[112:115], v[140:143], v[176:179], v[112:115]
  v_mfma_f32_16x16x32_bf16 v[116:119], v[144:147], v[176:179], v[116:119]
  v_mfma_f32_16x16x32_bf16 v[120:123], v[148:151], v[176:179], v[120:123]
  v_mfma_f32_16x16x32_bf16 v[124:127], v[152:155], v[176:179], v[124:127]
  v_mfma_f32_16x16x32_bf16 v[128:131], v[156:159], v[176:179], v[128:131]
  v_mfma_f32_16x16x32_bf16 v[132:135], v[160:163], v[176:179], v[132:135]
  s_waitcnt lgkmcnt(0)
  s_barrier
  v_mfma_f32_16x16x32_bf16 v[24:27], v[180:183], v[208:211], v[24:27]
  ds_read_b128 v[164:167], v224 offset:0
  v_mfma_f32_16x16x32_bf16 v[28:31], v[184:187], v[208:211], v[28:31]
  ds_read_b64_tr_b16 v[136:137], v228 offset:0
  v_mfma_f32_16x16x32_bf16 v[32:35], v[188:191], v[208:211], v[32:35]
  ds_read_b64_tr_b16 v[138:139], v228 offset:1792
  v_mfma_f32_16x16x32_bf16 v[36:39], v[192:195], v[208:211], v[36:39]
  ds_read_b64_tr_b16 v[140:141], v229 offset:32
  v_mfma_f32_16x16x32_bf16 v[40:43], v[196:199], v[208:211], v[40:43]
  ds_read_b64_tr_b16 v[142:143], v229 offset:1824
  v_mfma_f32_16x16x32_bf16 v[44:47], v[200:203], v[208:211], v[44:47]
  ds_read_b64_tr_b16 v[144:145], v228 offset:64
  v_mfma_f32_16x16x32_bf16 v[48:51], v[204:207], v[208:211], v[48:51]
  ds_read_b64_tr_b16 v[146:147], v228 offset:1856
  v_mfma_f32_16x16x32_bf16 v[52:55], v[180:183], v[212:215], v[52:55]
  ds_read_b64_tr_b16 v[148:149], v229 offset:96
  v_mfma_f32_16x16x32_bf16 v[56:59], v[184:187], v[212:215], v[56:59]
  ds_read_b64_tr_b16 v[150:151], v229 offset:1888
  v_mfma_f32_16x16x32_bf16 v[60:63], v[188:191], v[212:215], v[60:63]
  ds_read_b64_tr_b16 v[152:153], v228 offset:128
  v_mfma_f32_16x16x32_bf16 v[64:67], v[192:195], v[212:215], v[64:67]
  ds_read_b64_tr_b16 v[154:155], v228 offset:1920
  v_mfma_f32_16x16x32_bf16 v[68:71], v[196:199], v[212:215], v[68:71]
  ds_read_b64_tr_b16 v[156:157], v229 offset:160
  v_mfma_f32_16x16x32_bf16 v[72:75], v[200:203], v[212:215], v[72:75]
  ds_read_b64_tr_b16 v[158:159], v229 offset:1952
  v_mfma_f32_16x16x32_bf16 v[76:79], v[204:207], v[212:215], v[76:79]
  ds_read_b64_tr_b16 v[160:161], v230 offset:0
  v_mfma_f32_16x16x32_bf16 v[80:83], v[180:183], v[216:219], v[80:83]
  ds_read_b64_tr_b16 v[162:163], v230 offset:1792
  v_mfma_f32_16x16x32_bf16 v[84:87], v[184:187], v[216:219], v[84:87]
  ds_read_b128 v[168:171], v224 offset:2048
  v_mfma_f32_16x16x32_bf16 v[88:91], v[188:191], v[216:219], v[88:91]
  ds_read_b128 v[172:175], v224 offset:4096
  v_mfma_f32_16x16x32_bf16 v[92:95], v[192:195], v[216:219], v[92:95]
  ds_read_b128 v[176:179], v224 offset:6144
  v_mfma_f32_16x16x32_bf16 v[96:99], v[196:199], v[216:219], v[96:99]
  v_mfma_f32_16x16x32_bf16 v[100:103], v[200:203], v[216:219], v[100:103]
  v_mfma_f32_16x16x32_bf16 v[104:107], v[204:207], v[216:219], v[104:107]
  v_mfma_f32_16x16x32_bf16 v[108:111], v[180:183], v[220:223], v[108:111]
  v_mfma_f32_16x16x32_bf16 v[112:115], v[184:187], v[220:223], v[112:115]
  v_mfma_f32_16x16x32_bf16 v[116:119], v[188:191], v[220:223], v[116:119]
  v_mfma_f32_16x16x32_bf16 v[120:123], v[192:195], v[220:223], v[120:123]
  v_mfma_f32_16x16x32_bf16 v[124:127], v[196:199], v[220:223], v[124:127]
  v_mfma_f32_16x16x32_bf16 v[128:131], v[200:203], v[220:223], v[128:131]
  v_mfma_f32_16x16x32_bf16 v[132:135], v[204:207], v[220:223], v[132:135]
  s_waitcnt lgkmcnt(0)
  v_mfma_f32_16x16x32_bf16 v[24:27], v[136:139], v[164:167], v[24:27]
  ds_read_b128 v[208:211], v225 offset:0
  v_mfma_f32_16x16x32_bf16 v[28:31], v[140:143], v[164:167], v[28:31]
  ds_read_b64_tr_b16 v[180:181], v228 offset:14336
  v_mfma_f32_16x16x32_bf16 v[32:35], v[144:147], v[164:167], v[32:35]
  ds_read_b64_tr_b16 v[182:183], v228 offset:16128
  v_mfma_f32_16x16x32_bf16 v[36:39], v[148:151], v[164:167], v[36:39]
  ds_read_b64_tr_b16 v[184:185], v229 offset:14368
  v_mfma_f32_16x16x32_bf16 v[40:43], v[152:155], v[164:167], v[40:43]
  ds_read_b64_tr_b16 v[186:187], v229 offset:16160
  v_mfma_f32_16x16x32_bf16 v[44:47], v[156:159], v[164:167], v[44:47]
  ds_read_b64_tr_b16 v[188:189], v228 offset:14400
  v_mfma_f32_16x16x32_bf16 v[48:51], v[160:163], v[164:167], v[48:51]
  ds_read_b64_tr_b16 v[190:191], v228 offset:16192
  v_mfma_f32_16x16x32_bf16 v[52:55], v[136:139], v[168:171], v[52:55]
  ds_read_b64_tr_b16 v[192:193], v229 offset:14432
  v_mfma_f32_16x16x32_bf16 v[56:59], v[140:143], v[168:171], v[56:59]
  ds_read_b64_tr_b16 v[194:195], v229 offset:16224
  v_mfma_f32_16x16x32_bf16 v[60:63], v[144:147], v[168:171], v[60:63]
  ds_read_b64_tr_b16 v[196:197], v228 offset:14464
  v_mfma_f32_16x16x32_bf16 v[64:67], v[148:151], v[168:171], v[64:67]
  ds_read_b64_tr_b16 v[198:199], v228 offset:16256
  v_mfma_f32_16x16x32_bf16 v[68:71], v[152:155], v[168:171], v[68:71]
  ds_read_b64_tr_b16 v[200:201], v229 offset:14496
  v_mfma_f32_16x16x32_bf16 v[72:75], v[156:159], v[168:171], v[72:75]
  ds_read_b64_tr_b16 v[202:203], v229 offset:16288
  v_mfma_f32_16x16x32_bf16 v[76:79], v[160:163], v[168:171], v[76:79]
  ds_read_b64_tr_b16 v[204:205], v230 offset:14336
  v_mfma_f32_16x16x32_bf16 v[80:83], v[136:139], v[172:175], v[80:83]
  ds_read_b64_tr_b16 v[206:207], v230 offset:16128
  v_mfma_f32_16x16x32_bf16 v[84:87], v[140:143], v[172:175], v[84:87]
  ds_read_b128 v[212:215], v225 offset:2048
  v_mfma_f32_16x16x32_bf16 v[88:91], v[144:147], v[172:175], v[88:91]
  ds_read_b128 v[216:219], v225 offset:4096
  v_mfma_f32_16x16x32_bf16 v[92:95], v[148:151], v[172:175], v[92:95]
  ds_read_b128 v[220:223], v225 offset:6144
  v_mfma_f32_16x16x32_bf16 v[96:99], v[152:155], v[172:175], v[96:99]
  buffer_load_dword v17, v16, s[48:51], s44 offen
  s_add_u32 s44, s44, 3670016
  v_mfma_f32_16x16x32_bf16 v[100:103], v[156:159], v[172:175], v[100:103]
  v_mfma_f32_16x16x32_bf16 v[104:107], v[160:163], v[172:175], v[104:107]
  v_mfma_f32_16x16x32_bf16 v[108:111], v[136:139], v[176:179], v[108:111]
  v_mfma_f32_16x16x32_bf16 v[112:115], v[140:143], v[176:179], v[112:115]
  v_mfma_f32_16x16x32_bf16 v[116:119], v[144:147], v[176:179], v[116:119]
  v_mfma_f32_16x16x32_bf16 v[120:123], v[148:151], v[176:179], v[120:123]
  v_mfma_f32_16x16x32_bf16 v[124:127], v[152:155], v[176:179], v[124:127]
  v_mfma_f32_16x16x32_bf16 v[128:131], v[156:159], v[176:179], v[128:131]
  v_mfma_f32_16x16x32_bf16 v[132:135], v[160:163], v[176:179], v[132:135]
  s_waitcnt lgkmcnt(0)
  s_barrier
  v_mfma_f32_16x16x32_bf16 v[24:27], v[180:183], v[208:211], v[24:27]
  ds_read_b128 v[164:167], v224 offset:16384
  v_mfma_f32_16x16x32_bf16 v[28:31], v[184:187], v[208:211], v[28:31]
  ds_read_b64_tr_b16 v[136:137], v231 offset:0
  v_mfma_f32_16x16x32_bf16 v[32:35], v[188:191], v[208:211], v[32:35]
  ds_read_b64_tr_b16 v[138:139], v231 offset:1792
  v_mfma_f32_16x16x32_bf16 v[36:39], v[192:195], v[208:211], v[36:39]
  ds_read_b64_tr_b16 v[140:141], v232 offset:32
  v_mfma_f32_16x16x32_bf16 v[40:43], v[196:199], v[208:211], v[40:43]
  ds_read_b64_tr_b16 v[142:143], v232 offset:1824
  v_mfma_f32_16x16x32_bf16 v[44:47], v[200:203], v[208:211], v[44:47]
  ds_read_b64_tr_b16 v[144:145], v231 offset:64
  v_mfma_f32_16x16x32_bf16 v[48:51], v[204:207], v[208:211], v[48:51]
  ds_read_b64_tr_b16 v[146:147], v231 offset:1856
  v_mfma_f32_16x16x32_bf16 v[52:55], v[180:183], v[212:215], v[52:55]
  ds_read_b64_tr_b16 v[148:149], v232 offset:96
  v_mfma_f32_16x16x32_bf16 v[56:59], v[184:187], v[212:215], v[56:59]
  ds_read_b64_tr_b16 v[150:151], v232 offset:1888
  v_mfma_f32_16x16x32_bf16 v[60:63], v[188:191], v[212:215], v[60:63]
  ds_read_b64_tr_b16 v[152:153], v231 offset:128
  v_mfma_f32_16x16x32_bf16 v[64:67], v[192:195], v[212:215], v[64:67]
  ds_read_b64_tr_b16 v[154:155], v231 offset:1920
  v_mfma_f32_16x16x32_bf16 v[68:71], v[196:199], v[212:215], v[68:71]
  ds_read_b64_tr_b16 v[156:157], v232 offset:160
  v_mfma_f32_16x16x32_bf16 v[72:75], v[200:203], v[212:215], v[72:75]
  ds_read_b64_tr_b16 v[158:159], v232 offset:1952
  v_mfma_f32_16x16x32_bf16 v[76:79], v[204:207], v[212:215], v[76:79]
  ds_read_b64_tr_b16 v[160:161], v233 offset:0
  v_mfma_f32_16x16x32_bf16 v[80:83], v[180:183], v[216:219], v[80:83]
  ds_read_b64_tr_b16 v[162:163], v233 offset:1792
  v_mfma_f32_16x16x32_bf16 v[84:87], v[184:187], v[216:219], v[84:87]
  ds_read_b128 v[168:171], v224 offset:18432
  v_mfma_f32_16x16x32_bf16 v[88:91], v[188:191], v[216:219], v[88:91]
  ds_read_b128 v[172:175], v224 offset:20480
  v_mfma_f32_16x16x32_bf16 v[92:95], v[192:195], v[216:219], v[92:95]
  ds_read_b128 v[176:179], v224 offset:22528
  v_mfma_f32_16x16x32_bf16 v[96:99], v[196:199], v[216:219], v[96:99]
  v_mfma_f32_16x16x32_bf16 v[100:103], v[200:203], v[216:219], v[100:103]
  v_mfma_f32_16x16x32_bf16 v[104:107], v[204:207], v[216:219], v[104:107]
  v_mfma_f32_16x16x32_bf16 v[108:111], v[180:183], v[220:223], v[108:111]
  v_mfma_f32_16x16x32_bf16 v[112:115], v[184:187], v[220:223], v[112:115]
  v_mfma_f32_16x16x32_bf16 v[116:119], v[188:191], v[220:223], v[116:119]
  v_mfma_f32_16x16x32_bf16 v[120:123], v[192:195], v[220:223], v[120:123]
  v_mfma_f32_16x16x32_bf16 v[124:127], v[196:199], v[220:223], v[124:127]
  v_mfma_f32_16x16x32_bf16 v[128:131], v[200:203], v[220:223], v[128:131]
  v_mfma_f32_16x16x32_bf16 v[132:135], v[204:207], v[220:223], v[132:135]
  s_waitcnt lgkmcnt(0)
  v_mfma_f32_16x16x32_bf16 v[24:27], v[136:139], v[164:167], v[24:27]
  ds_read_b128 v[208:211], v225 offset:16384
  v_mfma_f32_16x16x32_bf16 v[28:31], v[140:143], v[164:167], v[28:31]
  ds_read_b64_tr_b16 v[180:181], v231 offset:14336
  v_mfma_f32_16x16x32_bf16 v[32:35], v[144:147], v[164:167], v[32:35]
  ds_read_b64_tr_b16 v[182:183], v231 offset:16128
  v_mfma_f32_16x16x32_bf16 v[36:39], v[148:151], v[164:167], v[36:39]
  ds_read_b64_tr_b16 v[184:185], v232 offset:14368
  v_mfma_f32_16x16x32_bf16 v[40:43], v[152:155], v[164:167], v[40:43]
  ds_read_b64_tr_b16 v[186:187], v232 offset:16160
  v_mfma_f32_16x16x32_bf16 v[44:47], v[156:159], v[164:167], v[44:47]
  ds_read_b64_tr_b16 v[188:189], v231 offset:14400
  v_mfma_f32_16x16x32_bf16 v[48:51], v[160:163], v[164:167], v[48:51]
  ds_read_b64_tr_b16 v[190:191], v231 offset:16192
  v_mfma_f32_16x16x32_bf16 v[52:55], v[136:139], v[168:171], v[52:55]
  ds_read_b64_tr_b16 v[192:193], v232 offset:14432
  v_mfma_f32_16x16x32_bf16 v[56:59], v[140:143], v[168:171], v[56:59]
  ds_read_b64_tr_b16 v[194:195], v232 offset:16224
  v_mfma_f32_16x16x32_bf16 v[60:63], v[144:147], v[168:171], v[60:63]
  ds_read_b64_tr_b16 v[196:197], v231 offset:14464
  v_mfma_f32_16x16x32_bf16 v[64:67], v[148:151], v[168:171], v[64:67]
  ds_read_b64_tr_b16 v[198:199], v231 offset:16256
  v_mfma_f32_16x16x32_bf16 v[68:71], v[152:155], v[168:171], v[68:71]
  ds_read_b64_tr_b16 v[200:201], v232 offset:14496
  v_mfma_f32_16x16x32_bf16 v[72:75], v[156:159], v[168:171], v[72:75]
  ds_read_b64_tr_b16 v[202:203], v232 offset:16288
  v_mfma_f32_16x16x32_bf16 v[76:79], v[160:163], v[168:171], v[76:79]
  ds_read_b64_tr_b16 v[204:205], v233 offset:14336
  v_mfma_f32_16x16x32_bf16 v[80:83], v[136:139], v[172:175], v[80:83]
  ds_read_b64_tr_b16 v[206:207], v233 offset:16128
  v_mfma_f32_16x16x32_bf16 v[84:87], v[140:143], v[172:175], v[84:87]
  ds_read_b128 v[212:215], v225 offset:18432
  v_mfma_f32_16x16x32_bf16 v[88:91], v[144:147], v[172:175], v[88:91]
  ds_read_b128 v[216:219], v225 offset:20480
  v_mfma_f32_16x16x32_bf16 v[92:95], v[148:151], v[172:175], v[92:95]
  ds_read_b128 v[220:223], v225 offset:22528
  v_mfma_f32_16x16x32_bf16 v[96:99], v[152:155], v[172:175], v[96:99]
  v_mfma_f32_16x16x32_bf16 v[100:103], v[156:159], v[172:175], v[100:103]
  v_mfma_f32_16x16x32_bf16 v[104:107], v[160:163], v[172:175], v[104:107]
  v_mfma_f32_16x16x32_bf16 v[108:111], v[136:139], v[176:179], v[108:111]
  v_mfma_f32_16x16x32_bf16 v[112:115], v[140:143], v[176:179], v[112:115]
  v_mfma_f32_16x16x32_bf16 v[116:119], v[144:147], v[176:179], v[116:119]
  v_mfma_f32_16x16x32_bf16 v[120:123], v[148:151], v[176:179], v[120:123]
  v_mfma_f32_16x16x32_bf16 v[124:127], v[152:155], v[176:179], v[124:127]
  v_mfma_f32_16x16x32_bf16 v[128:131], v[156:159], v[176:179], v[128:131]
  v_mfma_f32_16x16x32_bf16 v[132:135], v[160:163], v[176:179], v[132:135]
  s_waitcnt lgkmcnt(0)
  s_barrier
  v_mfma_f32_16x16x32_bf16 v[24:27], v[180:183], v[208:211], v[24:27]
  ds_read_b128 v[164:167], v224 offset:32768
  v_mfma_f32_16x16x32_bf16 v[28:31], v[184:187], v[208:211], v[28:31]
  ds_read_b64_tr_b16 v[136:137], v234 offset:0
  v_mfma_f32_16x16x32_bf16 v[32:35], v[188:191], v[208:211], v[32:35]
  ds_read_b64_tr_b16 v[138:139], v234 offset:1792
  v_mfma_f32_16x16x32_bf16 v[36:39], v[192:195], v[208:211], v[36:39]
  ds_read_b64_tr_b16 v[140:141], v235 offset:32
  v_mfma_f32_16x16x32_bf16 v[40:43], v[196:199], v[208:211], v[40:43]
  ds_read_b64_tr_b16 v[142:143], v235 offset:1824
  v_mfma_f32_16x16x32_bf16 v[44:47], v[200:203], v[208:211], v[44:47]
  ds_read_b64_tr_b16 v[144:145], v234 offset:64
  v_mfma_f32_16x16x32_bf16 v[48:51], v[204:207], v[208:211], v[48:51]
  ds_read_b64_tr_b16 v[146:147], v234 offset:1856
  v_mfma_f32_16x16x32_bf16 v[52:55], v[180:183], v[212:215], v[52:55]
  ds_read_b64_tr_b16 v[148:149], v235 offset:96
  v_mfma_f32_16x16x32_bf16 v[56:59], v[184:187], v[212:215], v[56:59]
  ds_read_b64_tr_b16 v[150:151], v235 offset:1888
  v_mfma_f32_16x16x32_bf16 v[60:63], v[188:191], v[212:215], v[60:63]
  ds_read_b64_tr_b16 v[152:153], v234 offset:128
  v_mfma_f32_16x16x32_bf16 v[64:67], v[192:195], v[212:215], v[64:67]
  ds_read_b64_tr_b16 v[154:155], v234 offset:1920
  v_mfma_f32_16x16x32_bf16 v[68:71], v[196:199], v[212:215], v[68:71]
  ds_read_b64_tr_b16 v[156:157], v235 offset:160
  v_mfma_f32_16x16x32_bf16 v[72:75], v[200:203], v[212:215], v[72:75]
  ds_read_b64_tr_b16 v[158:159], v235 offset:1952
  v_mfma_f32_16x16x32_bf16 v[76:79], v[204:207], v[212:215], v[76:79]
  ds_read_b64_tr_b16 v[160:161], v236 offset:0
  v_mfma_f32_16x16x32_bf16 v[80:83], v[180:183], v[216:219], v[80:83]
  ds_read_b64_tr_b16 v[162:163], v236 offset:1792
  v_mfma_f32_16x16x32_bf16 v[84:87], v[184:187], v[216:219], v[84:87]
  ds_read_b128 v[168:171], v224 offset:34816
  v_mfma_f32_16x16x32_bf16 v[88:91], v[188:191], v[216:219], v[88:91]
  ds_read_b128 v[172:175], v224 offset:36864
  v_mfma_f32_16x16x32_bf16 v[92:95], v[192:195], v[216:219], v[92:95]
  ds_read_b128 v[176:179], v224 offset:38912
  v_mfma_f32_16x16x32_bf16 v[96:99], v[196:199], v[216:219], v[96:99]
  v_mfma_f32_16x16x32_bf16 v[100:103], v[200:203], v[216:219], v[100:103]
  v_mfma_f32_16x16x32_bf16 v[104:107], v[204:207], v[216:219], v[104:107]
  v_mfma_f32_16x16x32_bf16 v[108:111], v[180:183], v[220:223], v[108:111]
  v_mfma_f32_16x16x32_bf16 v[112:115], v[184:187], v[220:223], v[112:115]
  v_mfma_f32_16x16x32_bf16 v[116:119], v[188:191], v[220:223], v[116:119]
  v_mfma_f32_16x16x32_bf16 v[120:123], v[192:195], v[220:223], v[120:123]
  v_mfma_f32_16x16x32_bf16 v[124:127], v[196:199], v[220:223], v[124:127]
  v_mfma_f32_16x16x32_bf16 v[128:131], v[200:203], v[220:223], v[128:131]
  v_mfma_f32_16x16x32_bf16 v[132:135], v[204:207], v[220:223], v[132:135]
  s_waitcnt lgkmcnt(0)
  v_mfma_f32_16x16x32_bf16 v[24:27], v[136:139], v[164:167], v[24:27]
  ds_read_b128 v[208:211], v225 offset:32768
  v_mfma_f32_16x16x32_bf16 v[28:31], v[140:143], v[164:167], v[28:31]
  ds_read_b64_tr_b16 v[180:181], v234 offset:14336
  v_mfma_f32_16x16x32_bf16 v[32:35], v[144:147], v[164:167], v[32:35]
  ds_read_b64_tr_b16 v[182:183], v234 offset:16128
  v_mfma_f32_16x16x32_bf16 v[36:39], v[148:151], v[164:167], v[36:39]
  ds_read_b64_tr_b16 v[184:185], v235 offset:14368
  v_mfma_f32_16x16x32_bf16 v[40:43], v[152:155], v[164:167], v[40:43]
  ds_read_b64_tr_b16 v[186:187], v235 offset:16160
  v_mfma_f32_16x16x32_bf16 v[44:47], v[156:159], v[164:167], v[44:47]
  ds_read_b64_tr_b16 v[188:189], v234 offset:14400
  v_mfma_f32_16x16x32_bf16 v[48:51], v[160:163], v[164:167], v[48:51]
  ds_read_b64_tr_b16 v[190:191], v234 offset:16192
  v_mfma_f32_16x16x32_bf16 v[52:55], v[136:139], v[168:171], v[52:55]
  ds_read_b64_tr_b16 v[192:193], v235 offset:14432
  v_mfma_f32_16x16x32_bf16 v[56:59], v[140:143], v[168:171], v[56:59]
  ds_read_b64_tr_b16 v[194:195], v235 offset:16224
  v_mfma_f32_16x16x32_bf16 v[60:63], v[144:147], v[168:171], v[60:63]
  ds_read_b64_tr_b16 v[196:197], v234 offset:14464
  v_mfma_f32_16x16x32_bf16 v[64:67], v[148:151], v[168:171], v[64:67]
  ds_read_b64_tr_b16 v[198:199], v234 offset:16256
  v_mfma_f32_16x16x32_bf16 v[68:71], v[152:155], v[168:171], v[68:71]
  ds_read_b64_tr_b16 v[200:201], v235 offset:14496
  v_mfma_f32_16x16x32_bf16 v[72:75], v[156:159], v[168:171], v[72:75]
  ds_read_b64_tr_b16 v[202:203], v235 offset:16288
  v_mfma_f32_16x16x32_bf16 v[76:79], v[160:163], v[168:171], v[76:79]
  ds_read_b64_tr_b16 v[204:205], v236 offset:14336
  v_mfma_f32_16x16x32_bf16 v[80:83], v[136:139], v[172:175], v[80:83]
  ds_read_b64_tr_b16 v[206:207], v236 offset:16128
  v_mfma_f32_16x16x32_bf16 v[84:87], v[140:143], v[172:175], v[84:87]
  ds_read_b128 v[212:215], v225 offset:34816
  v_mfma_f32_16x16x32_bf16 v[88:91], v[144:147], v[172:175], v[88:91]
  ds_read_b128 v[216:219], v225 offset:36864
  v_mfma_f32_16x16x32_bf16 v[92:95], v[148:151], v[172:175], v[92:95]
  ds_read_b128 v[220:223], v225 offset:38912
  v_mfma_f32_16x16x32_bf16 v[96:99], v[152:155], v[172:175], v[96:99]
  v_mfma_f32_16x16x32_bf16 v[100:103], v[156:159], v[172:175], v[100:103]
  v_mfma_f32_16x16x32_bf16 v[104:107], v[160:163], v[172:175], v[104:107]
  v_mfma_f32_16x16x32_bf16 v[108:111], v[136:139], v[176:179], v[108:111]
  v_mfma_f32_16x16x32_bf16 v[112:115], v[140:143], v[176:179], v[112:115]
  v_mfma_f32_16x16x32_bf16 v[116:119], v[144:147], v[176:179], v[116:119]
  v_mfma_f32_16x16x32_bf16 v[120:123], v[148:151], v[176:179], v[120:123]
  v_mfma_f32_16x16x32_bf16 v[124:127], v[152:155], v[176:179], v[124:127]
  v_mfma_f32_16x16x32_bf16 v[128:131], v[156:159], v[176:179], v[128:131]
  v_mfma_f32_16x16x32_bf16 v[132:135], v[160:163], v[176:179], v[132:135]
  s_waitcnt lgkmcnt(0)
  s_barrier
  v_mfma_f32_16x16x32_bf16 v[24:27], v[180:183], v[208:211], v[24:27]
  ds_read_b128 v[164:167], v224 offset:0
  v_mfma_f32_16x16x32_bf16 v[28:31], v[184:187], v[208:211], v[28:31]
  ds_read_b64_tr_b16 v[136:137], v228 offset:0
  v_mfma_f32_16x16x32_bf16 v[32:35], v[188:191], v[208:211], v[32:35]
  ds_read_b64_tr_b16 v[138:139], v228 offset:1792
  v_mfma_f32_16x16x32_bf16 v[36:39], v[192:195], v[208:211], v[36:39]
  ds_read_b64_tr_b16 v[140:141], v229 offset:32
  v_mfma_f32_16x16x32_bf16 v[40:43], v[196:199], v[208:211], v[40:43]
  ds_read_b64_tr_b16 v[142:143], v229 offset:1824
  v_mfma_f32_16x16x32_bf16 v[44:47], v[200:203], v[208:211], v[44:47]
  ds_read_b64_tr_b16 v[144:145], v228 offset:64
  v_mfma_f32_16x16x32_bf16 v[48:51], v[204:207], v[208:211], v[48:51]
  ds_read_b64_tr_b16 v[146:147], v228 offset:1856
  v_mfma_f32_16x16x32_bf16 v[52:55], v[180:183], v[212:215], v[52:55]
  ds_read_b64_tr_b16 v[148:149], v229 offset:96
  v_mfma_f32_16x16x32_bf16 v[56:59], v[184:187], v[212:215], v[56:59]
  ds_read_b64_tr_b16 v[150:151], v229 offset:1888
  v_mfma_f32_16x16x32_bf16 v[60:63], v[188:191], v[212:215], v[60:63]
  ds_read_b64_tr_b16 v[152:153], v228 offset:128
  v_mfma_f32_16x16x32_bf16 v[64:67], v[192:195], v[212:215], v[64:67]
  ds_read_b64_tr_b16 v[154:155], v228 offset:1920
  v_mfma_f32_16x16x32_bf16 v[68:71], v[196:199], v[212:215], v[68:71]
  ds_read_b64_tr_b16 v[156:157], v229 offset:160
  v_mfma_f32_16x16x32_bf16 v[72:75], v[200:203], v[212:215], v[72:75]
  ds_read_b64_tr_b16 v[158:159], v229 offset:1952
  v_mfma_f32_16x16x32_bf16 v[76:79], v[204:207], v[212:215], v[76:79]
  ds_read_b64_tr_b16 v[160:161], v230 offset:0
  v_mfma_f32_16x16x32_bf16 v[80:83], v[180:183], v[216:219], v[80:83]
  ds_read_b64_tr_b16 v[162:163], v230 offset:1792
  v_mfma_f32_16x16x32_bf16 v[84:87], v[184:187], v[216:219], v[84:87]
  ds_read_b128 v[168:171], v224 offset:2048
  v_mfma_f32_16x16x32_bf16 v[88:91], v[188:191], v[216:219], v[88:91]
  ds_read_b128 v[172:175], v224 offset:4096
  v_mfma_f32_16x16x32_bf16 v[92:95], v[192:195], v[216:219], v[92:95]
  ds_read_b128 v[176:179], v224 offset:6144
  v_mfma_f32_16x16x32_bf16 v[96:99], v[196:199], v[216:219], v[96:99]
  v_mfma_f32_16x16x32_bf16 v[100:103], v[200:203], v[216:219], v[100:103]
  v_mfma_f32_16x16x32_bf16 v[104:107], v[204:207], v[216:219], v[104:107]
  v_mfma_f32_16x16x32_bf16 v[108:111], v[180:183], v[220:223], v[108:111]
  v_mfma_f32_16x16x32_bf16 v[112:115], v[184:187], v[220:223], v[112:115]
  v_mfma_f32_16x16x32_bf16 v[116:119], v[188:191], v[220:223], v[116:119]
  v_mfma_f32_16x16x32_bf16 v[120:123], v[192:195], v[220:223], v[120:123]
  v_mfma_f32_16x16x32_bf16 v[124:127], v[196:199], v[220:223], v[124:127]
  v_mfma_f32_16x16x32_bf16 v[128:131], v[200:203], v[220:223], v[128:131]
  v_mfma_f32_16x16x32_bf16 v[132:135], v[204:207], v[220:223], v[132:135]
  s_waitcnt lgkmcnt(0)
  v_mfma_f32_16x16x32_bf16 v[24:27], v[136:139], v[164:167], v[24:27]
  ds_read_b128 v[208:211], v225 offset:0
  v_mfma_f32_16x16x32_bf16 v[28:31], v[140:143], v[164:167], v[28:31]
  ds_read_b64_tr_b16 v[180:181], v228 offset:14336
  v_mfma_f32_16x16x32_bf16 v[32:35], v[144:147], v[164:167], v[32:35]
  ds_read_b64_tr_b16 v[182:183], v228 offset:16128
  v_mfma_f32_16x16x32_bf16 v[36:39], v[148:151], v[164:167], v[36:39]
  ds_read_b64_tr_b16 v[184:185], v229 offset:14368
  v_mfma_f32_16x16x32_bf16 v[40:43], v[152:155], v[164:167], v[40:43]
  ds_read_b64_tr_b16 v[186:187], v229 offset:16160
  v_mfma_f32_16x16x32_bf16 v[44:47], v[156:159], v[164:167], v[44:47]
  ds_read_b64_tr_b16 v[188:189], v228 offset:14400
  v_mfma_f32_16x16x32_bf16 v[48:51], v[160:163], v[164:167], v[48:51]
  ds_read_b64_tr_b16 v[190:191], v228 offset:16192
  v_mfma_f32_16x16x32_bf16 v[52:55], v[136:139], v[168:171], v[52:55]
  ds_read_b64_tr_b16 v[192:193], v229 offset:14432
  v_mfma_f32_16x16x32_bf16 v[56:59], v[140:143], v[168:171], v[56:59]
  ds_read_b64_tr_b16 v[194:195], v229 offset:16224
  v_mfma_f32_16x16x32_bf16 v[60:63], v[144:147], v[168:171], v[60:63]
  ds_read_b64_tr_b16 v[196:197], v228 offset:14464
  v_mfma_f32_16x16x32_bf16 v[64:67], v[148:151], v[168:171], v[64:67]
  ds_read_b64_tr_b16 v[198:199], v228 offset:16256
  v_mfma_f32_16x16x32_bf16 v[68:71], v[152:155], v[168:171], v[68:71]
  ds_read_b64_tr_b16 v[200:201], v229 offset:14496
  v_mfma_f32_16x16x32_bf16 v[72:75], v[156:159], v[168:171], v[72:75]
  ds_read_b64_tr_b16 v[202:203], v229 offset:16288
  v_mfma_f32_16x16x32_bf16 v[76:79], v[160:163], v[168:171], v[76:79]
  ds_read_b64_tr_b16 v[204:205], v230 offset:14336
  v_mfma_f32_16x16x32_bf16 v[80:83], v[136:139], v[172:175], v[80:83]
  ds_read_b64_tr_b16 v[206:207], v230 offset:16128
  v_mfma_f32_16x16x32_bf16 v[84:87], v[140:143], v[172:175], v[84:87]
  ds_read_b128 v[212:215], v225 offset:2048
  v_mfma_f32_16x16x32_bf16 v[88:91], v[144:147], v[172:175], v[88:91]
  ds_read_b128 v[216:219], v225 offset:4096
  v_mfma_f32_16x16x32_bf16 v[92:95], v[148:151], v[172:175], v[92:95]
  ds_read_b128 v[220:223], v225 offset:6144
  v_mfma_f32_16x16x32_bf16 v[96:99], v[152:155], v[172:175], v[96:99]
  v_mfma_f32_16x16x32_bf16 v[100:103], v[156:159], v[172:175], v[100:103]
  v_mfma_f32_16x16x32_bf16 v[104:107], v[160:163], v[172:175], v[104:107]
  v_mfma_f32_16x16x32_bf16 v[108:111], v[136:139], v[176:179], v[108:111]
  v_mfma_f32_16x16x32_bf16 v[112:115], v[140:143], v[176:179], v[112:115]
  v_mfma_f32_16x16x32_bf16 v[116:119], v[144:147], v[176:179], v[116:119]
  v_mfma_f32_16x16x32_bf16 v[120:123], v[148:151], v[176:179], v[120:123]
  v_mfma_f32_16x16x32_bf16 v[124:127], v[152:155], v[176:179], v[124:127]
  v_mfma_f32_16x16x32_bf16 v[128:131], v[156:159], v[176:179], v[128:131]
  v_mfma_f32_16x16x32_bf16 v[132:135], v[160:163], v[176:179], v[132:135]
  s_waitcnt lgkmcnt(0)
  s_barrier
  v_mfma_f32_16x16x32_bf16 v[24:27], v[180:183], v[208:211], v[24:27]
  v_mfma_f32_16x16x32_bf16 v[28:31], v[184:187], v[208:211], v[28:31]
  v_mfma_f32_16x16x32_bf16 v[32:35], v[188:191], v[208:211], v[32:35]
  v_mfma_f32_16x16x32_bf16 v[36:39], v[192:195], v[208:211], v[36:39]
  v_mfma_f32_16x16x32_bf16 v[40:43], v[196:199], v[208:211], v[40:43]
  v_mfma_f32_16x16x32_bf16 v[44:47], v[200:203], v[208:211], v[44:47]
  v_mfma_f32_16x16x32_bf16 v[48:51], v[204:207], v[208:211], v[48:51]
  v_mfma_f32_16x16x32_bf16 v[52:55], v[180:183], v[212:215], v[52:55]
  v_mfma_f32_16x16x32_bf16 v[56:59], v[184:187], v[212:215], v[56:59]
  v_mfma_f32_16x16x32_bf16 v[60:63], v[188:191], v[212:215], v[60:63]
  v_mfma_f32_16x16x32_bf16 v[64:67], v[192:195], v[212:215], v[64:67]
  v_mfma_f32_16x16x32_bf16 v[68:71], v[196:199], v[212:215], v[68:71]
  v_mfma_f32_16x16x32_bf16 v[72:75], v[200:203], v[212:215], v[72:75]
  v_mfma_f32_16x16x32_bf16 v[76:79], v[204:207], v[212:215], v[76:79]
  v_mfma_f32_16x16x32_bf16 v[80:83], v[180:183], v[216:219], v[80:83]
  v_mfma_f32_16x16x32_bf16 v[84:87], v[184:187], v[216:219], v[84:87]
  v_mfma_f32_16x16x32_bf16 v[88:91], v[188:191], v[216:219], v[88:91]
  v_mfma_f32_16x16x32_bf16 v[92:95], v[192:195], v[216:219], v[92:95]
  v_mfma_f32_16x16x32_bf16 v[96:99], v[196:199], v[216:219], v[96:99]
  v_mfma_f32_16x16x32_bf16 v[100:103], v[200:203], v[216:219], v[100:103]
  v_mfma_f32_16x16x32_bf16 v[104:107], v[204:207], v[216:219], v[104:107]
  v_mfma_f32_16x16x32_bf16 v[108:111], v[180:183], v[220:223], v[108:111]
  v_mfma_f32_16x16x32_bf16 v[112:115], v[184:187], v[220:223], v[112:115]
  v_mfma_f32_16x16x32_bf16 v[116:119], v[188:191], v[220:223], v[116:119]
  v_mfma_f32_16x16x32_bf16 v[120:123], v[192:195], v[220:223], v[120:123]
  v_mfma_f32_16x16x32_bf16 v[124:127], v[196:199], v[220:223], v[124:127]
  v_mfma_f32_16x16x32_bf16 v[128:131], v[200:203], v[220:223], v[128:131]
  v_mfma_f32_16x16x32_bf16 v[132:135], v[204:207], v[220:223], v[132:135]
CG_epi1:
  v_mov_b32 v136, 0xc0135761
  v_mov_b32 v137, 0xc0135761
  v_mov_b32 v138, 0xbdd2d3e8
  v_mov_b32 v139, 0xbdd2d3e8
  v_mov_b32 v140, 1.0
  v_mov_b32 v141, 1.0
  s_mul_i32 s20, s24, 3
  s_add_u32 s20, s20, 0
  s_lshr_b32 s37, s20, 1
  s_lshl_b32 s37, s37, 15
  s_and_b32 s20, s20, 1
  s_lshl_b32 s20, s20, 13
  s_add_u32 s37, s37, s20
  s_lshl_b32 s20, s23, 12
  s_add_u32 s37, s37, s20
  v_add_u32 v228, s37, v12
  s_mul_i32 s20, s24, 3
  s_add_u32 s20, s20, 1
  s_lshr_b32 s37, s20, 1
  s_lshl_b32 s37, s37, 15
  s_and_b32 s20, s20, 1
  s_lshl_b32 s20, s20, 13
  s_add_u32 s37, s37, s20
  s_lshl_b32 s20, s23, 12
  s_add_u32 s37, s37, s20
  v_add_u32 v229, s37, v12
  s_mul_i32 s20, s24, 3
  s_add_u32 s20, s20, 2
  s_lshr_b32 s37, s20, 1
  s_lshl_b32 s37, s37, 15
  s_and_b32 s20, s20, 1
  s_lshl_b32 s20, s20, 13
  s_add_u32 s37, s37, s20
  s_lshl_b32 s20, s23, 12
  s_add_u32 s37, s37, s20
  v_add_u32 v230, s37, v12
  s_lshl_b32 s20, s23, 12
  s_lshl_b32 s37, s24, 3
  s_add_u32 s20, s20, s37
  s_add_u32 s20, s20, 98304
  v_add_u32 v231, s20, v12
  s_add_u32 s52, s6, 28311552
  s_addc_u32 s53, s7, 0
  s_mov_b32 s54, 14680064
  s_mov_b32 s55, 0x20000
  s_mul_i32 s37, s21, 917504
  s_mul_i32 s20, s22, 57344
  s_add_u32 s37, s37, s20
  s_mul_i32 s20, s24, 24576
  s_add_u32 s37, s37, s20
  s_lshl_b32 s20, s23, 12
  s_add_u32 s37, s37, s20
  s_add_u32 s37, s37, 16384
  v_pk_mul_f32 v[160:161], v[48:49], v[48:49]
  v_pk_mul_f32 v[162:163], v[50:51], v[50:51]
  v_pk_mul_f32 v[164:165], v[76:77], v[76:77]
  v_pk_mul_f32 v[166:167], v[78:79], v[78:79]
  v_pk_mul_f32 v[168:169], v[104:105], v[104:105]
  v_pk_mul_f32 v[170:171], v[106:107], v[106:107]
  v_pk_mul_f32 v[172:173], v[132:133], v[132:133]
  v_pk_mul_f32 v[174:175], v[134:135], v[134:135]
  v_pk_fma_f32 v[160:161], v[160:161], v[138:139], v[136:137]
  v_pk_fma_f32 v[162:163], v[162:163], v[138:139], v[136:137]
  v_pk_fma_f32 v[164:165], v[164:165], v[138:139], v[136:137]
  v_pk_fma_f32 v[166:167], v[166:167], v[138:139], v[136:137]
  v_pk_fma_f32 v[168:169], v[168:169], v[138:139], v[136:137]
  v_pk_fma_f32 v[170:171], v[170:171], v[138:139], v[136:137]
  v_pk_fma_f32 v[172:173], v[172:173], v[138:139], v[136:137]
  v_pk_fma_f32 v[174:175], v[174:175], v[138:139], v[136:137]
  v_pk_mul_f32 v[160:161], v[160:161], v[48:49]
  v_pk_mul_f32 v[162:163], v[162:163], v[50:51]
  v_pk_mul_f32 v[164:165], v[164:165], v[76:77]
  v_pk_mul_f32 v[166:167], v[166:167], v[78:79]
  v_pk_mul_f32 v[168:169], v[168:169], v[104:105]
  v_pk_mul_f32 v[170:171], v[170:171], v[106:107]
  v_pk_mul_f32 v[172:173], v[172:173], v[132:133]
  v_pk_mul_f32 v[174:175], v[174:175], v[134:135]
  v_exp_f32 v160, v160
  v_exp_f32 v161, v161
  v_exp_f32 v162, v162
  v_exp_f32 v163, v163
  v_exp_f32 v164, v164
  v_exp_f32 v165, v165
  v_exp_f32 v166, v166
  v_exp_f32 v167, v167
  v_exp_f32 v168, v168
  v_exp_f32 v169, v169
  v_exp_f32 v170, v170
  v_exp_f32 v171, v171
  v_exp_f32 v172, v172
  v_exp_f32 v173, v173
  v_exp_f32 v174, v174
  v_exp_f32 v175, v175
  v_pk_add_f32 v[160:161], v[160:161], v[140:141]
  v_pk_add_f32 v[162:163], v[162:163], v[140:141]
  v_pk_add_f32 v[164:165], v[164:165], v[140:141]
  v_pk_add_f32 v[166:167], v[166:167], v[140:141]
  v_pk_add_f32 v[168:169], v[168:169], v[140:141]
  v_pk_add_f32 v[170:171], v[170:171], v[140:141]
  v_pk_add_f32 v[172:173], v[172:173], v[140:141]
  v_pk_add_f32 v[174:175], v[174:175], v[140:141]
  v_rcp_f32 v160, v160
  v_rcp_f32 v161, v161
  v_rcp_f32 v162, v162
  v_rcp_f32 v163, v163
  v_rcp_f32 v164, v164
  v_rcp_f32 v165, v165
  v_rcp_f32 v166, v166
  v_rcp_f32 v167, v167
  v_rcp_f32 v168, v168
  v_rcp_f32 v169, v169
  v_rcp_f32 v170, v170
  v_rcp_f32 v171, v171
  v_rcp_f32 v172, v172
  v_rcp_f32 v173, v173
  v_rcp_f32 v174, v174
  v_rcp_f32 v175, v175
  v_pk_mul_f32 v[160:161], v[160:161], v[48:49]
  v_pk_mul_f32 v[162:163], v[162:163], v[50:51]
  v_pk_mul_f32 v[164:165], v[164:165], v[76:77]
  v_pk_mul_f32 v[166:167], v[166:167], v[78:79]
  v_pk_mul_f32 v[168:169], v[168:169], v[104:105]
  v_pk_mul_f32 v[170:171], v[170:171], v[106:107]
  v_pk_mul_f32 v[172:173], v[172:173], v[132:133]
  v_pk_mul_f32 v[174:175], v[174:175], v[134:135]
  v_cvt_pk_bf16_f32 v160, v160, v161
  v_cvt_pk_bf16_f32 v161, v162, v163
  v_cvt_pk_bf16_f32 v162, v164, v165
  v_cvt_pk_bf16_f32 v163, v166, v167
  v_cvt_pk_bf16_f32 v164, v168, v169
  v_cvt_pk_bf16_f32 v165, v170, v171
  v_cvt_pk_bf16_f32 v166, v172, v173
  v_cvt_pk_bf16_f32 v167, v174, v175
  ds_write_b64 v231, v[160:161] offset:0
  ds_write_b64 v231, v[162:163] offset:1024
  ds_write_b64 v231, v[164:165] offset:2048
  ds_write_b64 v231, v[166:167] offset:3072
  v_pk_mul_f32 v[144:145], v[24:25], v[24:25]
  v_pk_mul_f32 v[146:147], v[26:27], v[26:27]
  v_pk_mul_f32 v[148:149], v[28:29], v[28:29]
  v_pk_mul_f32 v[150:151], v[30:31], v[30:31]
  v_pk_mul_f32 v[152:153], v[52:53], v[52:53]
  v_pk_mul_f32 v[154:155], v[54:55], v[54:55]
  v_pk_mul_f32 v[156:157], v[56:57], v[56:57]
  v_pk_mul_f32 v[158:159], v[58:59], v[58:59]
  v_pk_fma_f32 v[144:145], v[144:145], v[138:139], v[136:137]
  v_pk_fma_f32 v[146:147], v[146:147], v[138:139], v[136:137]
  v_pk_fma_f32 v[148:149], v[148:149], v[138:139], v[136:137]
  v_pk_fma_f32 v[150:151], v[150:151], v[138:139], v[136:137]
  v_pk_fma_f32 v[152:153], v[152:153], v[138:139], v[136:137]
  v_pk_fma_f32 v[154:155], v[154:155], v[138:139], v[136:137]
  v_pk_fma_f32 v[156:157], v[156:157], v[138:139], v[136:137]
  v_pk_fma_f32 v[158:159], v[158:159], v[138:139], v[136:137]
  v_pk_mul_f32 v[144:145], v[144:145], v[24:25]
  v_pk_mul_f32 v[146:147], v[146:147], v[26:27]
  v_pk_mul_f32 v[148:149], v[148:149], v[28:29]
  v_pk_mul_f32 v[150:151], v[150:151], v[30:31]
  v_pk_mul_f32 v[152:153], v[152:153], v[52:53]
  v_pk_mul_f32 v[154:155], v[154:155], v[54:55]
  v_pk_mul_f32 v[156:157], v[156:157], v[56:57]
  v_pk_mul_f32 v[158:159], v[158:159], v[58:59]
  v_exp_f32 v144, v144
  v_exp_f32 v145, v145
  v_exp_f32 v146, v146
  v_exp_f32 v147, v147
  v_exp_f32 v148, v148
  v_exp_f32 v149, v149
  v_exp_f32 v150, v150
  v_exp_f32 v151, v151
  v_exp_f32 v152, v152
  v_exp_f32 v153, v153
  v_exp_f32 v154, v154
  v_exp_f32 v155, v155
  v_exp_f32 v156, v156
  v_exp_f32 v157, v157
  v_exp_f32 v158, v158
  v_exp_f32 v159, v159
  v_pk_add_f32 v[144:145], v[144:145], v[140:141]
  v_pk_add_f32 v[146:147], v[146:147], v[140:141]
  v_pk_add_f32 v[148:149], v[148:149], v[140:141]
  v_pk_add_f32 v[150:151], v[150:151], v[140:141]
  v_pk_add_f32 v[152:153], v[152:153], v[140:141]
  v_pk_add_f32 v[154:155], v[154:155], v[140:141]
  v_pk_add_f32 v[156:157], v[156:157], v[140:141]
  v_pk_add_f32 v[158:159], v[158:159], v[140:141]
  v_rcp_f32 v144, v144
  v_rcp_f32 v145, v145
  v_rcp_f32 v146, v146
  v_rcp_f32 v147, v147
  v_rcp_f32 v148, v148
  v_rcp_f32 v149, v149
  v_rcp_f32 v150, v150
  v_rcp_f32 v151, v151
  v_rcp_f32 v152, v152
  v_rcp_f32 v153, v153
  v_rcp_f32 v154, v154
  v_rcp_f32 v155, v155
  v_rcp_f32 v156, v156
  v_rcp_f32 v157, v157
  v_rcp_f32 v158, v158
  v_rcp_f32 v159, v159
  v_pk_mul_f32 v[144:145], v[144:145], v[24:25]
  v_pk_mul_f32 v[146:147], v[146:147], v[26:27]
  v_pk_mul_f32 v[148:149], v[148:149], v[28:29]
  v_pk_mul_f32 v[150:151], v[150:151], v[30:31]
  v_pk_mul_f32 v[152:153], v[152:153], v[52:53]
  v_pk_mul_f32 v[154:155], v[154:155], v[54:55]
  v_pk_mul_f32 v[156:157], v[156:157], v[56:57]
  v_pk_mul_f32 v[158:159], v[158:159], v[58:59]
  v_cvt_pk_bf16_f32 v144, v144, v145
  v_cvt_pk_bf16_f32 v145, v146, v147
  v_cvt_pk_bf16_f32 v146, v148, v149
  v_cvt_pk_bf16_f32 v147, v150, v151
  v_cvt_pk_bf16_f32 v148, v152, v153
  v_cvt_pk_bf16_f32 v149, v154, v155
  v_cvt_pk_bf16_f32 v150, v156, v157
  v_cvt_pk_bf16_f32 v151, v158, v159
  ds_write_b128 v228, v[144:147] offset:0
  ds_write_b128 v228, v[148:151] offset:1024
  v_pk_mul_f32 v[160:161], v[80:81], v[80:81]
  v_pk_mul_f32 v[162:163], v[82:83], v[82:83]
  v_pk_mul_f32 v[164:165], v[84:85], v[84:85]
  v_pk_mul_f32 v[166:167], v[86:87], v[86:87]
  v_pk_mul_f32 v[168:169], v[108:109], v[108:109]
  v_pk_mul_f32 v[170:171], v[110:111], v[110:111]
  v_pk_mul_f32 v[172:173], v[112:113], v[112:113]
  v_pk_mul_f32 v[174:175], v[114:115], v[114:115]
  v_pk_fma_f32 v[160:161], v[160:161], v[138:139], v[136:137]
  v_pk_fma_f32 v[162:163], v[162:163], v[138:139], v[136:137]
  v_pk_fma_f32 v[164:165], v[164:165], v[138:139], v[136:137]
  v_pk_fma_f32 v[166:167], v[166:167], v[138:139], v[136:137]
  v_pk_fma_f32 v[168:169], v[168:169], v[138:139], v[136:137]
  v_pk_fma_f32 v[170:171], v[170:171], v[138:139], v[136:137]
  v_pk_fma_f32 v[172:173], v[172:173], v[138:139], v[136:137]
  v_pk_fma_f32 v[174:175], v[174:175], v[138:139], v[136:137]
  v_pk_mul_f32 v[160:161], v[160:161], v[80:81]
  v_pk_mul_f32 v[162:163], v[162:163], v[82:83]
  v_pk_mul_f32 v[164:165], v[164:165], v[84:85]
  v_pk_mul_f32 v[166:167], v[166:167], v[86:87]
  v_pk_mul_f32 v[168:169], v[168:169], v[108:109]
  v_pk_mul_f32 v[170:171], v[170:171], v[110:111]
  v_pk_mul_f32 v[172:173], v[172:173], v[112:113]
  v_pk_mul_f32 v[174:175], v[174:175], v[114:115]
  v_exp_f32 v160, v160
  v_exp_f32 v161, v161
  v_exp_f32 v162, v162
  v_exp_f32 v163, v163
  v_exp_f32 v164, v164
  v_exp_f32 v165, v165
  v_exp_f32 v166, v166
  v_exp_f32 v167, v167
  v_exp_f32 v168, v168
  v_exp_f32 v169, v169
  v_exp_f32 v170, v170
  v_exp_f32 v171, v171
  v_exp_f32 v172, v172
  v_exp_f32 v173, v173
  v_exp_f32 v174, v174
  v_exp_f32 v175, v175
  v_pk_add_f32 v[160:161], v[160:161], v[140:141]
  v_pk_add_f32 v[162:163], v[162:163], v[140:141]
  v_pk_add_f32 v[164:165], v[164:165], v[140:141]
  v_pk_add_f32 v[166:167], v[166:167], v[140:141]
  v_pk_add_f32 v[168:169], v[168:169], v[140:141]
  v_pk_add_f32 v[170:171], v[170:171], v[140:141]
  v_pk_add_f32 v[172:173], v[172:173], v[140:141]
  v_pk_add_f32 v[174:175], v[174:175], v[140:141]
  v_rcp_f32 v160, v160
  v_rcp_f32 v161, v161
  v_rcp_f32 v162, v162
  v_rcp_f32 v163, v163
  v_rcp_f32 v164, v164
  v_rcp_f32 v165, v165
  v_rcp_f32 v166, v166
  v_rcp_f32 v167, v167
  v_rcp_f32 v168, v168
  v_rcp_f32 v169, v169
  v_rcp_f32 v170, v170
  v_rcp_f32 v171, v171
  v_rcp_f32 v172, v172
  v_rcp_f32 v173, v173
  v_rcp_f32 v174, v174
  v_rcp_f32 v175, v175
  v_pk_mul_f32 v[160:161], v[160:161], v[80:81]
  v_pk_mul_f32 v[162:163], v[162:163], v[82:83]
  v_pk_mul_f32 v[164:165], v[164:165], v[84:85]
  v_pk_mul_f32 v[166:167], v[166:167], v[86:87]
  v_pk_mul_f32 v[168:169], v[168:169], v[108:109]
  v_pk_mul_f32 v[170:171], v[170:171], v[110:111]
  v_pk_mul_f32 v[172:173], v[172:173], v[112:113]
  v_pk_mul_f32 v[174:175], v[174:175], v[114:115]
  v_cvt_pk_bf16_f32 v160, v160, v161
  v_cvt_pk_bf16_f32 v161, v162, v163
  v_cvt_pk_bf16_f32 v162, v164, v165
  v_cvt_pk_bf16_f32 v163, v166, v167
  v_cvt_pk_bf16_f32 v164, v168, v169
  v_cvt_pk_bf16_f32 v165, v170, v171
  v_cvt_pk_bf16_f32 v166, v172, v173
  v_cvt_pk_bf16_f32 v167, v174, v175
  ds_write_b128 v228, v[160:163] offset:2048
  ds_write_b128 v228, v[164:167] offset:3072
  s_waitcnt lgkmcnt(0)
  s_barrier
  v_pk_mul_f32 v[144:145], v[32:33], v[32:33]
  v_pk_mul_f32 v[146:147], v[34:35], v[34:35]
  v_pk_mul_f32 v[148:149], v[36:37], v[36:37]
  v_pk_mul_f32 v[150:151], v[38:39], v[38:39]
  v_pk_mul_f32 v[152:153], v[60:61], v[60:61]
  v_pk_mul_f32 v[154:155], v[62:63], v[62:63]
  v_pk_mul_f32 v[156:157], v[64:65], v[64:65]
  v_pk_mul_f32 v[158:159], v[66:67], v[66:67]
  v_pk_fma_f32 v[144:145], v[144:145], v[138:139], v[136:137]
  v_pk_fma_f32 v[146:147], v[146:147], v[138:139], v[136:137]
  v_pk_fma_f32 v[148:149], v[148:149], v[138:139], v[136:137]
  v_pk_fma_f32 v[150:151], v[150:151], v[138:139], v[136:137]
  v_pk_fma_f32 v[152:153], v[152:153], v[138:139], v[136:137]
  v_pk_fma_f32 v[154:155], v[154:155], v[138:139], v[136:137]
  v_pk_fma_f32 v[156:157], v[156:157], v[138:139], v[136:137]
  v_pk_fma_f32 v[158:159], v[158:159], v[138:139], v[136:137]
  v_pk_mul_f32 v[144:145], v[144:145], v[32:33]
  v_pk_mul_f32 v[146:147], v[146:147], v[34:35]
  v_pk_mul_f32 v[148:149], v[148:149], v[36:37]
  v_pk_mul_f32 v[150:151], v[150:151], v[38:39]
  v_pk_mul_f32 v[152:153], v[152:153], v[60:61]
  v_pk_mul_f32 v[154:155], v[154:155], v[62:63]
  v_pk_mul_f32 v[156:157], v[156:157], v[64:65]
  v_pk_mul_f32 v[158:159], v[158:159], v[66:67]
  v_exp_f32 v144, v144
  v_exp_f32 v145, v145
  v_exp_f32 v146, v146
  v_exp_f32 v147, v147
  v_exp_f32 v148, v148
  v_exp_f32 v149, v149
  v_exp_f32 v150, v150
  v_exp_f32 v151, v151
  v_exp_f32 v152, v152
  v_exp_f32 v153, v153
  v_exp_f32 v154, v154
  v_exp_f32 v155, v155
  v_exp_f32 v156, v156
  v_exp_f32 v157, v157
  v_exp_f32 v158, v158
  v_exp_f32 v159, v159
  v_pk_add_f32 v[144:145], v[144:145], v[140:141]
  v_pk_add_f32 v[146:147], v[146:147], v[140:141]
  v_pk_add_f32 v[148:149], v[148:149], v[140:141]
  v_pk_add_f32 v[150:151], v[150:151], v[140:141]
  v_pk_add_f32 v[152:153], v[152:153], v[140:141]
  v_pk_add_f32 v[154:155], v[154:155], v[140:141]
  v_pk_add_f32 v[156:157], v[156:157], v[140:141]
  v_pk_add_f32 v[158:159], v[158:159], v[140:141]
  v_rcp_f32 v144, v144
  v_rcp_f32 v145, v145
  v_rcp_f32 v146, v146
  v_rcp_f32 v147, v147
  v_rcp_f32 v148, v148
  v_rcp_f32 v149, v149
  v_rcp_f32 v150, v150
  v_rcp_f32 v151, v151
  v_rcp_f32 v152, v152
  v_rcp_f32 v153, v153
  v_rcp_f32 v154, v154
  v_rcp_f32 v155, v155
  v_rcp_f32 v156, v156
  v_rcp_f32 v157, v157
  v_rcp_f32 v158, v158
  v_rcp_f32 v159, v159
  v_pk_mul_f32 v[144:145], v[144:145], v[32:33]
  v_pk_mul_f32 v[146:147], v[146:147], v[34:35]
  v_pk_mul_f32 v[148:149], v[148:149], v[36:37]
  v_pk_mul_f32 v[150:151], v[150:151], v[38:39]
  v_pk_mul_f32 v[152:153], v[152:153], v[60:61]
  v_pk_mul_f32 v[154:155], v[154:155], v[62:63]
  v_pk_mul_f32 v[156:157], v[156:157], v[64:65]
  v_pk_mul_f32 v[158:159], v[158:159], v[66:67]
  v_cvt_pk_bf16_f32 v144, v144, v145
  v_cvt_pk_bf16_f32 v145, v146, v147
  v_cvt_pk_bf16_f32 v146, v148, v149
  v_cvt_pk_bf16_f32 v147, v150, v151
  v_cvt_pk_bf16_f32 v148, v152, v153
  v_cvt_pk_bf16_f32 v149, v154, v155
  v_cvt_pk_bf16_f32 v150, v156, v157
  v_cvt_pk_bf16_f32 v151, v158, v159
  ds_write_b128 v229, v[144:147] offset:0
  ds_write_b128 v229, v[148:151] offset:1024
  v_pk_mul_f32 v[160:161], v[88:89], v[88:89]
  v_pk_mul_f32 v[162:163], v[90:91], v[90:91]
  v_pk_mul_f32 v[164:165], v[92:93], v[92:93]
  v_pk_mul_f32 v[166:167], v[94:95], v[94:95]
  v_pk_mul_f32 v[168:169], v[116:117], v[116:117]
  v_pk_mul_f32 v[170:171], v[118:119], v[118:119]
  v_pk_mul_f32 v[172:173], v[120:121], v[120:121]
  v_pk_mul_f32 v[174:175], v[122:123], v[122:123]
  v_pk_fma_f32 v[160:161], v[160:161], v[138:139], v[136:137]
  v_pk_fma_f32 v[162:163], v[162:163], v[138:139], v[136:137]
  v_pk_fma_f32 v[164:165], v[164:165], v[138:139], v[136:137]
  v_pk_fma_f32 v[166:167], v[166:167], v[138:139], v[136:137]
  v_pk_fma_f32 v[168:169], v[168:169], v[138:139], v[136:137]
  v_pk_fma_f32 v[170:171], v[170:171], v[138:139], v[136:137]
  v_pk_fma_f32 v[172:173], v[172:173], v[138:139], v[136:137]
  v_pk_fma_f32 v[174:175], v[174:175], v[138:139], v[136:137]
  v_pk_mul_f32 v[160:161], v[160:161], v[88:89]
  v_pk_mul_f32 v[162:163], v[162:163], v[90:91]
  v_pk_mul_f32 v[164:165], v[164:165], v[92:93]
  v_pk_mul_f32 v[166:167], v[166:167], v[94:95]
  v_pk_mul_f32 v[168:169], v[168:169], v[116:117]
  v_pk_mul_f32 v[170:171], v[170:171], v[118:119]
  v_pk_mul_f32 v[172:173], v[172:173], v[120:121]
  v_pk_mul_f32 v[174:175], v[174:175], v[122:123]
  v_exp_f32 v160, v160
  v_exp_f32 v161, v161
  v_exp_f32 v162, v162
  v_exp_f32 v163, v163
  v_exp_f32 v164, v164
  v_exp_f32 v165, v165
  v_exp_f32 v166, v166
  v_exp_f32 v167, v167
  v_exp_f32 v168, v168
  v_exp_f32 v169, v169
  v_exp_f32 v170, v170
  v_exp_f32 v171, v171
  v_exp_f32 v172, v172
  v_exp_f32 v173, v173
  v_exp_f32 v174, v174
  v_exp_f32 v175, v175
  v_pk_add_f32 v[160:161], v[160:161], v[140:141]
  v_pk_add_f32 v[162:163], v[162:163], v[140:141]
  v_pk_add_f32 v[164:165], v[164:165], v[140:141]
  v_pk_add_f32 v[166:167], v[166:167], v[140:141]
  v_pk_add_f32 v[168:169], v[168:169], v[140:141]
  v_pk_add_f32 v[170:171], v[170:171], v[140:141]
  v_pk_add_f32 v[172:173], v[172:173], v[140:141]
  v_pk_add_f32 v[174:175], v[174:175], v[140:141]
  v_rcp_f32 v160, v160
  v_rcp_f32 v161, v161
  v_rcp_f32 v162, v162
  v_rcp_f32 v163, v163
  v_rcp_f32 v164, v164
  v_rcp_f32 v165, v165
  v_rcp_f32 v166, v166
  v_rcp_f32 v167, v167
  v_rcp_f32 v168, v168
  v_rcp_f32 v169, v169
  v_rcp_f32 v170, v170
  v_rcp_f32 v171, v171
  v_rcp_f32 v172, v172
  v_rcp_f32 v173, v173
  v_rcp_f32 v174, v174
  v_rcp_f32 v175, v175
  v_pk_mul_f32 v[160:161], v[160:161], v[88:89]
  v_pk_mul_f32 v[162:163], v[162:163], v[90:91]
  v_pk_mul_f32 v[164:165], v[164:165], v[92:93]
  v_pk_mul_f32 v[166:167], v[166:167], v[94:95]
  v_pk_mul_f32 v[168:169], v[168:169], v[116:117]
  v_pk_mul_f32 v[170:171], v[170:171], v[118:119]
  v_pk_mul_f32 v[172:173], v[172:173], v[120:121]
  v_pk_mul_f32 v[174:175], v[174:175], v[122:123]
  v_cvt_pk_bf16_f32 v160, v160, v161
  v_cvt_pk_bf16_f32 v161, v162, v163
  v_cvt_pk_bf16_f32 v162, v164, v165
  v_cvt_pk_bf16_f32 v163, v166, v167
  v_cvt_pk_bf16_f32 v164, v168, v169
  v_cvt_pk_bf16_f32 v165, v170, v171
  v_cvt_pk_bf16_f32 v166, v172, v173
  v_cvt_pk_bf16_f32 v167, v174, v175
  ds_write_b128 v229, v[160:163] offset:2048
  ds_write_b128 v229, v[164:167] offset:3072
  s_waitcnt lgkmcnt(0)
  s_barrier
  v_pk_mul_f32 v[144:145], v[40:41], v[40:41]
  v_pk_mul_f32 v[146:147], v[42:43], v[42:43]
  v_pk_mul_f32 v[148:149], v[44:45], v[44:45]
  v_pk_mul_f32 v[150:151], v[46:47], v[46:47]
  v_pk_mul_f32 v[152:153], v[68:69], v[68:69]
  v_pk_mul_f32 v[154:155], v[70:71], v[70:71]
  v_pk_mul_f32 v[156:157], v[72:73], v[72:73]
  v_pk_mul_f32 v[158:159], v[74:75], v[74:75]
  v_pk_fma_f32 v[144:145], v[144:145], v[138:139], v[136:137]
  v_pk_fma_f32 v[146:147], v[146:147], v[138:139], v[136:137]
  v_pk_fma_f32 v[148:149], v[148:149], v[138:139], v[136:137]
  v_pk_fma_f32 v[150:151], v[150:151], v[138:139], v[136:137]
  v_pk_fma_f32 v[152:153], v[152:153], v[138:139], v[136:137]
  v_pk_fma_f32 v[154:155], v[154:155], v[138:139], v[136:137]
  v_pk_fma_f32 v[156:157], v[156:157], v[138:139], v[136:137]
  v_pk_fma_f32 v[158:159], v[158:159], v[138:139], v[136:137]
  v_pk_mul_f32 v[144:145], v[144:145], v[40:41]
  v_pk_mul_f32 v[146:147], v[146:147], v[42:43]
  v_pk_mul_f32 v[148:149], v[148:149], v[44:45]
  v_pk_mul_f32 v[150:151], v[150:151], v[46:47]
  v_pk_mul_f32 v[152:153], v[152:153], v[68:69]
  v_pk_mul_f32 v[154:155], v[154:155], v[70:71]
  v_pk_mul_f32 v[156:157], v[156:157], v[72:73]
  v_pk_mul_f32 v[158:159], v[158:159], v[74:75]
  v_exp_f32 v144, v144
  v_exp_f32 v145, v145
  v_exp_f32 v146, v146
  v_exp_f32 v147, v147
  v_exp_f32 v148, v148
  v_exp_f32 v149, v149
  v_exp_f32 v150, v150
  v_exp_f32 v151, v151
  v_exp_f32 v152, v152
  v_exp_f32 v153, v153
  v_exp_f32 v154, v154
  v_exp_f32 v155, v155
  v_exp_f32 v156, v156
  v_exp_f32 v157, v157
  v_exp_f32 v158, v158
  v_exp_f32 v159, v159
  v_pk_add_f32 v[144:145], v[144:145], v[140:141]
  v_pk_add_f32 v[146:147], v[146:147], v[140:141]
  v_pk_add_f32 v[148:149], v[148:149], v[140:141]
  v_pk_add_f32 v[150:151], v[150:151], v[140:141]
  v_pk_add_f32 v[152:153], v[152:153], v[140:141]
  v_pk_add_f32 v[154:155], v[154:155], v[140:141]
  v_pk_add_f32 v[156:157], v[156:157], v[140:141]
  v_pk_add_f32 v[158:159], v[158:159], v[140:141]
  v_rcp_f32 v144, v144
  v_rcp_f32 v145, v145
  v_rcp_f32 v146, v146
  v_rcp_f32 v147, v147
  v_rcp_f32 v148, v148
  v_rcp_f32 v149, v149
  v_rcp_f32 v150, v150
  v_rcp_f32 v151, v151
  v_rcp_f32 v152, v152
  v_rcp_f32 v153, v153
  v_rcp_f32 v154, v154
  v_rcp_f32 v155, v155
  v_rcp_f32 v156, v156
  v_rcp_f32 v157, v157
  v_rcp_f32 v158, v158
  v_rcp_f32 v159, v159
  v_pk_mul_f32 v[144:145], v[144:145], v[40:41]
  v_pk_mul_f32 v[146:147], v[146:147], v[42:43]
  v_pk_mul_f32 v[148:149], v[148:149], v[44:45]
  v_pk_mul_f32 v[150:151], v[150:151], v[46:47]
  v_pk_mul_f32 v[152:153], v[152:153], v[68:69]
  v_pk_mul_f32 v[154:155], v[154:155], v[70:71]
  v_pk_mul_f32 v[156:157], v[156:157], v[72:73]
  v_pk_mul_f32 v[158:159], v[158:159], v[74:75]
  v_cvt_pk_bf16_f32 v144, v144, v145
  v_cvt_pk_bf16_f32 v145, v146, v147
  v_cvt_pk_bf16_f32 v146, v148, v149
  v_cvt_pk_bf16_f32 v147, v150, v151
  v_cvt_pk_bf16_f32 v148, v152, v153
  v_cvt_pk_bf16_f32 v149, v154, v155
  v_cvt_pk_bf16_f32 v150, v156, v157
  v_cvt_pk_bf16_f32 v151, v158, v159
  ds_write_b128 v230, v[144:147] offset:0
  buffer_store_dwordx4 v[144:147], v12, s[52:55], s37 offen offset:0 sc1
  ds_write_b128 v230, v[148:151] offset:1024
  buffer_store_dwordx4 v[148:151], v12, s[52:55], s37 offen offset:1024 sc1
  v_pk_mul_f32 v[160:161], v[96:97], v[96:97]
  v_pk_mul_f32 v[162:163], v[98:99], v[98:99]
  v_pk_mul_f32 v[164:165], v[100:101], v[100:101]
  v_pk_mul_f32 v[166:167], v[102:103], v[102:103]
  v_pk_mul_f32 v[168:169], v[124:125], v[124:125]
  v_pk_mul_f32 v[170:171], v[126:127], v[126:127]
  v_pk_mul_f32 v[172:173], v[128:129], v[128:129]
  v_pk_mul_f32 v[174:175], v[130:131], v[130:131]
  v_pk_fma_f32 v[160:161], v[160:161], v[138:139], v[136:137]
  v_pk_fma_f32 v[162:163], v[162:163], v[138:139], v[136:137]
  v_pk_fma_f32 v[164:165], v[164:165], v[138:139], v[136:137]
  v_pk_fma_f32 v[166:167], v[166:167], v[138:139], v[136:137]
  v_pk_fma_f32 v[168:169], v[168:169], v[138:139], v[136:137]
  v_pk_fma_f32 v[170:171], v[170:171], v[138:139], v[136:137]
  v_pk_fma_f32 v[172:173], v[172:173], v[138:139], v[136:137]
  v_pk_fma_f32 v[174:175], v[174:175], v[138:139], v[136:137]
  v_pk_mul_f32 v[160:161], v[160:161], v[96:97]
  v_pk_mul_f32 v[162:163], v[162:163], v[98:99]
  v_pk_mul_f32 v[164:165], v[164:165], v[100:101]
  v_pk_mul_f32 v[166:167], v[166:167], v[102:103]
  v_pk_mul_f32 v[168:169], v[168:169], v[124:125]
  v_pk_mul_f32 v[170:171], v[170:171], v[126:127]
  v_pk_mul_f32 v[172:173], v[172:173], v[128:129]
  v_pk_mul_f32 v[174:175], v[174:175], v[130:131]
  v_exp_f32 v160, v160
  v_exp_f32 v161, v161
  v_exp_f32 v162, v162
  v_exp_f32 v163, v163
  v_exp_f32 v164, v164
  v_exp_f32 v165, v165
  v_exp_f32 v166, v166
  v_exp_f32 v167, v167
  v_exp_f32 v168, v168
  v_exp_f32 v169, v169
  v_exp_f32 v170, v170
  v_exp_f32 v171, v171
  v_exp_f32 v172, v172
  v_exp_f32 v173, v173
  v_exp_f32 v174, v174
  v_exp_f32 v175, v175
  v_pk_add_f32 v[160:161], v[160:161], v[140:141]
  v_pk_add_f32 v[162:163], v[162:163], v[140:141]
  v_pk_add_f32 v[164:165], v[164:165], v[140:141]
  v_pk_add_f32 v[166:167], v[166:167], v[140:141]
  v_pk_add_f32 v[168:169], v[168:169], v[140:141]
  v_pk_add_f32 v[170:171], v[170:171], v[140:141]
  v_pk_add_f32 v[172:173], v[172:173], v[140:141]
  v_pk_add_f32 v[174:175], v[174:175], v[140:141]
  v_rcp_f32 v160, v160
  v_rcp_f32 v161, v161
  v_rcp_f32 v162, v162
  v_rcp_f32 v163, v163
  v_rcp_f32 v164, v164
  v_rcp_f32 v165, v165
  v_rcp_f32 v166, v166
  v_rcp_f32 v167, v167
  v_rcp_f32 v168, v168
  v_rcp_f32 v169, v169
  v_rcp_f32 v170, v170
  v_rcp_f32 v171, v171
  v_rcp_f32 v172, v172
  v_rcp_f32 v173, v173
  v_rcp_f32 v174, v174
  v_rcp_f32 v175, v175
  v_pk_mul_f32 v[160:161], v[160:161], v[96:97]
  v_pk_mul_f32 v[162:163], v[162:163], v[98:99]
  v_pk_mul_f32 v[164:165], v[164:165], v[100:101]
  v_pk_mul_f32 v[166:167], v[166:167], v[102:103]
  v_pk_mul_f32 v[168:169], v[168:169], v[124:125]
  v_pk_mul_f32 v[170:171], v[170:171], v[126:127]
  v_pk_mul_f32 v[172:173], v[172:173], v[128:129]
  v_pk_mul_f32 v[174:175], v[174:175], v[130:131]
  v_cvt_pk_bf16_f32 v160, v160, v161
  v_cvt_pk_bf16_f32 v161, v162, v163
  v_cvt_pk_bf16_f32 v162, v164, v165
  v_cvt_pk_bf16_f32 v163, v166, v167
  v_cvt_pk_bf16_f32 v164, v168, v169
  v_cvt_pk_bf16_f32 v165, v170, v171
  v_cvt_pk_bf16_f32 v166, v172, v173
  v_cvt_pk_bf16_f32 v167, v174, v175
  ds_write_b128 v230, v[160:163] offset:2048
  buffer_store_dwordx4 v[160:163], v12, s[52:55], s37 offen offset:2048 sc1
  ds_write_b128 v230, v[164:167] offset:3072
  buffer_store_dwordx4 v[164:167], v12, s[52:55], s37 offen offset:3072 sc1
  s_lshr_b32 s37, s22, 3
  s_and_b32 s38, s22, 7
  s_xor_b32 s20, s37, 0
  s_lshl_b32 s20, s20, 11
  s_lshl_b32 s38, s23, 12
  s_add_u32 s20, s20, s38
  v_add_u32 v88, s20, v12
  s_xor_b32 s20, s37, 1
  s_lshl_b32 s20, s20, 11
  s_lshl_b32 s38, s23, 12
  s_add_u32 s20, s20, s38
  v_add_u32 v89, s20, v12
  v_lshrrev_b32 v4, 2, v1
  v_and_b32 v5, 7, v4
  v_lshlrev_b32 v4, 8, v4
  v_and_b32 v6, 3, v2
  v_lshl_add_u32 v4, v6, 3, v4
  v_add_u32 v4, 16384, v4
  s_lshl_b32 s20, s24, 2
  v_xor_b32 v5, s20, v5
  v_xor_b32 v6, 0, v5
  v_lshl_add_u32 v96, v6, 5, v4
  v_xor_b32 v6, 1, v5
  v_lshl_add_u32 v97, v6, 5, v4
  v_xor_b32 v6, 2, v5
  v_lshl_add_u32 v98, v6, 5, v4
  v_xor_b32 v6, 3, v5
  v_lshl_add_u32 v99, v6, 5, v4
  s_waitcnt lgkmcnt(0)
  s_barrier
  ds_read_b128 v[132:135], v88 offset:0
  ds_read_b64_tr_b16 v[116:117], v96 offset:0
  ds_read_b64_tr_b16 v[118:119], v96 offset:4096
  ds_read_b64_tr_b16 v[120:121], v97 offset:0
  ds_read_b64_tr_b16 v[122:123], v97 offset:4096
  ds_read_b64_tr_b16 v[124:125], v98 offset:0
  ds_read_b64_tr_b16 v[126:127], v98 offset:4096
  ds_read_b64_tr_b16 v[128:129], v99 offset:0
  ds_read_b64_tr_b16 v[130:131], v99 offset:4096
  ds_read_b128 v[136:139], v88 offset:1024
  ds_read_b128 v[140:143], v89 offset:0
  ds_read_b128 v[144:147], v89 offset:1024
  s_waitcnt lgkmcnt(0)
  v_mfma_f32_16x16x32_bf16 v[24:27], v[116:119], v[132:135], 0
  ds_read_b128 v[164:167], v88 offset:8192
  v_mfma_f32_16x16x32_bf16 v[28:31], v[120:123], v[132:135], 0
  ds_read_b64_tr_b16 v[148:149], v96 offset:8192
  v_mfma_f32_16x16x32_bf16 v[32:35], v[124:127], v[132:135], 0
  ds_read_b64_tr_b16 v[150:151], v96 offset:12288
  v_mfma_f32_16x16x32_bf16 v[36:39], v[128:131], v[132:135], 0
  ds_read_b64_tr_b16 v[152:153], v97 offset:8192
  v_mfma_f32_16x16x32_bf16 v[40:43], v[116:119], v[136:139], 0
  ds_read_b64_tr_b16 v[154:155], v97 offset:12288
  v_mfma_f32_16x16x32_bf16 v[44:47], v[120:123], v[136:139], 0
  ds_read_b64_tr_b16 v[156:157], v98 offset:8192
  v_mfma_f32_16x16x32_bf16 v[48:51], v[124:127], v[136:139], 0
  ds_read_b64_tr_b16 v[158:159], v98 offset:12288
  v_mfma_f32_16x16x32_bf16 v[52:55], v[128:131], v[136:139], 0
  ds_read_b64_tr_b16 v[160:161], v99 offset:8192
  v_mfma_f32_16x16x32_bf16 v[56:59], v[116:119], v[140:143], 0
  ds_read_b64_tr_b16 v[162:163], v99 offset:12288
  v_mfma_f32_16x16x32_bf16 v[60:63], v[120:123], v[140:143], 0
  ds_read_b128 v[168:171], v88 offset:9216
  v_mfma_f32_16x16x32_bf16 v[64:67], v[124:127], v[140:143], 0
  ds_read_b128 v[172:175], v89 offset:8192
  v_mfma_f32_16x16x32_bf16 v[68:71], v[128:131], v[140:143], 0
  ds_read_b128 v[176:179], v89 offset:9216
  v_mfma_f32_16x16x32_bf16 v[72:75], v[116:119], v[144:147], 0
  v_add_u32 v90, 65536, v88
  v_add_u32 v91, 65536, v89
  v_mfma_f32_16x16x32_bf16 v[76:79], v[120:123], v[144:147], 0
  v_add_u32 v100, 65536, v96
  v_add_u32 v101, 65536, v97
  v_mfma_f32_16x16x32_bf16 v[80:83], v[124:127], v[144:147], 0
  v_add_u32 v102, 65536, v98
  v_add_u32 v103, 65536, v99
  v_mfma_f32_16x16x32_bf16 v[84:87], v[128:131], v[144:147], 0
  v_add_u32 v92, 131072, v88
  v_add_u32 v93, 131072, v89
  s_waitcnt lgkmcnt(0)
  s_barrier
  v_mfma_f32_16x16x32_bf16 v[24:27], v[148:151], v[164:167], v[24:27]
  ds_read_b128 v[132:135], v88 offset:32768
  v_mfma_f32_16x16x32_bf16 v[28:31], v[152:155], v[164:167], v[28:31]
  ds_read_b64_tr_b16 v[116:117], v96 offset:32768
  v_mfma_f32_16x16x32_bf16 v[32:35], v[156:159], v[164:167], v[32:35]
  ds_read_b64_tr_b16 v[118:119], v96 offset:36864
  v_mfma_f32_16x16x32_bf16 v[36:39], v[160:163], v[164:167], v[36:39]
  ds_read_b64_tr_b16 v[120:121], v97 offset:32768
  v_mfma_f32_16x16x32_bf16 v[40:43], v[148:151], v[168:171], v[40:43]
  ds_read_b64_tr_b16 v[122:123], v97 offset:36864
  v_mfma_f32_16x16x32_bf16 v[44:47], v[152:155], v[168:171], v[44:47]
  ds_read_b64_tr_b16 v[124:125], v98 offset:32768
  v_mfma_f32_16x16x32_bf16 v[48:51], v[156:159], v[168:171], v[48:51]
  ds_read_b64_tr_b16 v[126:127], v98 offset:36864
  v_mfma_f32_16x16x32_bf16 v[52:55], v[160:163], v[168:171], v[52:55]
  ds_read_b64_tr_b16 v[128:129], v99 offset:32768
  v_mfma_f32_16x16x32_bf16 v[56:59], v[148:151], v[172:175], v[56:59]
  ds_read_b64_tr_b16 v[130:131], v99 offset:36864
  v_mfma_f32_16x16x32_bf16 v[60:63], v[152:155], v[172:175], v[60:63]
  ds_read_b128 v[136:139], v88 offset:33792
  v_mfma_f32_16x16x32_bf16 v[64:67], v[156:159], v[172:175], v[64:67]
  ds_read_b128 v[140:143], v89 offset:32768
  v_mfma_f32_16x16x32_bf16 v[68:71], v[160:163], v[172:175], v[68:71]
  ds_read_b128 v[144:147], v89 offset:33792
  v_mfma_f32_16x16x32_bf16 v[72:75], v[148:151], v[176:179], v[72:75]
  v_mfma_f32_16x16x32_bf16 v[76:79], v[152:155], v[176:179], v[76:79]
  v_mfma_f32_16x16x32_bf16 v[80:83], v[156:159], v[176:179], v[80:83]
  v_mfma_f32_16x16x32_bf16 v[84:87], v[160:163], v[176:179], v[84:87]
  s_waitcnt lgkmcnt(0)
  v_mfma_f32_16x16x32_bf16 v[24:27], v[116:119], v[132:135], v[24:27]
  ds_read_b128 v[164:167], v88 offset:40960
  v_mfma_f32_16x16x32_bf16 v[28:31], v[120:123], v[132:135], v[28:31]
  ds_read_b64_tr_b16 v[148:149], v96 offset:40960
  v_mfma_f32_16x16x32_bf16 v[32:35], v[124:127], v[132:135], v[32:35]
  ds_read_b64_tr_b16 v[150:151], v96 offset:45056
  v_mfma_f32_16x16x32_bf16 v[36:39], v[128:131], v[132:135], v[36:39]
  ds_read_b64_tr_b16 v[152:153], v97 offset:40960
  v_mfma_f32_16x16x32_bf16 v[40:43], v[116:119], v[136:139], v[40:43]
  ds_read_b64_tr_b16 v[154:155], v97 offset:45056
  v_mfma_f32_16x16x32_bf16 v[44:47], v[120:123], v[136:139], v[44:47]
  ds_read_b64_tr_b16 v[156:157], v98 offset:40960
  v_mfma_f32_16x16x32_bf16 v[48:51], v[124:127], v[136:139], v[48:51]
  ds_read_b64_tr_b16 v[158:159], v98 offset:45056
  v_mfma_f32_16x16x32_bf16 v[52:55], v[128:131], v[136:139], v[52:55]
  ds_read_b64_tr_b16 v[160:161], v99 offset:40960
  v_mfma_f32_16x16x32_bf16 v[56:59], v[116:119], v[140:143], v[56:59]
  ds_read_b64_tr_b16 v[162:163], v99 offset:45056
  v_mfma_f32_16x16x32_bf16 v[60:63], v[120:123], v[140:143], v[60:63]
  ds_read_b128 v[168:171], v88 offset:41984
  v_mfma_f32_16x16x32_bf16 v[64:67], v[124:127], v[140:143], v[64:67]
  ds_read_b128 v[172:175], v89 offset:40960
  v_mfma_f32_16x16x32_bf16 v[68:71], v[128:131], v[140:143], v[68:71]
  ds_read_b128 v[176:179], v89 offset:41984
  v_mfma_f32_16x16x32_bf16 v[72:75], v[116:119], v[144:147], v[72:75]
  v_add_u32 v104, 131072, v96
  v_add_u32 v105, 131072, v97
  v_mfma_f32_16x16x32_bf16 v[76:79], v[120:123], v[144:147], v[76:79]
  v_add_u32 v106, 131072, v98
  v_add_u32 v107, 131072, v99
  v_mfma_f32_16x16x32_bf16 v[80:83], v[124:127], v[144:147], v[80:83]
  v_and_b32 v4, 1, v3
  v_lshlrev_b32 v4, 5, v4
  v_mfma_f32_16x16x32_bf16 v[84:87], v[128:131], v[144:147], v[84:87]
  v_lshrrev_b32 v5, 1, v3
  v_lshl_add_u32 v110, v5, 4, v4
  s_waitcnt lgkmcnt(0)
  s_barrier
  v_mfma_f32_16x16x32_bf16 v[24:27], v[148:151], v[164:167], v[24:27]
  ds_read_b128 v[132:135], v90 offset:0
  v_mfma_f32_16x16x32_bf16 v[28:31], v[152:155], v[164:167], v[28:31]
  ds_read_b64_tr_b16 v[116:117], v100 offset:0
  v_mfma_f32_16x16x32_bf16 v[32:35], v[156:159], v[164:167], v[32:35]
  ds_read_b64_tr_b16 v[118:119], v100 offset:4096
  v_mfma_f32_16x16x32_bf16 v[36:39], v[160:163], v[164:167], v[36:39]
  ds_read_b64_tr_b16 v[120:121], v101 offset:0
  v_mfma_f32_16x16x32_bf16 v[40:43], v[148:151], v[168:171], v[40:43]
  ds_read_b64_tr_b16 v[122:123], v101 offset:4096
  v_mfma_f32_16x16x32_bf16 v[44:47], v[152:155], v[168:171], v[44:47]
  ds_read_b64_tr_b16 v[124:125], v102 offset:0
  v_mfma_f32_16x16x32_bf16 v[48:51], v[156:159], v[168:171], v[48:51]
  ds_read_b64_tr_b16 v[126:127], v102 offset:4096
  v_mfma_f32_16x16x32_bf16 v[52:55], v[160:163], v[168:171], v[52:55]
  ds_read_b64_tr_b16 v[128:129], v103 offset:0
  v_mfma_f32_16x16x32_bf16 v[56:59], v[148:151], v[172:175], v[56:59]
  ds_read_b64_tr_b16 v[130:131], v103 offset:4096
  v_mfma_f32_16x16x32_bf16 v[60:63], v[152:155], v[172:175], v[60:63]
  ds_read_b128 v[136:139], v90 offset:1024
  v_mfma_f32_16x16x32_bf16 v[64:67], v[156:159], v[172:175], v[64:67]
  ds_read_b128 v[140:143], v91 offset:0
  v_mfma_f32_16x16x32_bf16 v[68:71], v[160:163], v[172:175], v[68:71]
  ds_read_b128 v[144:147], v91 offset:1024
  v_mfma_f32_16x16x32_bf16 v[72:75], v[148:151], v[176:179], v[72:75]
  v_mfma_f32_16x16x32_bf16 v[76:79], v[152:155], v[176:179], v[76:79]
  v_mfma_f32_16x16x32_bf16 v[80:83], v[156:159], v[176:179], v[80:83]
  v_mfma_f32_16x16x32_bf16 v[84:87], v[160:163], v[176:179], v[84:87]
  s_waitcnt lgkmcnt(0)
  s_lshl_b32 s42, s21, 1
  s_add_u32 s42, s42, s37
  s_lshl_b32 s42, s42, 13
  s_and_b32 s39, s22, 7
  s_lshl_b32 s39, s39, 2
  s_add_u32 s39, s39, s18
  s_lshl_b32 s39, s39, 7
  s_add_u32 s42, s42, s39
  s_add_u32 s42, s42, 790528
  s_waitcnt vmcnt(0)
  v_and_b32 v8, 31, v1
  v_lshlrev_b32 v8, 2, v8
  v_mov_b32 v9, s36
  buffer_store_dword v9, v8, s[32:35], s42 offen sc1
  v_mfma_f32_16x16x32_bf16 v[24:27], v[116:119], v[132:135], v[24:27]
  ds_read_b128 v[164:167], v90 offset:8192
  v_mfma_f32_16x16x32_bf16 v[28:31], v[120:123], v[132:135], v[28:31]
  ds_read_b64_tr_b16 v[148:149], v100 offset:8192
  v_mfma_f32_16x16x32_bf16 v[32:35], v[124:127], v[132:135], v[32:35]
  ds_read_b64_tr_b16 v[150:151], v100 offset:12288
  v_mfma_f32_16x16x32_bf16 v[36:39], v[128:131], v[132:135], v[36:39]
  ds_read_b64_tr_b16 v[152:153], v101 offset:8192
  v_mfma_f32_16x16x32_bf16 v[40:43], v[116:119], v[136:139], v[40:43]
  ds_read_b64_tr_b16 v[154:155], v101 offset:12288
  v_mfma_f32_16x16x32_bf16 v[44:47], v[120:123], v[136:139], v[44:47]
  ds_read_b64_tr_b16 v[156:157], v102 offset:8192
  v_mfma_f32_16x16x32_bf16 v[48:51], v[124:127], v[136:139], v[48:51]
  ds_read_b64_tr_b16 v[158:159], v102 offset:12288
  v_mfma_f32_16x16x32_bf16 v[52:55], v[128:131], v[136:139], v[52:55]
  ds_read_b64_tr_b16 v[160:161], v103 offset:8192
  v_mfma_f32_16x16x32_bf16 v[56:59], v[116:119], v[140:143], v[56:59]
  ds_read_b64_tr_b16 v[162:163], v103 offset:12288
  v_mfma_f32_16x16x32_bf16 v[60:63], v[120:123], v[140:143], v[60:63]
  ds_read_b128 v[168:171], v90 offset:9216
  v_mfma_f32_16x16x32_bf16 v[64:67], v[124:127], v[140:143], v[64:67]
  ds_read_b128 v[172:175], v91 offset:8192
  v_mfma_f32_16x16x32_bf16 v[68:71], v[128:131], v[140:143], v[68:71]
  ds_read_b128 v[176:179], v91 offset:9216
  v_mfma_f32_16x16x32_bf16 v[72:75], v[116:119], v[144:147], v[72:75]
  v_lshl_add_u32 v108, v2, 11, v110
  v_and_b32 v4, 7, v2
  v_mfma_f32_16x16x32_bf16 v[76:79], v[120:123], v[144:147], v[76:79]
  v_lshlrev_b32 v4, 19, v4
  v_lshrrev_b32 v5, 3, v2
  v_mfma_f32_16x16x32_bf16 v[80:83], v[124:127], v[144:147], v[80:83]
  v_lshl_add_u32 v4, v5, 11, v4
  v_add_u32 v109, v4, v110
  v_mfma_f32_16x16x32_bf16 v[84:87], v[128:131], v[144:147], v[84:87]
  v_add_u32 v111, 4096, v12
  s_mov_b32 s48, s14
  s_waitcnt lgkmcnt(0)
  s_barrier
  v_mfma_f32_16x16x32_bf16 v[24:27], v[148:151], v[164:167], v[24:27]
  ds_read_b128 v[132:135], v90 offset:32768
  v_mfma_f32_16x16x32_bf16 v[28:31], v[152:155], v[164:167], v[28:31]
  ds_read_b64_tr_b16 v[116:117], v100 offset:32768
  v_mfma_f32_16x16x32_bf16 v[32:35], v[156:159], v[164:167], v[32:35]
  ds_read_b64_tr_b16 v[118:119], v100 offset:36864
  v_mfma_f32_16x16x32_bf16 v[36:39], v[160:163], v[164:167], v[36:39]
  ds_read_b64_tr_b16 v[120:121], v101 offset:32768
  v_mfma_f32_16x16x32_bf16 v[40:43], v[148:151], v[168:171], v[40:43]
  ds_read_b64_tr_b16 v[122:123], v101 offset:36864
  v_mfma_f32_16x16x32_bf16 v[44:47], v[152:155], v[168:171], v[44:47]
  ds_read_b64_tr_b16 v[124:125], v102 offset:32768
  v_mfma_f32_16x16x32_bf16 v[48:51], v[156:159], v[168:171], v[48:51]
  ds_read_b64_tr_b16 v[126:127], v102 offset:36864
  v_mfma_f32_16x16x32_bf16 v[52:55], v[160:163], v[168:171], v[52:55]
  ds_read_b64_tr_b16 v[128:129], v103 offset:32768
  v_mfma_f32_16x16x32_bf16 v[56:59], v[148:151], v[172:175], v[56:59]
  ds_read_b64_tr_b16 v[130:131], v103 offset:36864
  v_mfma_f32_16x16x32_bf16 v[60:63], v[152:155], v[172:175], v[60:63]
  ds_read_b128 v[136:139], v90 offset:33792
  v_mfma_f32_16x16x32_bf16 v[64:67], v[156:159], v[172:175], v[64:67]
  ds_read_b128 v[140:143], v91 offset:32768
  v_mfma_f32_16x16x32_bf16 v[68:71], v[160:163], v[172:175], v[68:71]
  ds_read_b128 v[144:147], v91 offset:33792
  v_mfma_f32_16x16x32_bf16 v[72:75], v[148:151], v[176:179], v[72:75]
  v_mfma_f32_16x16x32_bf16 v[76:79], v[152:155], v[176:179], v[76:79]
  v_mfma_f32_16x16x32_bf16 v[80:83], v[156:159], v[176:179], v[80:83]
  v_mfma_f32_16x16x32_bf16 v[84:87], v[160:163], v[176:179], v[84:87]
  s_waitcnt lgkmcnt(0)
  v_mfma_f32_16x16x32_bf16 v[24:27], v[116:119], v[132:135], v[24:27]
  ds_read_b128 v[164:167], v90 offset:40960
  v_mfma_f32_16x16x32_bf16 v[28:31], v[120:123], v[132:135], v[28:31]
  ds_read_b64_tr_b16 v[148:149], v100 offset:40960
  v_mfma_f32_16x16x32_bf16 v[32:35], v[124:127], v[132:135], v[32:35]
  ds_read_b64_tr_b16 v[150:151], v100 offset:45056
  v_mfma_f32_16x16x32_bf16 v[36:39], v[128:131], v[132:135], v[36:39]
  ds_read_b64_tr_b16 v[152:153], v101 offset:40960
  v_mfma_f32_16x16x32_bf16 v[40:43], v[116:119], v[136:139], v[40:43]
  ds_read_b64_tr_b16 v[154:155], v101 offset:45056
  v_mfma_f32_16x16x32_bf16 v[44:47], v[120:123], v[136:139], v[44:47]
  ds_read_b64_tr_b16 v[156:157], v102 offset:40960
  v_mfma_f32_16x16x32_bf16 v[48:51], v[124:127], v[136:139], v[48:51]
  ds_read_b64_tr_b16 v[158:159], v102 offset:45056
  v_mfma_f32_16x16x32_bf16 v[52:55], v[128:131], v[136:139], v[52:55]
  ds_read_b64_tr_b16 v[160:161], v103 offset:40960
  v_mfma_f32_16x16x32_bf16 v[56:59], v[116:119], v[140:143], v[56:59]
  ds_read_b64_tr_b16 v[162:163], v103 offset:45056
  v_mfma_f32_16x16x32_bf16 v[60:63], v[120:123], v[140:143], v[60:63]
  ds_read_b128 v[168:171], v90 offset:41984
  v_mfma_f32_16x16x32_bf16 v[64:67], v[124:127], v[140:143], v[64:67]
  ds_read_b128 v[172:175], v91 offset:40960
  v_mfma_f32_16x16x32_bf16 v[68:71], v[128:131], v[140:143], v[68:71]
  ds_read_b128 v[176:179], v91 offset:41984
  v_mfma_f32_16x16x32_bf16 v[72:75], v[116:119], v[144:147], v[72:75]
  s_mov_b32 s49, s15
  s_mov_b32 s50, 2048
  v_mfma_f32_16x16x32_bf16 v[76:79], v[120:123], v[144:147], v[76:79]
  s_mov_b32 s51, 0x20000
  s_add_u32 s52, s6, 98304
  v_mfma_f32_16x16x32_bf16 v[80:83], v[124:127], v[144:147], v[80:83]
  s_addc_u32 s53, s7, 0
  s_mov_b32 s54, 2048
  v_mfma_f32_16x16x32_bf16 v[84:87], v[128:131], v[144:147], v[84:87]
  s_mov_b32 s55, 0x20000
  s_add_u32 s56, s6, 19922944
  s_waitcnt lgkmcnt(0)
  s_barrier
  v_mfma_f32_16x16x32_bf16 v[24:27], v[148:151], v[164:167], v[24:27]
  ds_read_b128 v[132:135], v92 offset:0
  v_mfma_f32_16x16x32_bf16 v[28:31], v[152:155], v[164:167], v[28:31]
  ds_read_b64_tr_b16 v[116:117], v104 offset:0
  v_mfma_f32_16x16x32_bf16 v[32:35], v[156:159], v[164:167], v[32:35]
  ds_read_b64_tr_b16 v[118:119], v104 offset:4096
  v_mfma_f32_16x16x32_bf16 v[36:39], v[160:163], v[164:167], v[36:39]
  ds_read_b64_tr_b16 v[120:121], v105 offset:0
  v_mfma_f32_16x16x32_bf16 v[40:43], v[148:151], v[168:171], v[40:43]
  ds_read_b64_tr_b16 v[122:123], v105 offset:4096
  v_mfma_f32_16x16x32_bf16 v[44:47], v[152:155], v[168:171], v[44:47]
  ds_read_b64_tr_b16 v[124:125], v106 offset:0
  v_mfma_f32_16x16x32_bf16 v[48:51], v[156:159], v[168:171], v[48:51]
  ds_read_b64_tr_b16 v[126:127], v106 offset:4096
  v_mfma_f32_16x16x32_bf16 v[52:55], v[160:163], v[168:171], v[52:55]
  ds_read_b64_tr_b16 v[128:129], v107 offset:0
  v_mfma_f32_16x16x32_bf16 v[56:59], v[148:151], v[172:175], v[56:59]
  ds_read_b64_tr_b16 v[130:131], v107 offset:4096
  v_mfma_f32_16x16x32_bf16 v[60:63], v[152:155], v[172:175], v[60:63]
  ds_read_b128 v[136:139], v92 offset:1024
  v_mfma_f32_16x16x32_bf16 v[64:67], v[156:159], v[172:175], v[64:67]
  ds_read_b128 v[140:143], v93 offset:0
  v_mfma_f32_16x16x32_bf16 v[68:71], v[160:163], v[172:175], v[68:71]
  ds_read_b128 v[144:147], v93 offset:1024
  v_mfma_f32_16x16x32_bf16 v[72:75], v[148:151], v[176:179], v[72:75]
  v_mfma_f32_16x16x32_bf16 v[76:79], v[152:155], v[176:179], v[76:79]
  v_mfma_f32_16x16x32_bf16 v[80:83], v[156:159], v[176:179], v[80:83]
  v_mfma_f32_16x16x32_bf16 v[84:87], v[160:163], v[176:179], v[84:87]
  s_waitcnt lgkmcnt(0)
  v_mfma_f32_16x16x32_bf16 v[24:27], v[116:119], v[132:135], v[24:27]
  ds_read_b128 v[164:167], v92 offset:8192
  v_mfma_f32_16x16x32_bf16 v[28:31], v[120:123], v[132:135], v[28:31]
  ds_read_b64_tr_b16 v[148:149], v104 offset:8192
  v_mfma_f32_16x16x32_bf16 v[32:35], v[124:127], v[132:135], v[32:35]
  ds_read_b64_tr_b16 v[150:151], v104 offset:12288
  v_mfma_f32_16x16x32_bf16 v[36:39], v[128:131], v[132:135], v[36:39]
  ds_read_b64_tr_b16 v[152:153], v105 offset:8192
  v_mfma_f32_16x16x32_bf16 v[40:43], v[116:119], v[136:139], v[40:43]
  ds_read_b64_tr_b16 v[154:155], v105 offset:12288
  v_mfma_f32_16x16x32_bf16 v[44:47], v[120:123], v[136:139], v[44:47]
  ds_read_b64_tr_b16 v[156:157], v106 offset:8192
  v_mfma_f32_16x16x32_bf16 v[48:51], v[124:127], v[136:139], v[48:51]
  ds_read_b64_tr_b16 v[158:159], v106 offset:12288
  v_mfma_f32_16x16x32_bf16 v[52:55], v[128:131], v[136:139], v[52:55]
  ds_read_b64_tr_b16 v[160:161], v107 offset:8192
  v_mfma_f32_16x16x32_bf16 v[56:59], v[116:119], v[140:143], v[56:59]
  ds_read_b64_tr_b16 v[162:163], v107 offset:12288
  v_mfma_f32_16x16x32_bf16 v[60:63], v[120:123], v[140:143], v[60:63]
  ds_read_b128 v[168:171], v92 offset:9216
  v_mfma_f32_16x16x32_bf16 v[64:67], v[124:127], v[140:143], v[64:67]
  ds_read_b128 v[172:175], v93 offset:8192
  v_mfma_f32_16x16x32_bf16 v[68:71], v[128:131], v[140:143], v[68:71]
  ds_read_b128 v[176:179], v93 offset:9216
  v_mfma_f32_16x16x32_bf16 v[72:75], v[116:119], v[144:147], v[72:75]
  s_addc_u32 s57, s7, 0
  s_mov_b32 s58, 4194304
  v_mfma_f32_16x16x32_bf16 v[76:79], v[120:123], v[144:147], v[76:79]
  s_mov_b32 s59, 0x20000
  s_mov_b32 s60, s16
  v_mfma_f32_16x16x32_bf16 v[80:83], v[124:127], v[144:147], v[80:83]
  s_mov_b32 s61, s17
  s_mov_b32 s62, 4194304
  v_mfma_f32_16x16x32_bf16 v[84:87], v[128:131], v[144:147], v[84:87]
  s_mov_b32 s63, 0x20000
  s_add_u32 s64, s6, 44040192
  s_waitcnt lgkmcnt(0)
  s_barrier
  v_mfma_f32_16x16x32_bf16 v[24:27], v[148:151], v[164:167], v[24:27]
  ds_read_b128 v[132:135], v88 offset:0
  v_mfma_f32_16x16x32_bf16 v[28:31], v[152:155], v[164:167], v[28:31]
  ds_read_b64_tr_b16 v[116:117], v96 offset:0
  v_mfma_f32_16x16x32_bf16 v[32:35], v[156:159], v[164:167], v[32:35]
  ds_read_b64_tr_b16 v[118:119], v96 offset:4096
  v_mfma_f32_16x16x32_bf16 v[36:39], v[160:163], v[164:167], v[36:39]
  ds_read_b64_tr_b16 v[120:121], v97 offset:0
  v_mfma_f32_16x16x32_bf16 v[40:43], v[148:151], v[168:171], v[40:43]
  ds_read_b64_tr_b16 v[122:123], v97 offset:4096
  v_mfma_f32_16x16x32_bf16 v[44:47], v[152:155], v[168:171], v[44:47]
  ds_read_b64_tr_b16 v[124:125], v98 offset:0
  v_mfma_f32_16x16x32_bf16 v[48:51], v[156:159], v[168:171], v[48:51]
  ds_read_b64_tr_b16 v[126:127], v98 offset:4096
  v_mfma_f32_16x16x32_bf16 v[52:55], v[160:163], v[168:171], v[52:55]
  ds_read_b64_tr_b16 v[128:129], v99 offset:0
  v_mfma_f32_16x16x32_bf16 v[56:59], v[148:151], v[172:175], v[56:59]
  ds_read_b64_tr_b16 v[130:131], v99 offset:4096
  v_mfma_f32_16x16x32_bf16 v[60:63], v[152:155], v[172:175], v[60:63]
  ds_read_b128 v[136:139], v88 offset:1024
  v_mfma_f32_16x16x32_bf16 v[64:67], v[156:159], v[172:175], v[64:67]
  ds_read_b128 v[140:143], v89 offset:0
  v_mfma_f32_16x16x32_bf16 v[68:71], v[160:163], v[172:175], v[68:71]
  ds_read_b128 v[144:147], v89 offset:1024
  v_mfma_f32_16x16x32_bf16 v[72:75], v[148:151], v[176:179], v[72:75]
  v_mfma_f32_16x16x32_bf16 v[76:79], v[152:155], v[176:179], v[76:79]
  v_mfma_f32_16x16x32_bf16 v[80:83], v[156:159], v[176:179], v[80:83]
  v_mfma_f32_16x16x32_bf16 v[84:87], v[160:163], v[176:179], v[84:87]
  s_waitcnt lgkmcnt(0)
  v_mfma_f32_16x16x32_bf16 v[24:27], v[116:119], v[132:135], v[24:27]
  ds_read_b128 v[164:167], v88 offset:8192
  v_mfma_f32_16x16x32_bf16 v[28:31], v[120:123], v[132:135], v[28:31]
  ds_read_b64_tr_b16 v[148:149], v96 offset:8192
  v_mfma_f32_16x16x32_bf16 v[32:35], v[124:127], v[132:135], v[32:35]
  ds_read_b64_tr_b16 v[150:151], v96 offset:12288
  v_mfma_f32_16x16x32_bf16 v[36:39], v[128:131], v[132:135], v[36:39]
  ds_read_b64_tr_b16 v[152:153], v97 offset:8192
  v_mfma_f32_16x16x32_bf16 v[40:43], v[116:119], v[136:139], v[40:43]
  ds_read_b64_tr_b16 v[154:155], v97 offset:12288
  v_mfma_f32_16x16x32_bf16 v[44:47], v[120:123], v[136:139], v[44:47]
  ds_read_b64_tr_b16 v[156:157], v98 offset:8192
  v_mfma_f32_16x16x32_bf16 v[48:51], v[124:127], v[136:139], v[48:51]
  ds_read_b64_tr_b16 v[158:159], v98 offset:12288
  v_mfma_f32_16x16x32_bf16 v[52:55], v[128:131], v[136:139], v[52:55]
  ds_read_b64_tr_b16 v[160:161], v99 offset:8192
  v_mfma_f32_16x16x32_bf16 v[56:59], v[116:119], v[140:143], v[56:59]
  ds_read_b64_tr_b16 v[162:163], v99 offset:12288
  v_mfma_f32_16x16x32_bf16 v[60:63], v[120:123], v[140:143], v[60:63]
  ds_read_b128 v[168:171], v88 offset:9216
  v_mfma_f32_16x16x32_bf16 v[64:67], v[124:127], v[140:143], v[64:67]
  ds_read_b128 v[172:175], v89 offset:8192
  v_mfma_f32_16x16x32_bf16 v[68:71], v[128:131], v[140:143], v[68:71]
  ds_read_b128 v[176:179], v89 offset:9216
  v_mfma_f32_16x16x32_bf16 v[72:75], v[116:119], v[144:147], v[72:75]
  s_addc_u32 s65, s7, 0
  s_mov_b32 s66, 8388608
  v_mfma_f32_16x16x32_bf16 v[76:79], v[120:123], v[144:147], v[76:79]
  s_mov_b32 s67, 0x20000
  s_and_b32 s38, s22, 7
  v_mfma_f32_16x16x32_bf16 v[80:83], v[124:127], v[144:147], v[80:83]
  s_lshl_b32 s40, s38, 8
  s_lshl_b32 s20, s24, 7
  v_mfma_f32_16x16x32_bf16 v[84:87], v[128:131], v[144:147], v[84:87]
  s_add_u32 s40, s40, s20
  s_lshl_b32 s42, s21, 2
  s_waitcnt lgkmcnt(0)
  s_barrier
  v_mfma_f32_16x16x32_bf16 v[24:27], v[148:151], v[164:167], v[24:27]
  ds_read_b128 v[132:135], v88 offset:32768
  v_mfma_f32_16x16x32_bf16 v[28:31], v[152:155], v[164:167], v[28:31]
  ds_read_b64_tr_b16 v[116:117], v96 offset:32768
  v_mfma_f32_16x16x32_bf16 v[32:35], v[156:159], v[164:167], v[32:35]
  ds_read_b64_tr_b16 v[118:119], v96 offset:36864
  v_mfma_f32_16x16x32_bf16 v[36:39], v[160:163], v[164:167], v[36:39]
  ds_read_b64_tr_b16 v[120:121], v97 offset:32768
  v_mfma_f32_16x16x32_bf16 v[40:43], v[148:151], v[168:171], v[40:43]
  ds_read_b64_tr_b16 v[122:123], v97 offset:36864
  v_mfma_f32_16x16x32_bf16 v[44:47], v[152:155], v[168:171], v[44:47]
  ds_read_b64_tr_b16 v[124:125], v98 offset:32768
  v_mfma_f32_16x16x32_bf16 v[48:51], v[156:159], v[168:171], v[48:51]
  ds_read_b64_tr_b16 v[126:127], v98 offset:36864
  v_mfma_f32_16x16x32_bf16 v[52:55], v[160:163], v[168:171], v[52:55]
  ds_read_b64_tr_b16 v[128:129], v99 offset:32768
  v_mfma_f32_16x16x32_bf16 v[56:59], v[148:151], v[172:175], v[56:59]
  ds_read_b64_tr_b16 v[130:131], v99 offset:36864
  v_mfma_f32_16x16x32_bf16 v[60:63], v[152:155], v[172:175], v[60:63]
  ds_read_b128 v[136:139], v88 offset:33792
  v_mfma_f32_16x16x32_bf16 v[64:67], v[156:159], v[172:175], v[64:67]
  ds_read_b128 v[140:143], v89 offset:32768
  v_mfma_f32_16x16x32_bf16 v[68:71], v[160:163], v[172:175], v[68:71]
  ds_read_b128 v[144:147], v89 offset:33792
  v_mfma_f32_16x16x32_bf16 v[72:75], v[148:151], v[176:179], v[72:75]
  v_mfma_f32_16x16x32_bf16 v[76:79], v[152:155], v[176:179], v[76:79]
  v_mfma_f32_16x16x32_bf16 v[80:83], v[156:159], v[176:179], v[80:83]
  v_mfma_f32_16x16x32_bf16 v[84:87], v[160:163], v[176:179], v[84:87]
  s_waitcnt lgkmcnt(0)
  v_mfma_f32_16x16x32_bf16 v[24:27], v[116:119], v[132:135], v[24:27]
  ds_read_b128 v[164:167], v88 offset:40960
  v_mfma_f32_16x16x32_bf16 v[28:31], v[120:123], v[132:135], v[28:31]
  ds_read_b64_tr_b16 v[148:149], v96 offset:40960
  v_mfma_f32_16x16x32_bf16 v[32:35], v[124:127], v[132:135], v[32:35]
  ds_read_b64_tr_b16 v[150:151], v96 offset:45056
  v_mfma_f32_16x16x32_bf16 v[36:39], v[128:131], v[132:135], v[36:39]
  ds_read_b64_tr_b16 v[152:153], v97 offset:40960
  v_mfma_f32_16x16x32_bf16 v[40:43], v[116:119], v[136:139], v[40:43]
  ds_read_b64_tr_b16 v[154:155], v97 offset:45056
  v_mfma_f32_16x16x32_bf16 v[44:47], v[120:123], v[136:139], v[44:47]
  ds_read_b64_tr_b16 v[156:157], v98 offset:40960
  v_mfma_f32_16x16x32_bf16 v[48:51], v[124:127], v[136:139], v[48:51]
  ds_read_b64_tr_b16 v[158:159], v98 offset:45056
  v_mfma_f32_16x16x32_bf16 v[52:55], v[128:131], v[136:139], v[52:55]
  ds_read_b64_tr_b16 v[160:161], v99 offset:40960
  v_mfma_f32_16x16x32_bf16 v[56:59], v[116:119], v[140:143], v[56:59]
  ds_read_b64_tr_b16 v[162:163], v99 offset:45056
  v_mfma_f32_16x16x32_bf16 v[60:63], v[120:123], v[140:143], v[60:63]
  ds_read_b128 v[168:171], v88 offset:41984
  v_mfma_f32_16x16x32_bf16 v[64:67], v[124:127], v[140:143], v[64:67]
  ds_read_b128 v[172:175], v89 offset:40960
  v_mfma_f32_16x16x32_bf16 v[68:71], v[128:131], v[140:143], v[68:71]
  ds_read_b128 v[176:179], v89 offset:41984
  v_mfma_f32_16x16x32_bf16 v[72:75], v[116:119], v[144:147], v[72:75]
  s_lshl_b32 s20, s23, 1
  s_add_u32 s42, s42, s20
  v_mfma_f32_16x16x32_bf16 v[76:79], v[120:123], v[144:147], v[76:79]
  s_add_u32 s42, s42, s37
  s_lshl_b32 s39, s42, 16
  v_mfma_f32_16x16x32_bf16 v[80:83], v[124:127], v[144:147], v[80:83]
  s_add_u32 s39, s39, s40
  s_lshl_b32 s41, s42, 13
  v_mfma_f32_16x16x32_bf16 v[84:87], v[128:131], v[144:147], v[84:87]
  s_add_u32 s41, s41, s40
  s_add_u32 s43, s39, 32768
  s_waitcnt lgkmcnt(0)
  s_barrier
  v_mfma_f32_16x16x32_bf16 v[24:27], v[148:151], v[164:167], v[24:27]
  ds_read_b128 v[132:135], v90 offset:0
  v_mfma_f32_16x16x32_bf16 v[28:31], v[152:155], v[164:167], v[28:31]
  ds_read_b64_tr_b16 v[116:117], v100 offset:0
  v_mfma_f32_16x16x32_bf16 v[32:35], v[156:159], v[164:167], v[32:35]
  ds_read_b64_tr_b16 v[118:119], v100 offset:4096
  v_mfma_f32_16x16x32_bf16 v[36:39], v[160:163], v[164:167], v[36:39]
  ds_read_b64_tr_b16 v[120:121], v101 offset:0
  v_mfma_f32_16x16x32_bf16 v[40:43], v[148:151], v[168:171], v[40:43]
  ds_read_b64_tr_b16 v[122:123], v101 offset:4096
  v_mfma_f32_16x16x32_bf16 v[44:47], v[152:155], v[168:171], v[44:47]
  ds_read_b64_tr_b16 v[124:125], v102 offset:0
  v_mfma_f32_16x16x32_bf16 v[48:51], v[156:159], v[168:171], v[48:51]
  ds_read_b64_tr_b16 v[126:127], v102 offset:4096
  v_mfma_f32_16x16x32_bf16 v[52:55], v[160:163], v[168:171], v[52:55]
  ds_read_b64_tr_b16 v[128:129], v103 offset:0
  v_mfma_f32_16x16x32_bf16 v[56:59], v[148:151], v[172:175], v[56:59]
  ds_read_b64_tr_b16 v[130:131], v103 offset:4096
  v_mfma_f32_16x16x32_bf16 v[60:63], v[152:155], v[172:175], v[60:63]
  ds_read_b128 v[136:139], v90 offset:1024
  v_mfma_f32_16x16x32_bf16 v[64:67], v[156:159], v[172:175], v[64:67]
  ds_read_b128 v[140:143], v91 offset:0
  v_mfma_f32_16x16x32_bf16 v[68:71], v[160:163], v[172:175], v[68:71]
  ds_read_b128 v[144:147], v91 offset:1024
  v_mfma_f32_16x16x32_bf16 v[72:75], v[148:151], v[176:179], v[72:75]
  v_mfma_f32_16x16x32_bf16 v[76:79], v[152:155], v[176:179], v[76:79]
  v_mfma_f32_16x16x32_bf16 v[80:83], v[156:159], v[176:179], v[80:83]
  v_mfma_f32_16x16x32_bf16 v[84:87], v[160:163], v[176:179], v[84:87]
  s_waitcnt lgkmcnt(0)
  v_mfma_f32_16x16x32_bf16 v[24:27], v[116:119], v[132:135], v[24:27]
  ds_read_b128 v[164:167], v90 offset:8192
  v_mfma_f32_16x16x32_bf16 v[28:31], v[120:123], v[132:135], v[28:31]
  ds_read_b64_tr_b16 v[148:149], v100 offset:8192
  v_mfma_f32_16x16x32_bf16 v[32:35], v[124:127], v[132:135], v[32:35]
  ds_read_b64_tr_b16 v[150:151], v100 offset:12288
  v_mfma_f32_16x16x32_bf16 v[36:39], v[128:131], v[132:135], v[36:39]
  ds_read_b64_tr_b16 v[152:153], v101 offset:8192
  v_mfma_f32_16x16x32_bf16 v[40:43], v[116:119], v[136:139], v[40:43]
  ds_read_b64_tr_b16 v[154:155], v101 offset:12288
  v_mfma_f32_16x16x32_bf16 v[44:47], v[120:123], v[136:139], v[44:47]
  ds_read_b64_tr_b16 v[156:157], v102 offset:8192
  v_mfma_f32_16x16x32_bf16 v[48:51], v[124:127], v[136:139], v[48:51]
  ds_read_b64_tr_b16 v[158:159], v102 offset:12288
  v_mfma_f32_16x16x32_bf16 v[52:55], v[128:131], v[136:139], v[52:55]
  ds_read_b64_tr_b16 v[160:161], v103 offset:8192
  v_mfma_f32_16x16x32_bf16 v[56:59], v[116:119], v[140:143], v[56:59]
  ds_read_b64_tr_b16 v[162:163], v103 offset:12288
  v_mfma_f32_16x16x32_bf16 v[60:63], v[120:123], v[140:143], v[60:63]
  ds_read_b128 v[168:171], v90 offset:9216
  v_mfma_f32_16x16x32_bf16 v[64:67], v[124:127], v[140:143], v[64:67]
  ds_read_b128 v[172:175], v91 offset:8192
  v_mfma_f32_16x16x32_bf16 v[68:71], v[128:131], v[140:143], v[68:71]
  ds_read_b128 v[176:179], v91 offset:9216
  v_mfma_f32_16x16x32_bf16 v[72:75], v[116:119], v[144:147], v[72:75]
  s_lshl_b32 s46, s2, 2
  s_add_u32 s46, s46, s18
  v_mfma_f32_16x16x32_bf16 v[76:79], v[120:123], v[144:147], v[76:79]
  s_xor_b32 s47, s46, 16
  s_lshl_b32 s44, s46, 13
  v_mfma_f32_16x16x32_bf16 v[80:83], v[124:127], v[144:147], v[80:83]
  s_lshl_b32 s45, s47, 13
  s_movk_i32 s46, 0xff
  v_mfma_f32_16x16x32_bf16 v[84:87], v[128:131], v[144:147], v[84:87]
  v_lshlrev_b32 v112, 3, v1
  v_and_b32 v112, 24, v112
  s_waitcnt lgkmcnt(0)
  s_barrier
  v_mfma_f32_16x16x32_bf16 v[24:27], v[148:151], v[164:167], v[24:27]
  ds_read_b128 v[132:135], v90 offset:32768
  v_mfma_f32_16x16x32_bf16 v[28:31], v[152:155], v[164:167], v[28:31]
  ds_read_b64_tr_b16 v[116:117], v100 offset:32768
  v_mfma_f32_16x16x32_bf16 v[32:35], v[156:159], v[164:167], v[32:35]
  ds_read_b64_tr_b16 v[118:119], v100 offset:36864
  v_mfma_f32_16x16x32_bf16 v[36:39], v[160:163], v[164:167], v[36:39]
  ds_read_b64_tr_b16 v[120:121], v101 offset:32768
  v_mfma_f32_16x16x32_bf16 v[40:43], v[148:151], v[168:171], v[40:43]
  ds_read_b64_tr_b16 v[122:123], v101 offset:36864
  v_mfma_f32_16x16x32_bf16 v[44:47], v[152:155], v[168:171], v[44:47]
  ds_read_b64_tr_b16 v[124:125], v102 offset:32768
  v_mfma_f32_16x16x32_bf16 v[48:51], v[156:159], v[168:171], v[48:51]
  ds_read_b64_tr_b16 v[126:127], v102 offset:36864
  v_mfma_f32_16x16x32_bf16 v[52:55], v[160:163], v[168:171], v[52:55]
  ds_read_b64_tr_b16 v[128:129], v103 offset:32768
  v_mfma_f32_16x16x32_bf16 v[56:59], v[148:151], v[172:175], v[56:59]
  ds_read_b64_tr_b16 v[130:131], v103 offset:36864
  v_mfma_f32_16x16x32_bf16 v[60:63], v[152:155], v[172:175], v[60:63]
  ds_read_b128 v[136:139], v90 offset:33792
  v_mfma_f32_16x16x32_bf16 v[64:67], v[156:159], v[172:175], v[64:67]
  ds_read_b128 v[140:143], v91 offset:32768
  v_mfma_f32_16x16x32_bf16 v[68:71], v[160:163], v[172:175], v[68:71]
  ds_read_b128 v[144:147], v91 offset:33792
  v_mfma_f32_16x16x32_bf16 v[72:75], v[148:151], v[176:179], v[72:75]
  v_mfma_f32_16x16x32_bf16 v[76:79], v[152:155], v[176:179], v[76:79]
  v_mfma_f32_16x16x32_bf16 v[80:83], v[156:159], v[176:179], v[80:83]
  v_mfma_f32_16x16x32_bf16 v[84:87], v[160:163], v[176:179], v[84:87]
  s_waitcnt lgkmcnt(0)
  v_mfma_f32_16x16x32_bf16 v[24:27], v[116:119], v[132:135], v[24:27]
  ds_read_b128 v[164:167], v90 offset:40960
  v_mfma_f32_16x16x32_bf16 v[28:31], v[120:123], v[132:135], v[28:31]
  ds_read_b64_tr_b16 v[148:149], v100 offset:40960
  v_mfma_f32_16x16x32_bf16 v[32:35], v[124:127], v[132:135], v[32:35]
  ds_read_b64_tr_b16 v[150:151], v100 offset:45056
  v_mfma_f32_16x16x32_bf16 v[36:39], v[128:131], v[132:135], v[36:39]
  ds_read_b64_tr_b16 v[152:153], v101 offset:40960
  v_mfma_f32_16x16x32_bf16 v[40:43], v[116:119], v[136:139], v[40:43]
  ds_read_b64_tr_b16 v[154:155], v101 offset:45056
  v_mfma_f32_16x16x32_bf16 v[44:47], v[120:123], v[136:139], v[44:47]
  ds_read_b64_tr_b16 v[156:157], v102 offset:40960
  v_mfma_f32_16x16x32_bf16 v[48:51], v[124:127], v[136:139], v[48:51]
  ds_read_b64_tr_b16 v[158:159], v102 offset:45056
  v_mfma_f32_16x16x32_bf16 v[52:55], v[128:131], v[136:139], v[52:55]
  ds_read_b64_tr_b16 v[160:161], v103 offset:40960
  v_mfma_f32_16x16x32_bf16 v[56:59], v[116:119], v[140:143], v[56:59]
  ds_read_b64_tr_b16 v[162:163], v103 offset:45056
  v_mfma_f32_16x16x32_bf16 v[60:63], v[120:123], v[140:143], v[60:63]
  ds_read_b128 v[168:171], v90 offset:41984
  v_mfma_f32_16x16x32_bf16 v[64:67], v[124:127], v[140:143], v[64:67]
  ds_read_b128 v[172:175], v91 offset:40960
  v_mfma_f32_16x16x32_bf16 v[68:71], v[128:131], v[140:143], v[68:71]
  ds_read_b128 v[176:179], v91 offset:41984
  v_mfma_f32_16x16x32_bf16 v[72:75], v[116:119], v[144:147], v[72:75]
  v_lshrrev_b32 v112, v112, s36
  v_and_b32 v112, 0xff, v112
  v_mfma_f32_16x16x32_bf16 v[76:79], v[120:123], v[144:147], v[76:79]
  v_and_b32 v113, 7, v1
  v_lshlrev_b32 v113, 4, v113
  v_mfma_f32_16x16x32_bf16 v[80:83], v[124:127], v[144:147], v[80:83]
  v_add_u32 v113, 8064, v113
  v_mfma_f32_16x16x32_bf16 v[84:87], v[128:131], v[144:147], v[84:87]
  s_waitcnt lgkmcnt(0)
  s_barrier
  v_mfma_f32_16x16x32_bf16 v[24:27], v[148:151], v[164:167], v[24:27]
  ds_read_b128 v[132:135], v92 offset:0
  v_mfma_f32_16x16x32_bf16 v[28:31], v[152:155], v[164:167], v[28:31]
  ds_read_b64_tr_b16 v[116:117], v104 offset:0
  v_mfma_f32_16x16x32_bf16 v[32:35], v[156:159], v[164:167], v[32:35]
  ds_read_b64_tr_b16 v[118:119], v104 offset:4096
  v_mfma_f32_16x16x32_bf16 v[36:39], v[160:163], v[164:167], v[36:39]
  ds_read_b64_tr_b16 v[120:121], v105 offset:0
  v_mfma_f32_16x16x32_bf16 v[40:43], v[148:151], v[168:171], v[40:43]
  ds_read_b64_tr_b16 v[122:123], v105 offset:4096
  v_mfma_f32_16x16x32_bf16 v[44:47], v[152:155], v[168:171], v[44:47]
  ds_read_b64_tr_b16 v[124:125], v106 offset:0
  v_mfma_f32_16x16x32_bf16 v[48:51], v[156:159], v[168:171], v[48:51]
  ds_read_b64_tr_b16 v[126:127], v106 offset:4096
  v_mfma_f32_16x16x32_bf16 v[52:55], v[160:163], v[168:171], v[52:55]
  ds_read_b64_tr_b16 v[128:129], v107 offset:0
  v_mfma_f32_16x16x32_bf16 v[56:59], v[148:151], v[172:175], v[56:59]
  ds_read_b64_tr_b16 v[130:131], v107 offset:4096
  v_mfma_f32_16x16x32_bf16 v[60:63], v[152:155], v[172:175], v[60:63]
  ds_read_b128 v[136:139], v92 offset:1024
  v_mfma_f32_16x16x32_bf16 v[64:67], v[156:159], v[172:175], v[64:67]
  ds_read_b128 v[140:143], v93 offset:0
  v_mfma_f32_16x16x32_bf16 v[68:71], v[160:163], v[172:175], v[68:71]
  ds_read_b128 v[144:147], v93 offset:1024
  v_mfma_f32_16x16x32_bf16 v[72:75], v[148:151], v[176:179], v[72:75]
  v_mfma_f32_16x16x32_bf16 v[76:79], v[152:155], v[176:179], v[76:79]
  v_mfma_f32_16x16x32_bf16 v[80:83], v[156:159], v[176:179], v[80:83]
  v_mfma_f32_16x16x32_bf16 v[84:87], v[160:163], v[176:179], v[84:87]
  s_waitcnt lgkmcnt(0)
  v_mfma_f32_16x16x32_bf16 v[24:27], v[116:119], v[132:135], v[24:27]
  ds_read_b128 v[164:167], v92 offset:8192
  v_mfma_f32_16x16x32_bf16 v[28:31], v[120:123], v[132:135], v[28:31]
  ds_read_b64_tr_b16 v[148:149], v104 offset:8192
  v_mfma_f32_16x16x32_bf16 v[32:35], v[124:127], v[132:135], v[32:35]
  ds_read_b64_tr_b16 v[150:151], v104 offset:12288
  v_mfma_f32_16x16x32_bf16 v[36:39], v[128:131], v[132:135], v[36:39]
  ds_read_b64_tr_b16 v[152:153], v105 offset:8192
  v_mfma_f32_16x16x32_bf16 v[40:43], v[116:119], v[136:139], v[40:43]
  ds_read_b64_tr_b16 v[154:155], v105 offset:12288
  v_mfma_f32_16x16x32_bf16 v[44:47], v[120:123], v[136:139], v[44:47]
  ds_read_b64_tr_b16 v[156:157], v106 offset:8192
  v_mfma_f32_16x16x32_bf16 v[48:51], v[124:127], v[136:139], v[48:51]
  ds_read_b64_tr_b16 v[158:159], v106 offset:12288
  v_mfma_f32_16x16x32_bf16 v[52:55], v[128:131], v[136:139], v[52:55]
  ds_read_b64_tr_b16 v[160:161], v107 offset:8192
  v_mfma_f32_16x16x32_bf16 v[56:59], v[116:119], v[140:143], v[56:59]
  ds_read_b64_tr_b16 v[162:163], v107 offset:12288
  v_mfma_f32_16x16x32_bf16 v[60:63], v[120:123], v[140:143], v[60:63]
  ds_read_b128 v[168:171], v92 offset:9216
  v_mfma_f32_16x16x32_bf16 v[64:67], v[124:127], v[140:143], v[64:67]
  ds_read_b128 v[172:175], v93 offset:8192
  v_mfma_f32_16x16x32_bf16 v[68:71], v[128:131], v[140:143], v[68:71]
  ds_read_b128 v[176:179], v93 offset:9216
  v_mfma_f32_16x16x32_bf16 v[72:75], v[116:119], v[144:147], v[72:75]
  v_mfma_f32_16x16x32_bf16 v[76:79], v[120:123], v[144:147], v[76:79]
  v_mfma_f32_16x16x32_bf16 v[80:83], v[124:127], v[144:147], v[80:83]
  v_mfma_f32_16x16x32_bf16 v[84:87], v[128:131], v[144:147], v[84:87]
  s_waitcnt lgkmcnt(0)
  s_barrier
  v_mfma_f32_16x16x32_bf16 v[24:27], v[148:151], v[164:167], v[24:27]
  ds_read_b128 v[132:135], v88 offset:0
  v_mfma_f32_16x16x32_bf16 v[28:31], v[152:155], v[164:167], v[28:31]
  ds_read_b64_tr_b16 v[116:117], v96 offset:0
  v_mfma_f32_16x16x32_bf16 v[32:35], v[156:159], v[164:167], v[32:35]
  ds_read_b64_tr_b16 v[118:119], v96 offset:4096
  v_mfma_f32_16x16x32_bf16 v[36:39], v[160:163], v[164:167], v[36:39]
  ds_read_b64_tr_b16 v[120:121], v97 offset:0
  v_mfma_f32_16x16x32_bf16 v[40:43], v[148:151], v[168:171], v[40:43]
  ds_read_b64_tr_b16 v[122:123], v97 offset:4096
  v_mfma_f32_16x16x32_bf16 v[44:47], v[152:155], v[168:171], v[44:47]
  ds_read_b64_tr_b16 v[124:125], v98 offset:0
  v_mfma_f32_16x16x32_bf16 v[48:51], v[156:159], v[168:171], v[48:51]
  ds_read_b64_tr_b16 v[126:127], v98 offset:4096
  v_mfma_f32_16x16x32_bf16 v[52:55], v[160:163], v[168:171], v[52:55]
  ds_read_b64_tr_b16 v[128:129], v99 offset:0
  v_mfma_f32_16x16x32_bf16 v[56:59], v[148:151], v[172:175], v[56:59]
  ds_read_b64_tr_b16 v[130:131], v99 offset:4096
  v_mfma_f32_16x16x32_bf16 v[60:63], v[152:155], v[172:175], v[60:63]
  ds_read_b128 v[136:139], v88 offset:1024
  v_mfma_f32_16x16x32_bf16 v[64:67], v[156:159], v[172:175], v[64:67]
  ds_read_b128 v[140:143], v89 offset:0
  v_mfma_f32_16x16x32_bf16 v[68:71], v[160:163], v[172:175], v[68:71]
  ds_read_b128 v[144:147], v89 offset:1024
  v_mfma_f32_16x16x32_bf16 v[72:75], v[148:151], v[176:179], v[72:75]
  v_mfma_f32_16x16x32_bf16 v[76:79], v[152:155], v[176:179], v[76:79]
  v_mfma_f32_16x16x32_bf16 v[80:83], v[156:159], v[176:179], v[80:83]
  v_mfma_f32_16x16x32_bf16 v[84:87], v[160:163], v[176:179], v[84:87]
  s_waitcnt lgkmcnt(0)
  v_mfma_f32_16x16x32_bf16 v[24:27], v[116:119], v[132:135], v[24:27]
  ds_read_b128 v[164:167], v88 offset:8192
  v_mfma_f32_16x16x32_bf16 v[28:31], v[120:123], v[132:135], v[28:31]
  ds_read_b64_tr_b16 v[148:149], v96 offset:8192
  v_mfma_f32_16x16x32_bf16 v[32:35], v[124:127], v[132:135], v[32:35]
  ds_read_b64_tr_b16 v[150:151], v96 offset:12288
  v_mfma_f32_16x16x32_bf16 v[36:39], v[128:131], v[132:135], v[36:39]
  ds_read_b64_tr_b16 v[152:153], v97 offset:8192
  v_mfma_f32_16x16x32_bf16 v[40:43], v[116:119], v[136:139], v[40:43]
  ds_read_b64_tr_b16 v[154:155], v97 offset:12288
  v_mfma_f32_16x16x32_bf16 v[44:47], v[120:123], v[136:139], v[44:47]
  ds_read_b64_tr_b16 v[156:157], v98 offset:8192
  v_mfma_f32_16x16x32_bf16 v[48:51], v[124:127], v[136:139], v[48:51]
  ds_read_b64_tr_b16 v[158:159], v98 offset:12288
  v_mfma_f32_16x16x32_bf16 v[52:55], v[128:131], v[136:139], v[52:55]
  ds_read_b64_tr_b16 v[160:161], v99 offset:8192
  v_mfma_f32_16x16x32_bf16 v[56:59], v[116:119], v[140:143], v[56:59]
  ds_read_b64_tr_b16 v[162:163], v99 offset:12288
  v_mfma_f32_16x16x32_bf16 v[60:63], v[120:123], v[140:143], v[60:63]
  ds_read_b128 v[168:171], v88 offset:9216
  v_mfma_f32_16x16x32_bf16 v[64:67], v[124:127], v[140:143], v[64:67]
  ds_read_b128 v[172:175], v89 offset:8192
  v_mfma_f32_16x16x32_bf16 v[68:71], v[128:131], v[140:143], v[68:71]
  ds_read_b128 v[176:179], v89 offset:9216
  v_mfma_f32_16x16x32_bf16 v[72:75], v[116:119], v[144:147], v[72:75]
  v_mfma_f32_16x16x32_bf16 v[76:79], v[120:123], v[144:147], v[76:79]
  v_mfma_f32_16x16x32_bf16 v[80:83], v[124:127], v[144:147], v[80:83]
  v_mfma_f32_16x16x32_bf16 v[84:87], v[128:131], v[144:147], v[84:87]
  s_waitcnt lgkmcnt(0)
  s_barrier
  v_mfma_f32_16x16x32_bf16 v[24:27], v[148:151], v[164:167], v[24:27]
  ds_read_b128 v[132:135], v88 offset:32768
  v_mfma_f32_16x16x32_bf16 v[28:31], v[152:155], v[164:167], v[28:31]
  ds_read_b64_tr_b16 v[116:117], v96 offset:32768
  v_mfma_f32_16x16x32_bf16 v[32:35], v[156:159], v[164:167], v[32:35]
  ds_read_b64_tr_b16 v[118:119], v96 offset:36864
  v_mfma_f32_16x16x32_bf16 v[36:39], v[160:163], v[164:167], v[36:39]
  ds_read_b64_tr_b16 v[120:121], v97 offset:32768
  v_mfma_f32_16x16x32_bf16 v[40:43], v[148:151], v[168:171], v[40:43]
  ds_read_b64_tr_b16 v[122:123], v97 offset:36864
  v_mfma_f32_16x16x32_bf16 v[44:47], v[152:155], v[168:171], v[44:47]
  ds_read_b64_tr_b16 v[124:125], v98 offset:32768
  v_mfma_f32_16x16x32_bf16 v[48:51], v[156:159], v[168:171], v[48:51]
  ds_read_b64_tr_b16 v[126:127], v98 offset:36864
  v_mfma_f32_16x16x32_bf16 v[52:55], v[160:163], v[168:171], v[52:55]
  ds_read_b64_tr_b16 v[128:129], v99 offset:32768
  v_mfma_f32_16x16x32_bf16 v[56:59], v[148:151], v[172:175], v[56:59]
  ds_read_b64_tr_b16 v[130:131], v99 offset:36864
  v_mfma_f32_16x16x32_bf16 v[60:63], v[152:155], v[172:175], v[60:63]
  ds_read_b128 v[136:139], v88 offset:33792
  v_mfma_f32_16x16x32_bf16 v[64:67], v[156:159], v[172:175], v[64:67]
  ds_read_b128 v[140:143], v89 offset:32768
  v_mfma_f32_16x16x32_bf16 v[68:71], v[160:163], v[172:175], v[68:71]
  ds_read_b128 v[144:147], v89 offset:33792
  v_mfma_f32_16x16x32_bf16 v[72:75], v[148:151], v[176:179], v[72:75]
  v_mfma_f32_16x16x32_bf16 v[76:79], v[152:155], v[176:179], v[76:79]
  v_mfma_f32_16x16x32_bf16 v[80:83], v[156:159], v[176:179], v[80:83]
  v_mfma_f32_16x16x32_bf16 v[84:87], v[160:163], v[176:179], v[84:87]
  s_waitcnt lgkmcnt(0)
  v_mfma_f32_16x16x32_bf16 v[24:27], v[116:119], v[132:135], v[24:27]
  ds_read_b128 v[164:167], v88 offset:40960
  v_mfma_f32_16x16x32_bf16 v[28:31], v[120:123], v[132:135], v[28:31]
  ds_read_b64_tr_b16 v[148:149], v96 offset:40960
  v_mfma_f32_16x16x32_bf16 v[32:35], v[124:127], v[132:135], v[32:35]
  ds_read_b64_tr_b16 v[150:151], v96 offset:45056
  v_mfma_f32_16x16x32_bf16 v[36:39], v[128:131], v[132:135], v[36:39]
  ds_read_b64_tr_b16 v[152:153], v97 offset:40960
  v_mfma_f32_16x16x32_bf16 v[40:43], v[116:119], v[136:139], v[40:43]
  ds_read_b64_tr_b16 v[154:155], v97 offset:45056
  v_mfma_f32_16x16x32_bf16 v[44:47], v[120:123], v[136:139], v[44:47]
  ds_read_b64_tr_b16 v[156:157], v98 offset:40960
  v_mfma_f32_16x16x32_bf16 v[48:51], v[124:127], v[136:139], v[48:51]
  ds_read_b64_tr_b16 v[158:159], v98 offset:45056
  v_mfma_f32_16x16x32_bf16 v[52:55], v[128:131], v[136:139], v[52:55]
  ds_read_b64_tr_b16 v[160:161], v99 offset:40960
  v_mfma_f32_16x16x32_bf16 v[56:59], v[116:119], v[140:143], v[56:59]
  ds_read_b64_tr_b16 v[162:163], v99 offset:45056
  v_mfma_f32_16x16x32_bf16 v[60:63], v[120:123], v[140:143], v[60:63]
  ds_read_b128 v[168:171], v88 offset:41984
  v_mfma_f32_16x16x32_bf16 v[64:67], v[124:127], v[140:143], v[64:67]
  ds_read_b128 v[172:175], v89 offset:40960
  v_mfma_f32_16x16x32_bf16 v[68:71], v[128:131], v[140:143], v[68:71]
  ds_read_b128 v[176:179], v89 offset:41984
  v_mfma_f32_16x16x32_bf16 v[72:75], v[116:119], v[144:147], v[72:75]
  v_mfma_f32_16x16x32_bf16 v[76:79], v[120:123], v[144:147], v[76:79]
  v_mfma_f32_16x16x32_bf16 v[80:83], v[124:127], v[144:147], v[80:83]
  v_mfma_f32_16x16x32_bf16 v[84:87], v[128:131], v[144:147], v[84:87]
  s_waitcnt lgkmcnt(0)
  s_barrier
  v_mfma_f32_16x16x32_bf16 v[24:27], v[148:151], v[164:167], v[24:27]
  ds_read_b128 v[132:135], v90 offset:0
  v_mfma_f32_16x16x32_bf16 v[28:31], v[152:155], v[164:167], v[28:31]
  ds_read_b64_tr_b16 v[116:117], v100 offset:0
  v_mfma_f32_16x16x32_bf16 v[32:35], v[156:159], v[164:167], v[32:35]
  ds_read_b64_tr_b16 v[118:119], v100 offset:4096
  v_mfma_f32_16x16x32_bf16 v[36:39], v[160:163], v[164:167], v[36:39]
  ds_read_b64_tr_b16 v[120:121], v101 offset:0
  v_mfma_f32_16x16x32_bf16 v[40:43], v[148:151], v[168:171], v[40:43]
  ds_read_b64_tr_b16 v[122:123], v101 offset:4096
  v_mfma_f32_16x16x32_bf16 v[44:47], v[152:155], v[168:171], v[44:47]
  ds_read_b64_tr_b16 v[124:125], v102 offset:0
  v_mfma_f32_16x16x32_bf16 v[48:51], v[156:159], v[168:171], v[48:51]
  ds_read_b64_tr_b16 v[126:127], v102 offset:4096
  v_mfma_f32_16x16x32_bf16 v[52:55], v[160:163], v[168:171], v[52:55]
  ds_read_b64_tr_b16 v[128:129], v103 offset:0
  v_mfma_f32_16x16x32_bf16 v[56:59], v[148:151], v[172:175], v[56:59]
  ds_read_b64_tr_b16 v[130:131], v103 offset:4096
  v_mfma_f32_16x16x32_bf16 v[60:63], v[152:155], v[172:175], v[60:63]
  ds_read_b128 v[136:139], v90 offset:1024
  v_mfma_f32_16x16x32_bf16 v[64:67], v[156:159], v[172:175], v[64:67]
  ds_read_b128 v[140:143], v91 offset:0
  v_mfma_f32_16x16x32_bf16 v[68:71], v[160:163], v[172:175], v[68:71]
  ds_read_b128 v[144:147], v91 offset:1024
  v_mfma_f32_16x16x32_bf16 v[72:75], v[148:151], v[176:179], v[72:75]
  v_mfma_f32_16x16x32_bf16 v[76:79], v[152:155], v[176:179], v[76:79]
  v_mfma_f32_16x16x32_bf16 v[80:83], v[156:159], v[176:179], v[80:83]
  v_mfma_f32_16x16x32_bf16 v[84:87], v[160:163], v[176:179], v[84:87]
  s_waitcnt lgkmcnt(0)
  v_mfma_f32_16x16x32_bf16 v[24:27], v[116:119], v[132:135], v[24:27]
  ds_read_b128 v[164:167], v90 offset:8192
  v_mfma_f32_16x16x32_bf16 v[28:31], v[120:123], v[132:135], v[28:31]
  ds_read_b64_tr_b16 v[148:149], v100 offset:8192
  v_mfma_f32_16x16x32_bf16 v[32:35], v[124:127], v[132:135], v[32:35]
  ds_read_b64_tr_b16 v[150:151], v100 offset:12288
  v_mfma_f32_16x16x32_bf16 v[36:39], v[128:131], v[132:135], v[36:39]
  ds_read_b64_tr_b16 v[152:153], v101 offset:8192
  v_mfma_f32_16x16x32_bf16 v[40:43], v[116:119], v[136:139], v[40:43]
  ds_read_b64_tr_b16 v[154:155], v101 offset:12288
  v_mfma_f32_16x16x32_bf16 v[44:47], v[120:123], v[136:139], v[44:47]
  ds_read_b64_tr_b16 v[156:157], v102 offset:8192
  v_mfma_f32_16x16x32_bf16 v[48:51], v[124:127], v[136:139], v[48:51]
  ds_read_b64_tr_b16 v[158:159], v102 offset:12288
  v_mfma_f32_16x16x32_bf16 v[52:55], v[128:131], v[136:139], v[52:55]
  ds_read_b64_tr_b16 v[160:161], v103 offset:8192
  v_mfma_f32_16x16x32_bf16 v[56:59], v[116:119], v[140:143], v[56:59]
  ds_read_b64_tr_b16 v[162:163], v103 offset:12288
  v_mfma_f32_16x16x32_bf16 v[60:63], v[120:123], v[140:143], v[60:63]
  ds_read_b128 v[168:171], v90 offset:9216
  v_mfma_f32_16x16x32_bf16 v[64:67], v[124:127], v[140:143], v[64:67]
  ds_read_b128 v[172:175], v91 offset:8192
  v_mfma_f32_16x16x32_bf16 v[68:71], v[128:131], v[140:143], v[68:71]
  ds_read_b128 v[176:179], v91 offset:9216
  v_mfma_f32_16x16x32_bf16 v[72:75], v[116:119], v[144:147], v[72:75]
  v_mfma_f32_16x16x32_bf16 v[76:79], v[120:123], v[144:147], v[76:79]
  v_mfma_f32_16x16x32_bf16 v[80:83], v[124:127], v[144:147], v[80:83]
  v_mfma_f32_16x16x32_bf16 v[84:87], v[128:131], v[144:147], v[84:87]
  s_waitcnt lgkmcnt(0)
  s_barrier
  v_mfma_f32_16x16x32_bf16 v[24:27], v[148:151], v[164:167], v[24:27]
  ds_read_b128 v[132:135], v90 offset:32768
  v_mfma_f32_16x16x32_bf16 v[28:31], v[152:155], v[164:167], v[28:31]
  ds_read_b64_tr_b16 v[116:117], v100 offset:32768
  v_mfma_f32_16x16x32_bf16 v[32:35], v[156:159], v[164:167], v[32:35]
  ds_read_b64_tr_b16 v[118:119], v100 offset:36864
  v_mfma_f32_16x16x32_bf16 v[36:39], v[160:163], v[164:167], v[36:39]
  ds_read_b64_tr_b16 v[120:121], v101 offset:32768
  v_mfma_f32_16x16x32_bf16 v[40:43], v[148:151], v[168:171], v[40:43]
  ds_read_b64_tr_b16 v[122:123], v101 offset:36864
  v_mfma_f32_16x16x32_bf16 v[44:47], v[152:155], v[168:171], v[44:47]
  ds_read_b64_tr_b16 v[124:125], v102 offset:32768
  v_mfma_f32_16x16x32_bf16 v[48:51], v[156:159], v[168:171], v[48:51]
  ds_read_b64_tr_b16 v[126:127], v102 offset:36864
  v_mfma_f32_16x16x32_bf16 v[52:55], v[160:163], v[168:171], v[52:55]
  ds_read_b64_tr_b16 v[128:129], v103 offset:32768
  v_mfma_f32_16x16x32_bf16 v[56:59], v[148:151], v[172:175], v[56:59]
  ds_read_b64_tr_b16 v[130:131], v103 offset:36864
  v_mfma_f32_16x16x32_bf16 v[60:63], v[152:155], v[172:175], v[60:63]
  ds_read_b128 v[136:139], v90 offset:33792
  v_mfma_f32_16x16x32_bf16 v[64:67], v[156:159], v[172:175], v[64:67]
  ds_read_b128 v[140:143], v91 offset:32768
  v_mfma_f32_16x16x32_bf16 v[68:71], v[160:163], v[172:175], v[68:71]
  ds_read_b128 v[144:147], v91 offset:33792
  v_mfma_f32_16x16x32_bf16 v[72:75], v[148:151], v[176:179], v[72:75]
  v_mfma_f32_16x16x32_bf16 v[76:79], v[152:155], v[176:179], v[76:79]
  v_mfma_f32_16x16x32_bf16 v[80:83], v[156:159], v[176:179], v[80:83]
  v_mfma_f32_16x16x32_bf16 v[84:87], v[160:163], v[176:179], v[84:87]
  s_waitcnt lgkmcnt(0)
  v_mfma_f32_16x16x32_bf16 v[24:27], v[116:119], v[132:135], v[24:27]
  ds_read_b128 v[164:167], v90 offset:40960
  v_mfma_f32_16x16x32_bf16 v[28:31], v[120:123], v[132:135], v[28:31]
  ds_read_b64_tr_b16 v[148:149], v100 offset:40960
  v_mfma_f32_16x16x32_bf16 v[32:35], v[124:127], v[132:135], v[32:35]
  ds_read_b64_tr_b16 v[150:151], v100 offset:45056
  v_mfma_f32_16x16x32_bf16 v[36:39], v[128:131], v[132:135], v[36:39]
  ds_read_b64_tr_b16 v[152:153], v101 offset:40960
  v_mfma_f32_16x16x32_bf16 v[40:43], v[116:119], v[136:139], v[40:43]
  ds_read_b64_tr_b16 v[154:155], v101 offset:45056
  v_mfma_f32_16x16x32_bf16 v[44:47], v[120:123], v[136:139], v[44:47]
  ds_read_b64_tr_b16 v[156:157], v102 offset:40960
  v_mfma_f32_16x16x32_bf16 v[48:51], v[124:127], v[136:139], v[48:51]
  ds_read_b64_tr_b16 v[158:159], v102 offset:45056
  v_mfma_f32_16x16x32_bf16 v[52:55], v[128:131], v[136:139], v[52:55]
  ds_read_b64_tr_b16 v[160:161], v103 offset:40960
  v_mfma_f32_16x16x32_bf16 v[56:59], v[116:119], v[140:143], v[56:59]
  ds_read_b64_tr_b16 v[162:163], v103 offset:45056
  v_mfma_f32_16x16x32_bf16 v[60:63], v[120:123], v[140:143], v[60:63]
  ds_read_b128 v[168:171], v90 offset:41984
  v_mfma_f32_16x16x32_bf16 v[64:67], v[124:127], v[140:143], v[64:67]
  ds_read_b128 v[172:175], v91 offset:40960
  v_mfma_f32_16x16x32_bf16 v[68:71], v[128:131], v[140:143], v[68:71]
  ds_read_b128 v[176:179], v91 offset:41984
  v_mfma_f32_16x16x32_bf16 v[72:75], v[116:119], v[144:147], v[72:75]
  v_mfma_f32_16x16x32_bf16 v[76:79], v[120:123], v[144:147], v[76:79]
  v_mfma_f32_16x16x32_bf16 v[80:83], v[124:127], v[144:147], v[80:83]
  v_mfma_f32_16x16x32_bf16 v[84:87], v[128:131], v[144:147], v[84:87]
  s_waitcnt lgkmcnt(0)
  s_barrier
  v_mfma_f32_16x16x32_bf16 v[24:27], v[148:151], v[164:167], v[24:27]
  ds_read_b128 v[132:135], v92 offset:0
  v_mfma_f32_16x16x32_bf16 v[28:31], v[152:155], v[164:167], v[28:31]
  ds_read_b64_tr_b16 v[116:117], v104 offset:0
  v_mfma_f32_16x16x32_bf16 v[32:35], v[156:159], v[164:167], v[32:35]
  ds_read_b64_tr_b16 v[118:119], v104 offset:4096
  v_mfma_f32_16x16x32_bf16 v[36:39], v[160:163], v[164:167], v[36:39]
  ds_read_b64_tr_b16 v[120:121], v105 offset:0
  v_mfma_f32_16x16x32_bf16 v[40:43], v[148:151], v[168:171], v[40:43]
  ds_read_b64_tr_b16 v[122:123], v105 offset:4096
  v_mfma_f32_16x16x32_bf16 v[44:47], v[152:155], v[168:171], v[44:47]
  ds_read_b64_tr_b16 v[124:125], v106 offset:0
  v_mfma_f32_16x16x32_bf16 v[48:51], v[156:159], v[168:171], v[48:51]
  ds_read_b64_tr_b16 v[126:127], v106 offset:4096
  v_mfma_f32_16x16x32_bf16 v[52:55], v[160:163], v[168:171], v[52:55]
  ds_read_b64_tr_b16 v[128:129], v107 offset:0
  v_mfma_f32_16x16x32_bf16 v[56:59], v[148:151], v[172:175], v[56:59]
  ds_read_b64_tr_b16 v[130:131], v107 offset:4096
  v_mfma_f32_16x16x32_bf16 v[60:63], v[152:155], v[172:175], v[60:63]
  ds_read_b128 v[136:139], v92 offset:1024
  v_mfma_f32_16x16x32_bf16 v[64:67], v[156:159], v[172:175], v[64:67]
  ds_read_b128 v[140:143], v93 offset:0
  v_mfma_f32_16x16x32_bf16 v[68:71], v[160:163], v[172:175], v[68:71]
  ds_read_b128 v[144:147], v93 offset:1024
  v_mfma_f32_16x16x32_bf16 v[72:75], v[148:151], v[176:179], v[72:75]
  v_mfma_f32_16x16x32_bf16 v[76:79], v[152:155], v[176:179], v[76:79]
  v_mfma_f32_16x16x32_bf16 v[80:83], v[156:159], v[176:179], v[80:83]
  v_mfma_f32_16x16x32_bf16 v[84:87], v[160:163], v[176:179], v[84:87]
  s_waitcnt lgkmcnt(0)
  v_mfma_f32_16x16x32_bf16 v[24:27], v[116:119], v[132:135], v[24:27]
  ds_read_b128 v[164:167], v92 offset:8192
  v_mfma_f32_16x16x32_bf16 v[28:31], v[120:123], v[132:135], v[28:31]
  ds_read_b64_tr_b16 v[148:149], v104 offset:8192
  v_mfma_f32_16x16x32_bf16 v[32:35], v[124:127], v[132:135], v[32:35]
  ds_read_b64_tr_b16 v[150:151], v104 offset:12288
  v_mfma_f32_16x16x32_bf16 v[36:39], v[128:131], v[132:135], v[36:39]
  ds_read_b64_tr_b16 v[152:153], v105 offset:8192
  v_mfma_f32_16x16x32_bf16 v[40:43], v[116:119], v[136:139], v[40:43]
  ds_read_b64_tr_b16 v[154:155], v105 offset:12288
  v_mfma_f32_16x16x32_bf16 v[44:47], v[120:123], v[136:139], v[44:47]
  ds_read_b64_tr_b16 v[156:157], v106 offset:8192
  v_mfma_f32_16x16x32_bf16 v[48:51], v[124:127], v[136:139], v[48:51]
  ds_read_b64_tr_b16 v[158:159], v106 offset:12288
  v_mfma_f32_16x16x32_bf16 v[52:55], v[128:131], v[136:139], v[52:55]
  ds_read_b64_tr_b16 v[160:161], v107 offset:8192
  v_mfma_f32_16x16x32_bf16 v[56:59], v[116:119], v[140:143], v[56:59]
  ds_read_b64_tr_b16 v[162:163], v107 offset:12288
  v_mfma_f32_16x16x32_bf16 v[60:63], v[120:123], v[140:143], v[60:63]
  ds_read_b128 v[168:171], v92 offset:9216
  v_mfma_f32_16x16x32_bf16 v[64:67], v[124:127], v[140:143], v[64:67]
  ds_read_b128 v[172:175], v93 offset:8192
  v_mfma_f32_16x16x32_bf16 v[68:71], v[128:131], v[140:143], v[68:71]
  ds_read_b128 v[176:179], v93 offset:9216
  v_mfma_f32_16x16x32_bf16 v[72:75], v[116:119], v[144:147], v[72:75]
  v_mfma_f32_16x16x32_bf16 v[76:79], v[120:123], v[144:147], v[76:79]
  v_mfma_f32_16x16x32_bf16 v[80:83], v[124:127], v[144:147], v[80:83]
  v_mfma_f32_16x16x32_bf16 v[84:87], v[128:131], v[144:147], v[84:87]
  s_waitcnt lgkmcnt(0)
  s_barrier
  v_mfma_f32_16x16x32_bf16 v[24:27], v[148:151], v[164:167], v[24:27]
  ds_read_b128 v[132:135], v88 offset:0
  v_mfma_f32_16x16x32_bf16 v[28:31], v[152:155], v[164:167], v[28:31]
  ds_read_b64_tr_b16 v[116:117], v96 offset:0
  v_mfma_f32_16x16x32_bf16 v[32:35], v[156:159], v[164:167], v[32:35]
  ds_read_b64_tr_b16 v[118:119], v96 offset:4096
  v_mfma_f32_16x16x32_bf16 v[36:39], v[160:163], v[164:167], v[36:39]
  ds_read_b64_tr_b16 v[120:121], v97 offset:0
  v_mfma_f32_16x16x32_bf16 v[40:43], v[148:151], v[168:171], v[40:43]
  ds_read_b64_tr_b16 v[122:123], v97 offset:4096
  v_mfma_f32_16x16x32_bf16 v[44:47], v[152:155], v[168:171], v[44:47]
  ds_read_b64_tr_b16 v[124:125], v98 offset:0
  v_mfma_f32_16x16x32_bf16 v[48:51], v[156:159], v[168:171], v[48:51]
  ds_read_b64_tr_b16 v[126:127], v98 offset:4096
  v_mfma_f32_16x16x32_bf16 v[52:55], v[160:163], v[168:171], v[52:55]
  ds_read_b64_tr_b16 v[128:129], v99 offset:0
  v_mfma_f32_16x16x32_bf16 v[56:59], v[148:151], v[172:175], v[56:59]
  ds_read_b64_tr_b16 v[130:131], v99 offset:4096
  v_mfma_f32_16x16x32_bf16 v[60:63], v[152:155], v[172:175], v[60:63]
  ds_read_b128 v[136:139], v88 offset:1024
  v_mfma_f32_16x16x32_bf16 v[64:67], v[156:159], v[172:175], v[64:67]
  ds_read_b128 v[140:143], v89 offset:0
  v_mfma_f32_16x16x32_bf16 v[68:71], v[160:163], v[172:175], v[68:71]
  ds_read_b128 v[144:147], v89 offset:1024
  v_mfma_f32_16x16x32_bf16 v[72:75], v[148:151], v[176:179], v[72:75]
  v_mfma_f32_16x16x32_bf16 v[76:79], v[152:155], v[176:179], v[76:79]
  v_mfma_f32_16x16x32_bf16 v[80:83], v[156:159], v[176:179], v[80:83]
  v_mfma_f32_16x16x32_bf16 v[84:87], v[160:163], v[176:179], v[84:87]
  s_waitcnt lgkmcnt(0)
  v_mfma_f32_16x16x32_bf16 v[24:27], v[116:119], v[132:135], v[24:27]
  ds_read_b128 v[164:167], v88 offset:8192
  v_mfma_f32_16x16x32_bf16 v[28:31], v[120:123], v[132:135], v[28:31]
  ds_read_b64_tr_b16 v[148:149], v96 offset:8192
  v_mfma_f32_16x16x32_bf16 v[32:35], v[124:127], v[132:135], v[32:35]
  ds_read_b64_tr_b16 v[150:151], v96 offset:12288
  v_mfma_f32_16x16x32_bf16 v[36:39], v[128:131], v[132:135], v[36:39]
  ds_read_b64_tr_b16 v[152:153], v97 offset:8192
  v_mfma_f32_16x16x32_bf16 v[40:43], v[116:119], v[136:139], v[40:43]
  ds_read_b64_tr_b16 v[154:155], v97 offset:12288
  v_mfma_f32_16x16x32_bf16 v[44:47], v[120:123], v[136:139], v[44:47]
  ds_read_b64_tr_b16 v[156:157], v98 offset:8192
  v_mfma_f32_16x16x32_bf16 v[48:51], v[124:127], v[136:139], v[48:51]
  ds_read_b64_tr_b16 v[158:159], v98 offset:12288
  v_mfma_f32_16x16x32_bf16 v[52:55], v[128:131], v[136:139], v[52:55]
  ds_read_b64_tr_b16 v[160:161], v99 offset:8192
  v_mfma_f32_16x16x32_bf16 v[56:59], v[116:119], v[140:143], v[56:59]
  ds_read_b64_tr_b16 v[162:163], v99 offset:12288
  v_mfma_f32_16x16x32_bf16 v[60:63], v[120:123], v[140:143], v[60:63]
  ds_read_b128 v[168:171], v88 offset:9216
  v_mfma_f32_16x16x32_bf16 v[64:67], v[124:127], v[140:143], v[64:67]
  ds_read_b128 v[172:175], v89 offset:8192
  v_mfma_f32_16x16x32_bf16 v[68:71], v[128:131], v[140:143], v[68:71]
  ds_read_b128 v[176:179], v89 offset:9216
  v_mfma_f32_16x16x32_bf16 v[72:75], v[116:119], v[144:147], v[72:75]
  v_mfma_f32_16x16x32_bf16 v[76:79], v[120:123], v[144:147], v[76:79]
  v_mfma_f32_16x16x32_bf16 v[80:83], v[124:127], v[144:147], v[80:83]
  v_mfma_f32_16x16x32_bf16 v[84:87], v[128:131], v[144:147], v[84:87]
  s_waitcnt lgkmcnt(0)
  s_barrier
  v_mfma_f32_16x16x32_bf16 v[24:27], v[148:151], v[164:167], v[24:27]
  ds_read_b128 v[132:135], v88 offset:32768
  v_mfma_f32_16x16x32_bf16 v[28:31], v[152:155], v[164:167], v[28:31]
  ds_read_b64_tr_b16 v[116:117], v96 offset:32768
  v_mfma_f32_16x16x32_bf16 v[32:35], v[156:159], v[164:167], v[32:35]
  ds_read_b64_tr_b16 v[118:119], v96 offset:36864
  v_mfma_f32_16x16x32_bf16 v[36:39], v[160:163], v[164:167], v[36:39]
  ds_read_b64_tr_b16 v[120:121], v97 offset:32768
  v_mfma_f32_16x16x32_bf16 v[40:43], v[148:151], v[168:171], v[40:43]
  ds_read_b64_tr_b16 v[122:123], v97 offset:36864
  v_mfma_f32_16x16x32_bf16 v[44:47], v[152:155], v[168:171], v[44:47]
  ds_read_b64_tr_b16 v[124:125], v98 offset:32768
  v_mfma_f32_16x16x32_bf16 v[48:51], v[156:159], v[168:171], v[48:51]
  ds_read_b64_tr_b16 v[126:127], v98 offset:36864
  v_mfma_f32_16x16x32_bf16 v[52:55], v[160:163], v[168:171], v[52:55]
  ds_read_b64_tr_b16 v[128:129], v99 offset:32768
  v_mfma_f32_16x16x32_bf16 v[56:59], v[148:151], v[172:175], v[56:59]
  ds_read_b64_tr_b16 v[130:131], v99 offset:36864
  v_mfma_f32_16x16x32_bf16 v[60:63], v[152:155], v[172:175], v[60:63]
  ds_read_b128 v[136:139], v88 offset:33792
  v_mfma_f32_16x16x32_bf16 v[64:67], v[156:159], v[172:175], v[64:67]
  ds_read_b128 v[140:143], v89 offset:32768
  v_mfma_f32_16x16x32_bf16 v[68:71], v[160:163], v[172:175], v[68:71]
  ds_read_b128 v[144:147], v89 offset:33792
  v_mfma_f32_16x16x32_bf16 v[72:75], v[148:151], v[176:179], v[72:75]
  v_mfma_f32_16x16x32_bf16 v[76:79], v[152:155], v[176:179], v[76:79]
  v_mfma_f32_16x16x32_bf16 v[80:83], v[156:159], v[176:179], v[80:83]
  v_mfma_f32_16x16x32_bf16 v[84:87], v[160:163], v[176:179], v[84:87]
  s_waitcnt lgkmcnt(0)
  v_mfma_f32_16x16x32_bf16 v[24:27], v[116:119], v[132:135], v[24:27]
  ds_read_b128 v[164:167], v88 offset:40960
  v_mfma_f32_16x16x32_bf16 v[28:31], v[120:123], v[132:135], v[28:31]
  ds_read_b64_tr_b16 v[148:149], v96 offset:40960
  v_mfma_f32_16x16x32_bf16 v[32:35], v[124:127], v[132:135], v[32:35]
  ds_read_b64_tr_b16 v[150:151], v96 offset:45056
  v_mfma_f32_16x16x32_bf16 v[36:39], v[128:131], v[132:135], v[36:39]
  ds_read_b64_tr_b16 v[152:153], v97 offset:40960
  v_mfma_f32_16x16x32_bf16 v[40:43], v[116:119], v[136:139], v[40:43]
  ds_read_b64_tr_b16 v[154:155], v97 offset:45056
  v_mfma_f32_16x16x32_bf16 v[44:47], v[120:123], v[136:139], v[44:47]
  ds_read_b64_tr_b16 v[156:157], v98 offset:40960
  v_mfma_f32_16x16x32_bf16 v[48:51], v[124:127], v[136:139], v[48:51]
  ds_read_b64_tr_b16 v[158:159], v98 offset:45056
  v_mfma_f32_16x16x32_bf16 v[52:55], v[128:131], v[136:139], v[52:55]
  ds_read_b64_tr_b16 v[160:161], v99 offset:40960
  v_mfma_f32_16x16x32_bf16 v[56:59], v[116:119], v[140:143], v[56:59]
  ds_read_b64_tr_b16 v[162:163], v99 offset:45056
  v_mfma_f32_16x16x32_bf16 v[60:63], v[120:123], v[140:143], v[60:63]
  ds_read_b128 v[168:171], v88 offset:41984
  v_mfma_f32_16x16x32_bf16 v[64:67], v[124:127], v[140:143], v[64:67]
  ds_read_b128 v[172:175], v89 offset:40960
  v_mfma_f32_16x16x32_bf16 v[68:71], v[128:131], v[140:143], v[68:71]
  ds_read_b128 v[176:179], v89 offset:41984
  v_mfma_f32_16x16x32_bf16 v[72:75], v[116:119], v[144:147], v[72:75]
  v_mfma_f32_16x16x32_bf16 v[76:79], v[120:123], v[144:147], v[76:79]
  v_mfma_f32_16x16x32_bf16 v[80:83], v[124:127], v[144:147], v[80:83]
  v_mfma_f32_16x16x32_bf16 v[84:87], v[128:131], v[144:147], v[84:87]
  s_waitcnt lgkmcnt(0)
  s_barrier
  v_mfma_f32_16x16x32_bf16 v[24:27], v[148:151], v[164:167], v[24:27]
  ds_read_b128 v[132:135], v90 offset:0
  v_mfma_f32_16x16x32_bf16 v[28:31], v[152:155], v[164:167], v[28:31]
  ds_read_b64_tr_b16 v[116:117], v100 offset:0
  v_mfma_f32_16x16x32_bf16 v[32:35], v[156:159], v[164:167], v[32:35]
  ds_read_b64_tr_b16 v[118:119], v100 offset:4096
  v_mfma_f32_16x16x32_bf16 v[36:39], v[160:163], v[164:167], v[36:39]
  ds_read_b64_tr_b16 v[120:121], v101 offset:0
  v_mfma_f32_16x16x32_bf16 v[40:43], v[148:151], v[168:171], v[40:43]
  ds_read_b64_tr_b16 v[122:123], v101 offset:4096
  v_mfma_f32_16x16x32_bf16 v[44:47], v[152:155], v[168:171], v[44:47]
  ds_read_b64_tr_b16 v[124:125], v102 offset:0
  v_mfma_f32_16x16x32_bf16 v[48:51], v[156:159], v[168:171], v[48:51]
  ds_read_b64_tr_b16 v[126:127], v102 offset:4096
  v_mfma_f32_16x16x32_bf16 v[52:55], v[160:163], v[168:171], v[52:55]
  ds_read_b64_tr_b16 v[128:129], v103 offset:0
  v_mfma_f32_16x16x32_bf16 v[56:59], v[148:151], v[172:175], v[56:59]
  ds_read_b64_tr_b16 v[130:131], v103 offset:4096
  v_mfma_f32_16x16x32_bf16 v[60:63], v[152:155], v[172:175], v[60:63]
  ds_read_b128 v[136:139], v90 offset:1024
  v_mfma_f32_16x16x32_bf16 v[64:67], v[156:159], v[172:175], v[64:67]
  ds_read_b128 v[140:143], v91 offset:0
  v_mfma_f32_16x16x32_bf16 v[68:71], v[160:163], v[172:175], v[68:71]
  ds_read_b128 v[144:147], v91 offset:1024
  v_mfma_f32_16x16x32_bf16 v[72:75], v[148:151], v[176:179], v[72:75]
  v_mfma_f32_16x16x32_bf16 v[76:79], v[152:155], v[176:179], v[76:79]
  v_mfma_f32_16x16x32_bf16 v[80:83], v[156:159], v[176:179], v[80:83]
  v_mfma_f32_16x16x32_bf16 v[84:87], v[160:163], v[176:179], v[84:87]
  s_waitcnt lgkmcnt(0)
  v_mfma_f32_16x16x32_bf16 v[24:27], v[116:119], v[132:135], v[24:27]
  ds_read_b128 v[164:167], v90 offset:8192
  v_mfma_f32_16x16x32_bf16 v[28:31], v[120:123], v[132:135], v[28:31]
  ds_read_b64_tr_b16 v[148:149], v100 offset:8192
  v_mfma_f32_16x16x32_bf16 v[32:35], v[124:127], v[132:135], v[32:35]
  ds_read_b64_tr_b16 v[150:151], v100 offset:12288
  v_mfma_f32_16x16x32_bf16 v[36:39], v[128:131], v[132:135], v[36:39]
  ds_read_b64_tr_b16 v[152:153], v101 offset:8192
  v_mfma_f32_16x16x32_bf16 v[40:43], v[116:119], v[136:139], v[40:43]
  ds_read_b64_tr_b16 v[154:155], v101 offset:12288
  v_mfma_f32_16x16x32_bf16 v[44:47], v[120:123], v[136:139], v[44:47]
  ds_read_b64_tr_b16 v[156:157], v102 offset:8192
  v_mfma_f32_16x16x32_bf16 v[48:51], v[124:127], v[136:139], v[48:51]
  ds_read_b64_tr_b16 v[158:159], v102 offset:12288
  v_mfma_f32_16x16x32_bf16 v[52:55], v[128:131], v[136:139], v[52:55]
  ds_read_b64_tr_b16 v[160:161], v103 offset:8192
  v_mfma_f32_16x16x32_bf16 v[56:59], v[116:119], v[140:143], v[56:59]
  ds_read_b64_tr_b16 v[162:163], v103 offset:12288
  v_mfma_f32_16x16x32_bf16 v[60:63], v[120:123], v[140:143], v[60:63]
  ds_read_b128 v[168:171], v90 offset:9216
  v_mfma_f32_16x16x32_bf16 v[64:67], v[124:127], v[140:143], v[64:67]
  ds_read_b128 v[172:175], v91 offset:8192
  v_mfma_f32_16x16x32_bf16 v[68:71], v[128:131], v[140:143], v[68:71]
  ds_read_b128 v[176:179], v91 offset:9216
  v_mfma_f32_16x16x32_bf16 v[72:75], v[116:119], v[144:147], v[72:75]
  v_mfma_f32_16x16x32_bf16 v[76:79], v[120:123], v[144:147], v[76:79]
  v_mfma_f32_16x16x32_bf16 v[80:83], v[124:127], v[144:147], v[80:83]
  v_mfma_f32_16x16x32_bf16 v[84:87], v[128:131], v[144:147], v[84:87]
  s_waitcnt lgkmcnt(0)
  s_barrier
  v_mfma_f32_16x16x32_bf16 v[24:27], v[148:151], v[164:167], v[24:27]
  ds_read_b128 v[132:135], v90 offset:32768
  v_mfma_f32_16x16x32_bf16 v[28:31], v[152:155], v[164:167], v[28:31]
  ds_read_b64_tr_b16 v[116:117], v100 offset:32768
  v_mfma_f32_16x16x32_bf16 v[32:35], v[156:159], v[164:167], v[32:35]
  ds_read_b64_tr_b16 v[118:119], v100 offset:36864
  v_mfma_f32_16x16x32_bf16 v[36:39], v[160:163], v[164:167], v[36:39]
  ds_read_b64_tr_b16 v[120:121], v101 offset:32768
  v_mfma_f32_16x16x32_bf16 v[40:43], v[148:151], v[168:171], v[40:43]
  ds_read_b64_tr_b16 v[122:123], v101 offset:36864
  v_mfma_f32_16x16x32_bf16 v[44:47], v[152:155], v[168:171], v[44:47]
  ds_read_b64_tr_b16 v[124:125], v102 offset:32768
  v_mfma_f32_16x16x32_bf16 v[48:51], v[156:159], v[168:171], v[48:51]
  ds_read_b64_tr_b16 v[126:127], v102 offset:36864
  v_mfma_f32_16x16x32_bf16 v[52:55], v[160:163], v[168:171], v[52:55]
  ds_read_b64_tr_b16 v[128:129], v103 offset:32768
  v_mfma_f32_16x16x32_bf16 v[56:59], v[148:151], v[172:175], v[56:59]
  ds_read_b64_tr_b16 v[130:131], v103 offset:36864
  v_mfma_f32_16x16x32_bf16 v[60:63], v[152:155], v[172:175], v[60:63]
  ds_read_b128 v[136:139], v90 offset:33792
  v_mfma_f32_16x16x32_bf16 v[64:67], v[156:159], v[172:175], v[64:67]
  ds_read_b128 v[140:143], v91 offset:32768
  v_mfma_f32_16x16x32_bf16 v[68:71], v[160:163], v[172:175], v[68:71]
  ds_read_b128 v[144:147], v91 offset:33792
  v_mfma_f32_16x16x32_bf16 v[72:75], v[148:151], v[176:179], v[72:75]
  v_mfma_f32_16x16x32_bf16 v[76:79], v[152:155], v[176:179], v[76:79]
  v_mfma_f32_16x16x32_bf16 v[80:83], v[156:159], v[176:179], v[80:83]
  v_mfma_f32_16x16x32_bf16 v[84:87], v[160:163], v[176:179], v[84:87]
  s_waitcnt lgkmcnt(0)
  v_mfma_f32_16x16x32_bf16 v[24:27], v[116:119], v[132:135], v[24:27]
  ds_read_b128 v[164:167], v90 offset:40960
  v_mfma_f32_16x16x32_bf16 v[28:31], v[120:123], v[132:135], v[28:31]
  ds_read_b64_tr_b16 v[148:149], v100 offset:40960
  v_mfma_f32_16x16x32_bf16 v[32:35], v[124:127], v[132:135], v[32:35]
  ds_read_b64_tr_b16 v[150:151], v100 offset:45056
  v_mfma_f32_16x16x32_bf16 v[36:39], v[128:131], v[132:135], v[36:39]
  ds_read_b64_tr_b16 v[152:153], v101 offset:40960
  v_mfma_f32_16x16x32_bf16 v[40:43], v[116:119], v[136:139], v[40:43]
  ds_read_b64_tr_b16 v[154:155], v101 offset:45056
  v_mfma_f32_16x16x32_bf16 v[44:47], v[120:123], v[136:139], v[44:47]
  ds_read_b64_tr_b16 v[156:157], v102 offset:40960
  v_mfma_f32_16x16x32_bf16 v[48:51], v[124:127], v[136:139], v[48:51]
  ds_read_b64_tr_b16 v[158:159], v102 offset:45056
  v_mfma_f32_16x16x32_bf16 v[52:55], v[128:131], v[136:139], v[52:55]
  ds_read_b64_tr_b16 v[160:161], v103 offset:40960
  v_mfma_f32_16x16x32_bf16 v[56:59], v[116:119], v[140:143], v[56:59]
  ds_read_b64_tr_b16 v[162:163], v103 offset:45056
  v_mfma_f32_16x16x32_bf16 v[60:63], v[120:123], v[140:143], v[60:63]
  ds_read_b128 v[168:171], v90 offset:41984
  v_mfma_f32_16x16x32_bf16 v[64:67], v[124:127], v[140:143], v[64:67]
  ds_read_b128 v[172:175], v91 offset:40960
  v_mfma_f32_16x16x32_bf16 v[68:71], v[128:131], v[140:143], v[68:71]
  ds_read_b128 v[176:179], v91 offset:41984
  v_mfma_f32_16x16x32_bf16 v[72:75], v[116:119], v[144:147], v[72:75]
  v_mfma_f32_16x16x32_bf16 v[76:79], v[120:123], v[144:147], v[76:79]
  v_mfma_f32_16x16x32_bf16 v[80:83], v[124:127], v[144:147], v[80:83]
  v_mfma_f32_16x16x32_bf16 v[84:87], v[128:131], v[144:147], v[84:87]
  s_waitcnt lgkmcnt(0)
  s_barrier
  v_mfma_f32_16x16x32_bf16 v[24:27], v[148:151], v[164:167], v[24:27]
  ds_read_b128 v[132:135], v92 offset:0
  v_mfma_f32_16x16x32_bf16 v[28:31], v[152:155], v[164:167], v[28:31]
  ds_read_b64_tr_b16 v[116:117], v104 offset:0
  v_mfma_f32_16x16x32_bf16 v[32:35], v[156:159], v[164:167], v[32:35]
  ds_read_b64_tr_b16 v[118:119], v104 offset:4096
  v_mfma_f32_16x16x32_bf16 v[36:39], v[160:163], v[164:167], v[36:39]
  ds_read_b64_tr_b16 v[120:121], v105 offset:0
  v_mfma_f32_16x16x32_bf16 v[40:43], v[148:151], v[168:171], v[40:43]
  ds_read_b64_tr_b16 v[122:123], v105 offset:4096
  v_mfma_f32_16x16x32_bf16 v[44:47], v[152:155], v[168:171], v[44:47]
  ds_read_b64_tr_b16 v[124:125], v106 offset:0
  v_mfma_f32_16x16x32_bf16 v[48:51], v[156:159], v[168:171], v[48:51]
  ds_read_b64_tr_b16 v[126:127], v106 offset:4096
  v_mfma_f32_16x16x32_bf16 v[52:55], v[160:163], v[168:171], v[52:55]
  ds_read_b64_tr_b16 v[128:129], v107 offset:0
  v_mfma_f32_16x16x32_bf16 v[56:59], v[148:151], v[172:175], v[56:59]
  ds_read_b64_tr_b16 v[130:131], v107 offset:4096
  v_mfma_f32_16x16x32_bf16 v[60:63], v[152:155], v[172:175], v[60:63]
  ds_read_b128 v[136:139], v92 offset:1024
  v_mfma_f32_16x16x32_bf16 v[64:67], v[156:159], v[172:175], v[64:67]
  ds_read_b128 v[140:143], v93 offset:0
  v_mfma_f32_16x16x32_bf16 v[68:71], v[160:163], v[172:175], v[68:71]
  ds_read_b128 v[144:147], v93 offset:1024
  v_mfma_f32_16x16x32_bf16 v[72:75], v[148:151], v[176:179], v[72:75]
  v_mfma_f32_16x16x32_bf16 v[76:79], v[152:155], v[176:179], v[76:79]
  v_mfma_f32_16x16x32_bf16 v[80:83], v[156:159], v[176:179], v[80:83]
  v_mfma_f32_16x16x32_bf16 v[84:87], v[160:163], v[176:179], v[84:87]
  s_waitcnt lgkmcnt(0)
  v_mfma_f32_16x16x32_bf16 v[24:27], v[116:119], v[132:135], v[24:27]
  ds_read_b128 v[164:167], v92 offset:8192
  v_mfma_f32_16x16x32_bf16 v[28:31], v[120:123], v[132:135], v[28:31]
  ds_read_b64_tr_b16 v[148:149], v104 offset:8192
  v_mfma_f32_16x16x32_bf16 v[32:35], v[124:127], v[132:135], v[32:35]
  ds_read_b64_tr_b16 v[150:151], v104 offset:12288
  v_mfma_f32_16x16x32_bf16 v[36:39], v[128:131], v[132:135], v[36:39]
  ds_read_b64_tr_b16 v[152:153], v105 offset:8192
  v_mfma_f32_16x16x32_bf16 v[40:43], v[116:119], v[136:139], v[40:43]
  ds_read_b64_tr_b16 v[154:155], v105 offset:12288
  v_mfma_f32_16x16x32_bf16 v[44:47], v[120:123], v[136:139], v[44:47]
  ds_read_b64_tr_b16 v[156:157], v106 offset:8192
  v_mfma_f32_16x16x32_bf16 v[48:51], v[124:127], v[136:139], v[48:51]
  ds_read_b64_tr_b16 v[158:159], v106 offset:12288
  v_mfma_f32_16x16x32_bf16 v[52:55], v[128:131], v[136:139], v[52:55]
  ds_read_b64_tr_b16 v[160:161], v107 offset:8192
  v_mfma_f32_16x16x32_bf16 v[56:59], v[116:119], v[140:143], v[56:59]
  ds_read_b64_tr_b16 v[162:163], v107 offset:12288
  v_mfma_f32_16x16x32_bf16 v[60:63], v[120:123], v[140:143], v[60:63]
  ds_read_b128 v[168:171], v92 offset:9216
  v_mfma_f32_16x16x32_bf16 v[64:67], v[124:127], v[140:143], v[64:67]
  ds_read_b128 v[172:175], v93 offset:8192
  v_mfma_f32_16x16x32_bf16 v[68:71], v[128:131], v[140:143], v[68:71]
  ds_read_b128 v[176:179], v93 offset:9216
  v_mfma_f32_16x16x32_bf16 v[72:75], v[116:119], v[144:147], v[72:75]
  buffer_load_dwordx4 v[180:183], v108, s[56:59], s39 offen offset:0 sc1
  v_mfma_f32_16x16x32_bf16 v[76:79], v[120:123], v[144:147], v[76:79]
  v_mfma_f32_16x16x32_bf16 v[80:83], v[124:127], v[144:147], v[80:83]
  v_mfma_f32_16x16x32_bf16 v[84:87], v[128:131], v[144:147], v[84:87]
  s_waitcnt lgkmcnt(0)
  s_barrier
  v_mfma_f32_16x16x32_bf16 v[24:27], v[148:151], v[164:167], v[24:27]
  ds_read_b128 v[132:135], v88 offset:0
  v_mfma_f32_16x16x32_bf16 v[28:31], v[152:155], v[164:167], v[28:31]
  ds_read_b64_tr_b16 v[116:117], v96 offset:0
  v_mfma_f32_16x16x32_bf16 v[32:35], v[156:159], v[164:167], v[32:35]
  ds_read_b64_tr_b16 v[118:119], v96 offset:4096
  v_mfma_f32_16x16x32_bf16 v[36:39], v[160:163], v[164:167], v[36:39]
  ds_read_b64_tr_b16 v[120:121], v97 offset:0
  v_mfma_f32_16x16x32_bf16 v[40:43], v[148:151], v[168:171], v[40:43]
  ds_read_b64_tr_b16 v[122:123], v97 offset:4096
  v_mfma_f32_16x16x32_bf16 v[44:47], v[152:155], v[168:171], v[44:47]
  ds_read_b64_tr_b16 v[124:125], v98 offset:0
  v_mfma_f32_16x16x32_bf16 v[48:51], v[156:159], v[168:171], v[48:51]
  ds_read_b64_tr_b16 v[126:127], v98 offset:4096
  v_mfma_f32_16x16x32_bf16 v[52:55], v[160:163], v[168:171], v[52:55]
  ds_read_b64_tr_b16 v[128:129], v99 offset:0
  v_mfma_f32_16x16x32_bf16 v[56:59], v[148:151], v[172:175], v[56:59]
  ds_read_b64_tr_b16 v[130:131], v99 offset:4096
  v_mfma_f32_16x16x32_bf16 v[60:63], v[152:155], v[172:175], v[60:63]
  ds_read_b128 v[136:139], v88 offset:1024
  v_mfma_f32_16x16x32_bf16 v[64:67], v[156:159], v[172:175], v[64:67]
  ds_read_b128 v[140:143], v89 offset:0
  v_mfma_f32_16x16x32_bf16 v[68:71], v[160:163], v[172:175], v[68:71]
  ds_read_b128 v[144:147], v89 offset:1024
  v_mfma_f32_16x16x32_bf16 v[72:75], v[148:151], v[176:179], v[72:75]
  v_mfma_f32_16x16x32_bf16 v[76:79], v[152:155], v[176:179], v[76:79]
  v_mfma_f32_16x16x32_bf16 v[80:83], v[156:159], v[176:179], v[80:83]
  v_mfma_f32_16x16x32_bf16 v[84:87], v[160:163], v[176:179], v[84:87]
  s_waitcnt lgkmcnt(0)
  v_mfma_f32_16x16x32_bf16 v[24:27], v[116:119], v[132:135], v[24:27]
  ds_read_b128 v[164:167], v88 offset:8192
  v_mfma_f32_16x16x32_bf16 v[28:31], v[120:123], v[132:135], v[28:31]
  ds_read_b64_tr_b16 v[148:149], v96 offset:8192
  v_mfma_f32_16x16x32_bf16 v[32:35], v[124:127], v[132:135], v[32:35]
  ds_read_b64_tr_b16 v[150:151], v96 offset:12288
  v_mfma_f32_16x16x32_bf16 v[36:39], v[128:131], v[132:135], v[36:39]
  ds_read_b64_tr_b16 v[152:153], v97 offset:8192
  v_mfma_f32_16x16x32_bf16 v[40:43], v[116:119], v[136:139], v[40:43]
  ds_read_b64_tr_b16 v[154:155], v97 offset:12288
  v_mfma_f32_16x16x32_bf16 v[44:47], v[120:123], v[136:139], v[44:47]
  ds_read_b64_tr_b16 v[156:157], v98 offset:8192
  v_mfma_f32_16x16x32_bf16 v[48:51], v[124:127], v[136:139], v[48:51]
  ds_read_b64_tr_b16 v[158:159], v98 offset:12288
  v_mfma_f32_16x16x32_bf16 v[52:55], v[128:131], v[136:139], v[52:55]
  ds_read_b64_tr_b16 v[160:161], v99 offset:8192
  v_mfma_f32_16x16x32_bf16 v[56:59], v[116:119], v[140:143], v[56:59]
  ds_read_b64_tr_b16 v[162:163], v99 offset:12288
  v_mfma_f32_16x16x32_bf16 v[60:63], v[120:123], v[140:143], v[60:63]
  ds_read_b128 v[168:171], v88 offset:9216
  v_mfma_f32_16x16x32_bf16 v[64:67], v[124:127], v[140:143], v[64:67]
  ds_read_b128 v[172:175], v89 offset:8192
  v_mfma_f32_16x16x32_bf16 v[68:71], v[128:131], v[140:143], v[68:71]
  ds_read_b128 v[176:179], v89 offset:9216
  v_mfma_f32_16x16x32_bf16 v[72:75], v[116:119], v[144:147], v[72:75]
  buffer_load_dwordx4 v[184:187], v108, s[56:59], s39 offen offset:64 sc1
  v_mfma_f32_16x16x32_bf16 v[76:79], v[120:123], v[144:147], v[76:79]
  v_mfma_f32_16x16x32_bf16 v[80:83], v[124:127], v[144:147], v[80:83]
  v_mfma_f32_16x16x32_bf16 v[84:87], v[128:131], v[144:147], v[84:87]
  s_waitcnt lgkmcnt(0)
  s_barrier
  v_mfma_f32_16x16x32_bf16 v[24:27], v[148:151], v[164:167], v[24:27]
  ds_read_b128 v[132:135], v88 offset:32768
  v_mfma_f32_16x16x32_bf16 v[28:31], v[152:155], v[164:167], v[28:31]
  ds_read_b64_tr_b16 v[116:117], v96 offset:32768
  v_mfma_f32_16x16x32_bf16 v[32:35], v[156:159], v[164:167], v[32:35]
  ds_read_b64_tr_b16 v[118:119], v96 offset:36864
  v_mfma_f32_16x16x32_bf16 v[36:39], v[160:163], v[164:167], v[36:39]
  ds_read_b64_tr_b16 v[120:121], v97 offset:32768
  v_mfma_f32_16x16x32_bf16 v[40:43], v[148:151], v[168:171], v[40:43]
  ds_read_b64_tr_b16 v[122:123], v97 offset:36864
  v_mfma_f32_16x16x32_bf16 v[44:47], v[152:155], v[168:171], v[44:47]
  ds_read_b64_tr_b16 v[124:125], v98 offset:32768
  v_mfma_f32_16x16x32_bf16 v[48:51], v[156:159], v[168:171], v[48:51]
  ds_read_b64_tr_b16 v[126:127], v98 offset:36864
  v_mfma_f32_16x16x32_bf16 v[52:55], v[160:163], v[168:171], v[52:55]
  ds_read_b64_tr_b16 v[128:129], v99 offset:32768
  v_mfma_f32_16x16x32_bf16 v[56:59], v[148:151], v[172:175], v[56:59]
  ds_read_b64_tr_b16 v[130:131], v99 offset:36864
  v_mfma_f32_16x16x32_bf16 v[60:63], v[152:155], v[172:175], v[60:63]
  ds_read_b128 v[136:139], v88 offset:33792
  v_mfma_f32_16x16x32_bf16 v[64:67], v[156:159], v[172:175], v[64:67]
  ds_read_b128 v[140:143], v89 offset:32768
  v_mfma_f32_16x16x32_bf16 v[68:71], v[160:163], v[172:175], v[68:71]
  ds_read_b128 v[144:147], v89 offset:33792
  v_mfma_f32_16x16x32_bf16 v[72:75], v[148:151], v[176:179], v[72:75]
  v_mfma_f32_16x16x32_bf16 v[76:79], v[152:155], v[176:179], v[76:79]
  v_mfma_f32_16x16x32_bf16 v[80:83], v[156:159], v[176:179], v[80:83]
  v_mfma_f32_16x16x32_bf16 v[84:87], v[160:163], v[176:179], v[84:87]
  s_waitcnt lgkmcnt(0)
  v_mfma_f32_16x16x32_bf16 v[24:27], v[116:119], v[132:135], v[24:27]
  ds_read_b128 v[164:167], v88 offset:40960
  v_mfma_f32_16x16x32_bf16 v[28:31], v[120:123], v[132:135], v[28:31]
  ds_read_b64_tr_b16 v[148:149], v96 offset:40960
  v_mfma_f32_16x16x32_bf16 v[32:35], v[124:127], v[132:135], v[32:35]
  ds_read_b64_tr_b16 v[150:151], v96 offset:45056
  v_mfma_f32_16x16x32_bf16 v[36:39], v[128:131], v[132:135], v[36:39]
  ds_read_b64_tr_b16 v[152:153], v97 offset:40960
  v_mfma_f32_16x16x32_bf16 v[40:43], v[116:119], v[136:139], v[40:43]
  ds_read_b64_tr_b16 v[154:155], v97 offset:45056
  v_mfma_f32_16x16x32_bf16 v[44:47], v[120:123], v[136:139], v[44:47]
  ds_read_b64_tr_b16 v[156:157], v98 offset:40960
  v_mfma_f32_16x16x32_bf16 v[48:51], v[124:127], v[136:139], v[48:51]
  ds_read_b64_tr_b16 v[158:159], v98 offset:45056
  v_mfma_f32_16x16x32_bf16 v[52:55], v[128:131], v[136:139], v[52:55]
  ds_read_b64_tr_b16 v[160:161], v99 offset:40960
  v_mfma_f32_16x16x32_bf16 v[56:59], v[116:119], v[140:143], v[56:59]
  ds_read_b64_tr_b16 v[162:163], v99 offset:45056
  v_mfma_f32_16x16x32_bf16 v[60:63], v[120:123], v[140:143], v[60:63]
  ds_read_b128 v[168:171], v88 offset:41984
  v_mfma_f32_16x16x32_bf16 v[64:67], v[124:127], v[140:143], v[64:67]
  ds_read_b128 v[172:175], v89 offset:40960
  v_mfma_f32_16x16x32_bf16 v[68:71], v[128:131], v[140:143], v[68:71]
  ds_read_b128 v[176:179], v89 offset:41984
  v_mfma_f32_16x16x32_bf16 v[72:75], v[116:119], v[144:147], v[72:75]
  buffer_load_dwordx4 v[188:191], v108, s[56:59], s43 offen offset:0 sc1
  v_mfma_f32_16x16x32_bf16 v[76:79], v[120:123], v[144:147], v[76:79]
  v_mfma_f32_16x16x32_bf16 v[80:83], v[124:127], v[144:147], v[80:83]
  v_mfma_f32_16x16x32_bf16 v[84:87], v[128:131], v[144:147], v[84:87]
  s_waitcnt lgkmcnt(0)
  s_barrier
  v_mfma_f32_16x16x32_bf16 v[24:27], v[148:151], v[164:167], v[24:27]
  ds_read_b128 v[132:135], v90 offset:0
  v_mfma_f32_16x16x32_bf16 v[28:31], v[152:155], v[164:167], v[28:31]
  ds_read_b64_tr_b16 v[116:117], v100 offset:0
  v_mfma_f32_16x16x32_bf16 v[32:35], v[156:159], v[164:167], v[32:35]
  ds_read_b64_tr_b16 v[118:119], v100 offset:4096
  v_mfma_f32_16x16x32_bf16 v[36:39], v[160:163], v[164:167], v[36:39]
  ds_read_b64_tr_b16 v[120:121], v101 offset:0
  v_mfma_f32_16x16x32_bf16 v[40:43], v[148:151], v[168:171], v[40:43]
  ds_read_b64_tr_b16 v[122:123], v101 offset:4096
  v_mfma_f32_16x16x32_bf16 v[44:47], v[152:155], v[168:171], v[44:47]
  ds_read_b64_tr_b16 v[124:125], v102 offset:0
  v_mfma_f32_16x16x32_bf16 v[48:51], v[156:159], v[168:171], v[48:51]
  ds_read_b64_tr_b16 v[126:127], v102 offset:4096
  v_mfma_f32_16x16x32_bf16 v[52:55], v[160:163], v[168:171], v[52:55]
  ds_read_b64_tr_b16 v[128:129], v103 offset:0
  v_mfma_f32_16x16x32_bf16 v[56:59], v[148:151], v[172:175], v[56:59]
  ds_read_b64_tr_b16 v[130:131], v103 offset:4096
  v_mfma_f32_16x16x32_bf16 v[60:63], v[152:155], v[172:175], v[60:63]
  ds_read_b128 v[136:139], v90 offset:1024
  v_mfma_f32_16x16x32_bf16 v[64:67], v[156:159], v[172:175], v[64:67]
  ds_read_b128 v[140:143], v91 offset:0
  v_mfma_f32_16x16x32_bf16 v[68:71], v[160:163], v[172:175], v[68:71]
  ds_read_b128 v[144:147], v91 offset:1024
  v_mfma_f32_16x16x32_bf16 v[72:75], v[148:151], v[176:179], v[72:75]
  v_mfma_f32_16x16x32_bf16 v[76:79], v[152:155], v[176:179], v[76:79]
  v_mfma_f32_16x16x32_bf16 v[80:83], v[156:159], v[176:179], v[80:83]
  v_mfma_f32_16x16x32_bf16 v[84:87], v[160:163], v[176:179], v[84:87]
  s_waitcnt lgkmcnt(0)
  v_mfma_f32_16x16x32_bf16 v[24:27], v[116:119], v[132:135], v[24:27]
  ds_read_b128 v[164:167], v90 offset:8192
  v_mfma_f32_16x16x32_bf16 v[28:31], v[120:123], v[132:135], v[28:31]
  ds_read_b64_tr_b16 v[148:149], v100 offset:8192
  v_mfma_f32_16x16x32_bf16 v[32:35], v[124:127], v[132:135], v[32:35]
  ds_read_b64_tr_b16 v[150:151], v100 offset:12288
  v_mfma_f32_16x16x32_bf16 v[36:39], v[128:131], v[132:135], v[36:39]
  ds_read_b64_tr_b16 v[152:153], v101 offset:8192
  v_mfma_f32_16x16x32_bf16 v[40:43], v[116:119], v[136:139], v[40:43]
  ds_read_b64_tr_b16 v[154:155], v101 offset:12288
  v_mfma_f32_16x16x32_bf16 v[44:47], v[120:123], v[136:139], v[44:47]
  ds_read_b64_tr_b16 v[156:157], v102 offset:8192
  v_mfma_f32_16x16x32_bf16 v[48:51], v[124:127], v[136:139], v[48:51]
  ds_read_b64_tr_b16 v[158:159], v102 offset:12288
  v_mfma_f32_16x16x32_bf16 v[52:55], v[128:131], v[136:139], v[52:55]
  ds_read_b64_tr_b16 v[160:161], v103 offset:8192
  v_mfma_f32_16x16x32_bf16 v[56:59], v[116:119], v[140:143], v[56:59]
  ds_read_b64_tr_b16 v[162:163], v103 offset:12288
  v_mfma_f32_16x16x32_bf16 v[60:63], v[120:123], v[140:143], v[60:63]
  ds_read_b128 v[168:171], v90 offset:9216
  v_mfma_f32_16x16x32_bf16 v[64:67], v[124:127], v[140:143], v[64:67]
  ds_read_b128 v[172:175], v91 offset:8192
  v_mfma_f32_16x16x32_bf16 v[68:71], v[128:131], v[140:143], v[68:71]
  ds_read_b128 v[176:179], v91 offset:9216
  v_mfma_f32_16x16x32_bf16 v[72:75], v[116:119], v[144:147], v[72:75]
  buffer_load_dwordx4 v[192:195], v108, s[56:59], s43 offen offset:64 sc1
  v_mfma_f32_16x16x32_bf16 v[76:79], v[120:123], v[144:147], v[76:79]
  v_mfma_f32_16x16x32_bf16 v[80:83], v[124:127], v[144:147], v[80:83]
  v_mfma_f32_16x16x32_bf16 v[84:87], v[128:131], v[144:147], v[84:87]
  s_waitcnt lgkmcnt(0)
  s_barrier
  v_mfma_f32_16x16x32_bf16 v[24:27], v[148:151], v[164:167], v[24:27]
  ds_read_b128 v[132:135], v90 offset:32768
  v_mfma_f32_16x16x32_bf16 v[28:31], v[152:155], v[164:167], v[28:31]
  ds_read_b64_tr_b16 v[116:117], v100 offset:32768
  v_mfma_f32_16x16x32_bf16 v[32:35], v[156:159], v[164:167], v[32:35]
  ds_read_b64_tr_b16 v[118:119], v100 offset:36864
  v_mfma_f32_16x16x32_bf16 v[36:39], v[160:163], v[164:167], v[36:39]
  ds_read_b64_tr_b16 v[120:121], v101 offset:32768
  v_mfma_f32_16x16x32_bf16 v[40:43], v[148:151], v[168:171], v[40:43]
  ds_read_b64_tr_b16 v[122:123], v101 offset:36864
  v_mfma_f32_16x16x32_bf16 v[44:47], v[152:155], v[168:171], v[44:47]
  ds_read_b64_tr_b16 v[124:125], v102 offset:32768
  v_mfma_f32_16x16x32_bf16 v[48:51], v[156:159], v[168:171], v[48:51]
  ds_read_b64_tr_b16 v[126:127], v102 offset:36864
  v_mfma_f32_16x16x32_bf16 v[52:55], v[160:163], v[168:171], v[52:55]
  ds_read_b64_tr_b16 v[128:129], v103 offset:32768
  v_mfma_f32_16x16x32_bf16 v[56:59], v[148:151], v[172:175], v[56:59]
  ds_read_b64_tr_b16 v[130:131], v103 offset:36864
  v_mfma_f32_16x16x32_bf16 v[60:63], v[152:155], v[172:175], v[60:63]
  ds_read_b128 v[136:139], v90 offset:33792
  v_mfma_f32_16x16x32_bf16 v[64:67], v[156:159], v[172:175], v[64:67]
  ds_read_b128 v[140:143], v91 offset:32768
  v_mfma_f32_16x16x32_bf16 v[68:71], v[160:163], v[172:175], v[68:71]
  ds_read_b128 v[144:147], v91 offset:33792
  v_mfma_f32_16x16x32_bf16 v[72:75], v[148:151], v[176:179], v[72:75]
  v_mfma_f32_16x16x32_bf16 v[76:79], v[152:155], v[176:179], v[76:79]
  v_mfma_f32_16x16x32_bf16 v[80:83], v[156:159], v[176:179], v[80:83]
  v_mfma_f32_16x16x32_bf16 v[84:87], v[160:163], v[176:179], v[84:87]
  s_waitcnt lgkmcnt(0)
  v_mfma_f32_16x16x32_bf16 v[24:27], v[116:119], v[132:135], v[24:27]
  ds_read_b128 v[164:167], v90 offset:40960
  v_mfma_f32_16x16x32_bf16 v[28:31], v[120:123], v[132:135], v[28:31]
  ds_read_b64_tr_b16 v[148:149], v100 offset:40960
  v_mfma_f32_16x16x32_bf16 v[32:35], v[124:127], v[132:135], v[32:35]
  ds_read_b64_tr_b16 v[150:151], v100 offset:45056
  v_mfma_f32_16x16x32_bf16 v[36:39], v[128:131], v[132:135], v[36:39]
  ds_read_b64_tr_b16 v[152:153], v101 offset:40960
  v_mfma_f32_16x16x32_bf16 v[40:43], v[116:119], v[136:139], v[40:43]
  ds_read_b64_tr_b16 v[154:155], v101 offset:45056
  v_mfma_f32_16x16x32_bf16 v[44:47], v[120:123], v[136:139], v[44:47]
  ds_read_b64_tr_b16 v[156:157], v102 offset:40960
  v_mfma_f32_16x16x32_bf16 v[48:51], v[124:127], v[136:139], v[48:51]
  ds_read_b64_tr_b16 v[158:159], v102 offset:45056
  v_mfma_f32_16x16x32_bf16 v[52:55], v[128:131], v[136:139], v[52:55]
  ds_read_b64_tr_b16 v[160:161], v103 offset:40960
  v_mfma_f32_16x16x32_bf16 v[56:59], v[116:119], v[140:143], v[56:59]
  ds_read_b64_tr_b16 v[162:163], v103 offset:45056
  v_mfma_f32_16x16x32_bf16 v[60:63], v[120:123], v[140:143], v[60:63]
  ds_read_b128 v[168:171], v90 offset:41984
  v_mfma_f32_16x16x32_bf16 v[64:67], v[124:127], v[140:143], v[64:67]
  ds_read_b128 v[172:175], v91 offset:40960
  v_mfma_f32_16x16x32_bf16 v[68:71], v[128:131], v[140:143], v[68:71]
  ds_read_b128 v[176:179], v91 offset:41984
  v_mfma_f32_16x16x32_bf16 v[72:75], v[116:119], v[144:147], v[72:75]
  buffer_load_dwordx4 v[196:199], v110, s[52:55], s40 offen offset:0 sc1
  v_mfma_f32_16x16x32_bf16 v[76:79], v[120:123], v[144:147], v[76:79]
  v_mfma_f32_16x16x32_bf16 v[80:83], v[124:127], v[144:147], v[80:83]
  v_mfma_f32_16x16x32_bf16 v[84:87], v[128:131], v[144:147], v[84:87]
  s_waitcnt lgkmcnt(0)
  s_barrier
  v_mfma_f32_16x16x32_bf16 v[24:27], v[148:151], v[164:167], v[24:27]
  ds_read_b128 v[132:135], v92 offset:0
  v_mfma_f32_16x16x32_bf16 v[28:31], v[152:155], v[164:167], v[28:31]
  ds_read_b64_tr_b16 v[116:117], v104 offset:0
  v_mfma_f32_16x16x32_bf16 v[32:35], v[156:159], v[164:167], v[32:35]
  ds_read_b64_tr_b16 v[118:119], v104 offset:4096
  v_mfma_f32_16x16x32_bf16 v[36:39], v[160:163], v[164:167], v[36:39]
  ds_read_b64_tr_b16 v[120:121], v105 offset:0
  v_mfma_f32_16x16x32_bf16 v[40:43], v[148:151], v[168:171], v[40:43]
  ds_read_b64_tr_b16 v[122:123], v105 offset:4096
  v_mfma_f32_16x16x32_bf16 v[44:47], v[152:155], v[168:171], v[44:47]
  ds_read_b64_tr_b16 v[124:125], v106 offset:0
  v_mfma_f32_16x16x32_bf16 v[48:51], v[156:159], v[168:171], v[48:51]
  ds_read_b64_tr_b16 v[126:127], v106 offset:4096
  v_mfma_f32_16x16x32_bf16 v[52:55], v[160:163], v[168:171], v[52:55]
  ds_read_b64_tr_b16 v[128:129], v107 offset:0
  v_mfma_f32_16x16x32_bf16 v[56:59], v[148:151], v[172:175], v[56:59]
  ds_read_b64_tr_b16 v[130:131], v107 offset:4096
  v_mfma_f32_16x16x32_bf16 v[60:63], v[152:155], v[172:175], v[60:63]
  ds_read_b128 v[136:139], v92 offset:1024
  v_mfma_f32_16x16x32_bf16 v[64:67], v[156:159], v[172:175], v[64:67]
  ds_read_b128 v[140:143], v93 offset:0
  v_mfma_f32_16x16x32_bf16 v[68:71], v[160:163], v[172:175], v[68:71]
  ds_read_b128 v[144:147], v93 offset:1024
  v_mfma_f32_16x16x32_bf16 v[72:75], v[148:151], v[176:179], v[72:75]
  v_mfma_f32_16x16x32_bf16 v[76:79], v[152:155], v[176:179], v[76:79]
  v_mfma_f32_16x16x32_bf16 v[80:83], v[156:159], v[176:179], v[80:83]
  v_mfma_f32_16x16x32_bf16 v[84:87], v[160:163], v[176:179], v[84:87]
  s_waitcnt lgkmcnt(0)
  v_mfma_f32_16x16x32_bf16 v[24:27], v[116:119], v[132:135], v[24:27]
  ds_read_b128 v[164:167], v92 offset:8192
  v_mfma_f32_16x16x32_bf16 v[28:31], v[120:123], v[132:135], v[28:31]
  ds_read_b64_tr_b16 v[148:149], v104 offset:8192
  v_mfma_f32_16x16x32_bf16 v[32:35], v[124:127], v[132:135], v[32:35]
  ds_read_b64_tr_b16 v[150:151], v104 offset:12288
  v_mfma_f32_16x16x32_bf16 v[36:39], v[128:131], v[132:135], v[36:39]
  ds_read_b64_tr_b16 v[152:153], v105 offset:8192
  v_mfma_f32_16x16x32_bf16 v[40:43], v[116:119], v[136:139], v[40:43]
  ds_read_b64_tr_b16 v[154:155], v105 offset:12288
  v_mfma_f32_16x16x32_bf16 v[44:47], v[120:123], v[136:139], v[44:47]
  ds_read_b64_tr_b16 v[156:157], v106 offset:8192
  v_mfma_f32_16x16x32_bf16 v[48:51], v[124:127], v[136:139], v[48:51]
  ds_read_b64_tr_b16 v[158:159], v106 offset:12288
  v_mfma_f32_16x16x32_bf16 v[52:55], v[128:131], v[136:139], v[52:55]
  ds_read_b64_tr_b16 v[160:161], v107 offset:8192
  v_mfma_f32_16x16x32_bf16 v[56:59], v[116:119], v[140:143], v[56:59]
  ds_read_b64_tr_b16 v[162:163], v107 offset:12288
  v_mfma_f32_16x16x32_bf16 v[60:63], v[120:123], v[140:143], v[60:63]
  ds_read_b128 v[168:171], v92 offset:9216
  v_mfma_f32_16x16x32_bf16 v[64:67], v[124:127], v[140:143], v[64:67]
  ds_read_b128 v[172:175], v93 offset:8192
  v_mfma_f32_16x16x32_bf16 v[68:71], v[128:131], v[140:143], v[68:71]
  ds_read_b128 v[176:179], v93 offset:9216
  v_mfma_f32_16x16x32_bf16 v[72:75], v[116:119], v[144:147], v[72:75]
  buffer_load_dwordx4 v[200:203], v110, s[52:55], s40 offen offset:64 sc1
  v_mfma_f32_16x16x32_bf16 v[76:79], v[120:123], v[144:147], v[76:79]
  v_mfma_f32_16x16x32_bf16 v[80:83], v[124:127], v[144:147], v[80:83]
  v_mfma_f32_16x16x32_bf16 v[84:87], v[128:131], v[144:147], v[84:87]
  s_waitcnt lgkmcnt(0)
  s_barrier
  v_mfma_f32_16x16x32_bf16 v[24:27], v[148:151], v[164:167], v[24:27]
  ds_read_b128 v[132:135], v88 offset:0
  v_mfma_f32_16x16x32_bf16 v[28:31], v[152:155], v[164:167], v[28:31]
  ds_read_b64_tr_b16 v[116:117], v96 offset:0
  v_mfma_f32_16x16x32_bf16 v[32:35], v[156:159], v[164:167], v[32:35]
  ds_read_b64_tr_b16 v[118:119], v96 offset:4096
  v_mfma_f32_16x16x32_bf16 v[36:39], v[160:163], v[164:167], v[36:39]
  ds_read_b64_tr_b16 v[120:121], v97 offset:0
  v_mfma_f32_16x16x32_bf16 v[40:43], v[148:151], v[168:171], v[40:43]
  ds_read_b64_tr_b16 v[122:123], v97 offset:4096
  v_mfma_f32_16x16x32_bf16 v[44:47], v[152:155], v[168:171], v[44:47]
  ds_read_b64_tr_b16 v[124:125], v98 offset:0
  v_mfma_f32_16x16x32_bf16 v[48:51], v[156:159], v[168:171], v[48:51]
  ds_read_b64_tr_b16 v[126:127], v98 offset:4096
  v_mfma_f32_16x16x32_bf16 v[52:55], v[160:163], v[168:171], v[52:55]
  ds_read_b64_tr_b16 v[128:129], v99 offset:0
  v_mfma_f32_16x16x32_bf16 v[56:59], v[148:151], v[172:175], v[56:59]
  ds_read_b64_tr_b16 v[130:131], v99 offset:4096
  v_mfma_f32_16x16x32_bf16 v[60:63], v[152:155], v[172:175], v[60:63]
  ds_read_b128 v[136:139], v88 offset:1024
  v_mfma_f32_16x16x32_bf16 v[64:67], v[156:159], v[172:175], v[64:67]
  ds_read_b128 v[140:143], v89 offset:0
  v_mfma_f32_16x16x32_bf16 v[68:71], v[160:163], v[172:175], v[68:71]
  ds_read_b128 v[144:147], v89 offset:1024
  v_mfma_f32_16x16x32_bf16 v[72:75], v[148:151], v[176:179], v[72:75]
  v_mfma_f32_16x16x32_bf16 v[76:79], v[152:155], v[176:179], v[76:79]
  v_mfma_f32_16x16x32_bf16 v[80:83], v[156:159], v[176:179], v[80:83]
  v_mfma_f32_16x16x32_bf16 v[84:87], v[160:163], v[176:179], v[84:87]
  s_waitcnt lgkmcnt(0)
  v_mfma_f32_16x16x32_bf16 v[24:27], v[116:119], v[132:135], v[24:27]
  ds_read_b128 v[164:167], v88 offset:8192
  v_mfma_f32_16x16x32_bf16 v[28:31], v[120:123], v[132:135], v[28:31]
  ds_read_b64_tr_b16 v[148:149], v96 offset:8192
  v_mfma_f32_16x16x32_bf16 v[32:35], v[124:127], v[132:135], v[32:35]
  ds_read_b64_tr_b16 v[150:151], v96 offset:12288
  v_mfma_f32_16x16x32_bf16 v[36:39], v[128:131], v[132:135], v[36:39]
  ds_read_b64_tr_b16 v[152:153], v97 offset:8192
  v_mfma_f32_16x16x32_bf16 v[40:43], v[116:119], v[136:139], v[40:43]
  ds_read_b64_tr_b16 v[154:155], v97 offset:12288
  v_mfma_f32_16x16x32_bf16 v[44:47], v[120:123], v[136:139], v[44:47]
  ds_read_b64_tr_b16 v[156:157], v98 offset:8192
  v_mfma_f32_16x16x32_bf16 v[48:51], v[124:127], v[136:139], v[48:51]
  ds_read_b64_tr_b16 v[158:159], v98 offset:12288
  v_mfma_f32_16x16x32_bf16 v[52:55], v[128:131], v[136:139], v[52:55]
  ds_read_b64_tr_b16 v[160:161], v99 offset:8192
  v_mfma_f32_16x16x32_bf16 v[56:59], v[116:119], v[140:143], v[56:59]
  ds_read_b64_tr_b16 v[162:163], v99 offset:12288
  v_mfma_f32_16x16x32_bf16 v[60:63], v[120:123], v[140:143], v[60:63]
  ds_read_b128 v[168:171], v88 offset:9216
  v_mfma_f32_16x16x32_bf16 v[64:67], v[124:127], v[140:143], v[64:67]
  ds_read_b128 v[172:175], v89 offset:8192
  v_mfma_f32_16x16x32_bf16 v[68:71], v[128:131], v[140:143], v[68:71]
  ds_read_b128 v[176:179], v89 offset:9216
  v_mfma_f32_16x16x32_bf16 v[72:75], v[116:119], v[144:147], v[72:75]
  buffer_load_dwordx4 v[204:207], v110, s[48:51], s40 offen offset:0
  v_mfma_f32_16x16x32_bf16 v[76:79], v[120:123], v[144:147], v[76:79]
  v_mfma_f32_16x16x32_bf16 v[80:83], v[124:127], v[144:147], v[80:83]
  v_mfma_f32_16x16x32_bf16 v[84:87], v[128:131], v[144:147], v[84:87]
  s_waitcnt lgkmcnt(0)
  s_barrier
  v_mfma_f32_16x16x32_bf16 v[24:27], v[148:151], v[164:167], v[24:27]
  ds_read_b128 v[132:135], v88 offset:32768
  v_mfma_f32_16x16x32_bf16 v[28:31], v[152:155], v[164:167], v[28:31]
  ds_read_b64_tr_b16 v[116:117], v96 offset:32768
  v_mfma_f32_16x16x32_bf16 v[32:35], v[156:159], v[164:167], v[32:35]
  ds_read_b64_tr_b16 v[118:119], v96 offset:36864
  v_mfma_f32_16x16x32_bf16 v[36:39], v[160:163], v[164:167], v[36:39]
  ds_read_b64_tr_b16 v[120:121], v97 offset:32768
  v_mfma_f32_16x16x32_bf16 v[40:43], v[148:151], v[168:171], v[40:43]
  ds_read_b64_tr_b16 v[122:123], v97 offset:36864
  v_mfma_f32_16x16x32_bf16 v[44:47], v[152:155], v[168:171], v[44:47]
  ds_read_b64_tr_b16 v[124:125], v98 offset:32768
  v_mfma_f32_16x16x32_bf16 v[48:51], v[156:159], v[168:171], v[48:51]
  ds_read_b64_tr_b16 v[126:127], v98 offset:36864
  v_mfma_f32_16x16x32_bf16 v[52:55], v[160:163], v[168:171], v[52:55]
  ds_read_b64_tr_b16 v[128:129], v99 offset:32768
  v_mfma_f32_16x16x32_bf16 v[56:59], v[148:151], v[172:175], v[56:59]
  ds_read_b64_tr_b16 v[130:131], v99 offset:36864
  v_mfma_f32_16x16x32_bf16 v[60:63], v[152:155], v[172:175], v[60:63]
  ds_read_b128 v[136:139], v88 offset:33792
  v_mfma_f32_16x16x32_bf16 v[64:67], v[156:159], v[172:175], v[64:67]
  ds_read_b128 v[140:143], v89 offset:32768
  v_mfma_f32_16x16x32_bf16 v[68:71], v[160:163], v[172:175], v[68:71]
  ds_read_b128 v[144:147], v89 offset:33792
  v_mfma_f32_16x16x32_bf16 v[72:75], v[148:151], v[176:179], v[72:75]
  v_mfma_f32_16x16x32_bf16 v[76:79], v[152:155], v[176:179], v[76:79]
  v_mfma_f32_16x16x32_bf16 v[80:83], v[156:159], v[176:179], v[80:83]
  v_mfma_f32_16x16x32_bf16 v[84:87], v[160:163], v[176:179], v[84:87]
  s_waitcnt lgkmcnt(0)
  v_mfma_f32_16x16x32_bf16 v[24:27], v[116:119], v[132:135], v[24:27]
  ds_read_b128 v[164:167], v88 offset:40960
  v_mfma_f32_16x16x32_bf16 v[28:31], v[120:123], v[132:135], v[28:31]
  ds_read_b64_tr_b16 v[148:149], v96 offset:40960
  v_mfma_f32_16x16x32_bf16 v[32:35], v[124:127], v[132:135], v[32:35]
  ds_read_b64_tr_b16 v[150:151], v96 offset:45056
  v_mfma_f32_16x16x32_bf16 v[36:39], v[128:131], v[132:135], v[36:39]
  ds_read_b64_tr_b16 v[152:153], v97 offset:40960
  v_mfma_f32_16x16x32_bf16 v[40:43], v[116:119], v[136:139], v[40:43]
  ds_read_b64_tr_b16 v[154:155], v97 offset:45056
  v_mfma_f32_16x16x32_bf16 v[44:47], v[120:123], v[136:139], v[44:47]
  ds_read_b64_tr_b16 v[156:157], v98 offset:40960
  v_mfma_f32_16x16x32_bf16 v[48:51], v[124:127], v[136:139], v[48:51]
  ds_read_b64_tr_b16 v[158:159], v98 offset:45056
  v_mfma_f32_16x16x32_bf16 v[52:55], v[128:131], v[136:139], v[52:55]
  ds_read_b64_tr_b16 v[160:161], v99 offset:40960
  v_mfma_f32_16x16x32_bf16 v[56:59], v[116:119], v[140:143], v[56:59]
  ds_read_b64_tr_b16 v[162:163], v99 offset:45056
  v_mfma_f32_16x16x32_bf16 v[60:63], v[120:123], v[140:143], v[60:63]
  ds_read_b128 v[168:171], v88 offset:41984
  v_mfma_f32_16x16x32_bf16 v[64:67], v[124:127], v[140:143], v[64:67]
  ds_read_b128 v[172:175], v89 offset:40960
  v_mfma_f32_16x16x32_bf16 v[68:71], v[128:131], v[140:143], v[68:71]
  ds_read_b128 v[176:179], v89 offset:41984
  v_mfma_f32_16x16x32_bf16 v[72:75], v[116:119], v[144:147], v[72:75]
  buffer_load_dwordx4 v[208:211], v110, s[48:51], s40 offen offset:64
  v_mfma_f32_16x16x32_bf16 v[76:79], v[120:123], v[144:147], v[76:79]
  v_mfma_f32_16x16x32_bf16 v[80:83], v[124:127], v[144:147], v[80:83]
  v_mfma_f32_16x16x32_bf16 v[84:87], v[128:131], v[144:147], v[84:87]
  s_waitcnt lgkmcnt(0)
  s_barrier
  v_mfma_f32_16x16x32_bf16 v[24:27], v[148:151], v[164:167], v[24:27]
  ds_read_b128 v[132:135], v90 offset:0
  v_mfma_f32_16x16x32_bf16 v[28:31], v[152:155], v[164:167], v[28:31]
  ds_read_b64_tr_b16 v[116:117], v100 offset:0
  v_mfma_f32_16x16x32_bf16 v[32:35], v[156:159], v[164:167], v[32:35]
  ds_read_b64_tr_b16 v[118:119], v100 offset:4096
  v_mfma_f32_16x16x32_bf16 v[36:39], v[160:163], v[164:167], v[36:39]
  ds_read_b64_tr_b16 v[120:121], v101 offset:0
  v_mfma_f32_16x16x32_bf16 v[40:43], v[148:151], v[168:171], v[40:43]
  ds_read_b64_tr_b16 v[122:123], v101 offset:4096
  v_mfma_f32_16x16x32_bf16 v[44:47], v[152:155], v[168:171], v[44:47]
  ds_read_b64_tr_b16 v[124:125], v102 offset:0
  v_mfma_f32_16x16x32_bf16 v[48:51], v[156:159], v[168:171], v[48:51]
  ds_read_b64_tr_b16 v[126:127], v102 offset:4096
  v_mfma_f32_16x16x32_bf16 v[52:55], v[160:163], v[168:171], v[52:55]
  ds_read_b64_tr_b16 v[128:129], v103 offset:0
  v_mfma_f32_16x16x32_bf16 v[56:59], v[148:151], v[172:175], v[56:59]
  ds_read_b64_tr_b16 v[130:131], v103 offset:4096
  v_mfma_f32_16x16x32_bf16 v[60:63], v[152:155], v[172:175], v[60:63]
  ds_read_b128 v[136:139], v90 offset:1024
  v_mfma_f32_16x16x32_bf16 v[64:67], v[156:159], v[172:175], v[64:67]
  ds_read_b128 v[140:143], v91 offset:0
  v_mfma_f32_16x16x32_bf16 v[68:71], v[160:163], v[172:175], v[68:71]
  ds_read_b128 v[144:147], v91 offset:1024
  v_mfma_f32_16x16x32_bf16 v[72:75], v[148:151], v[176:179], v[72:75]
  v_mfma_f32_16x16x32_bf16 v[76:79], v[152:155], v[176:179], v[76:79]
  v_mfma_f32_16x16x32_bf16 v[80:83], v[156:159], v[176:179], v[80:83]
  v_mfma_f32_16x16x32_bf16 v[84:87], v[160:163], v[176:179], v[84:87]
  s_waitcnt lgkmcnt(0)
  v_mfma_f32_16x16x32_bf16 v[24:27], v[116:119], v[132:135], v[24:27]
  ds_read_b128 v[164:167], v90 offset:8192
  v_mfma_f32_16x16x32_bf16 v[28:31], v[120:123], v[132:135], v[28:31]
  ds_read_b64_tr_b16 v[148:149], v100 offset:8192
  v_mfma_f32_16x16x32_bf16 v[32:35], v[124:127], v[132:135], v[32:35]
  ds_read_b64_tr_b16 v[150:151], v100 offset:12288
  v_mfma_f32_16x16x32_bf16 v[36:39], v[128:131], v[132:135], v[36:39]
  ds_read_b64_tr_b16 v[152:153], v101 offset:8192
  v_mfma_f32_16x16x32_bf16 v[40:43], v[116:119], v[136:139], v[40:43]
  ds_read_b64_tr_b16 v[154:155], v101 offset:12288
  v_mfma_f32_16x16x32_bf16 v[44:47], v[120:123], v[136:139], v[44:47]
  ds_read_b64_tr_b16 v[156:157], v102 offset:8192
  v_mfma_f32_16x16x32_bf16 v[48:51], v[124:127], v[136:139], v[48:51]
  ds_read_b64_tr_b16 v[158:159], v102 offset:12288
  v_mfma_f32_16x16x32_bf16 v[52:55], v[128:131], v[136:139], v[52:55]
  ds_read_b64_tr_b16 v[160:161], v103 offset:8192
  v_mfma_f32_16x16x32_bf16 v[56:59], v[116:119], v[140:143], v[56:59]
  ds_read_b64_tr_b16 v[162:163], v103 offset:12288
  v_mfma_f32_16x16x32_bf16 v[60:63], v[120:123], v[140:143], v[60:63]
  ds_read_b128 v[168:171], v90 offset:9216
  v_mfma_f32_16x16x32_bf16 v[64:67], v[124:127], v[140:143], v[64:67]
  ds_read_b128 v[172:175], v91 offset:8192
  v_mfma_f32_16x16x32_bf16 v[68:71], v[128:131], v[140:143], v[68:71]
  ds_read_b128 v[176:179], v91 offset:9216
  v_mfma_f32_16x16x32_bf16 v[72:75], v[116:119], v[144:147], v[72:75]
  v_mfma_f32_16x16x32_bf16 v[76:79], v[120:123], v[144:147], v[76:79]
  v_mfma_f32_16x16x32_bf16 v[80:83], v[124:127], v[144:147], v[80:83]
  v_mfma_f32_16x16x32_bf16 v[84:87], v[128:131], v[144:147], v[84:87]
  s_waitcnt lgkmcnt(0)
  buffer_load_dword v6, v113, s[64:67], s45 offen sc1
  v_mfma_f32_16x16x32_bf16 v[56:59], v[148:151], v[172:175], v[56:59]
  v_mfma_f32_16x16x32_bf16 v[60:63], v[152:155], v[172:175], v[60:63]
  v_mfma_f32_16x16x32_bf16 v[64:67], v[156:159], v[172:175], v[64:67]
  v_mfma_f32_16x16x32_bf16 v[68:71], v[160:163], v[172:175], v[68:71]
  v_mfma_f32_16x16x32_bf16 v[72:75], v[148:151], v[176:179], v[72:75]
  v_mfma_f32_16x16x32_bf16 v[76:79], v[152:155], v[176:179], v[76:79]
  v_mfma_f32_16x16x32_bf16 v[80:83], v[156:159], v[176:179], v[80:83]
  v_mfma_f32_16x16x32_bf16 v[84:87], v[160:163], v[176:179], v[84:87]
  v_mfma_f32_16x16x32_bf16 v[24:27], v[148:151], v[164:167], v[24:27]
  v_mfma_f32_16x16x32_bf16 v[28:31], v[152:155], v[164:167], v[28:31]
  v_mfma_f32_16x16x32_bf16 v[32:35], v[156:159], v[164:167], v[32:35]
  v_mfma_f32_16x16x32_bf16 v[36:39], v[160:163], v[164:167], v[36:39]
  v_mfma_f32_16x16x32_bf16 v[40:43], v[148:151], v[168:171], v[40:43]
  v_mfma_f32_16x16x32_bf16 v[44:47], v[152:155], v[168:171], v[44:47]
  v_mfma_f32_16x16x32_bf16 v[48:51], v[156:159], v[168:171], v[48:51]
  v_mfma_f32_16x16x32_bf16 v[52:55], v[160:163], v[168:171], v[52:55]
CG_epi2:
  v_bfi_b32 v56, s46, v112, v56
  buffer_store_dwordx4 v[56:59], v12, s[64:67], s44 offen offset:0 sc1
  v_bfi_b32 v60, s46, v112, v60
  buffer_store_dwordx4 v[60:63], v12, s[64:67], s44 offen offset:1024 sc1
  v_bfi_b32 v64, s46, v112, v64
  buffer_store_dwordx4 v[64:67], v12, s[64:67], s44 offen offset:2048 sc1
  v_bfi_b32 v68, s46, v112, v68
  buffer_store_dwordx4 v[68:71], v12, s[64:67], s44 offen offset:3072 sc1
  v_bfi_b32 v72, s46, v112, v72
  buffer_store_dwordx4 v[72:75], v111, s[64:67], s44 offen offset:0 sc1
  v_bfi_b32 v76, s46, v112, v76
  buffer_store_dwordx4 v[76:79], v111, s[64:67], s44 offen offset:1024 sc1
  v_bfi_b32 v80, s46, v112, v80
  buffer_store_dwordx4 v[80:83], v111, s[64:67], s44 offen offset:2048 sc1
  v_bfi_b32 v84, s46, v112, v84
  buffer_store_dwordx4 v[84:87], v111, s[64:67], s44 offen offset:3072 sc1
  s_waitcnt vmcnt(9)
  v_permlane16_swap_b32 v180, v182
  v_permlane16_swap_b32 v181, v183
  v_permlane16_swap_b32 v184, v186
  v_permlane16_swap_b32 v185, v187
  v_permlane16_swap_b32 v188, v190
  v_permlane16_swap_b32 v189, v191
  v_permlane16_swap_b32 v192, v194
  v_permlane16_swap_b32 v193, v195
  v_permlane16_swap_b32 v196, v198
  v_permlane16_swap_b32 v197, v199
  v_permlane16_swap_b32 v200, v202
  v_permlane16_swap_b32 v201, v203
  v_permlane16_swap_b32 v204, v206
  v_permlane16_swap_b32 v205, v207
  v_permlane16_swap_b32 v208, v210
  v_permlane16_swap_b32 v209, v211
  s_waitcnt vmcnt(8)
  v_xor_b32 v6, v112, v6
  v_and_b32 v6, 0xff, v6
  v_cmp_ne_u32 vcc, 0, v6
  s_mov_b32 s47, 0
  s_nop 3
  s_cbranch_vccnz EX_ne
  buffer_load_dwordx4 v[56:59], v12, s[64:67], s45 offen offset:0 sc1
  buffer_load_dwordx4 v[60:63], v12, s[64:67], s45 offen offset:1024 sc1
  buffer_load_dwordx4 v[64:67], v12, s[64:67], s45 offen offset:2048 sc1
  buffer_load_dwordx4 v[68:71], v12, s[64:67], s45 offen offset:3072 sc1
  buffer_load_dwordx4 v[72:75], v111, s[64:67], s45 offen offset:0 sc1
  buffer_load_dwordx4 v[76:79], v111, s[64:67], s45 offen offset:1024 sc1
  buffer_load_dwordx4 v[80:83], v111, s[64:67], s45 offen offset:2048 sc1
  buffer_load_dwordx4 v[84:87], v111, s[64:67], s45 offen offset:3072 sc1
  s_mov_b32 s47, 1
EX_ne:
  v_lshlrev_b32 v116, 16, v196
  v_and_b32 v117, s19, v196
  v_lshlrev_b32 v118, 16, v197
  v_and_b32 v119, s19, v197
  v_lshlrev_b32 v120, 16, v198
  v_and_b32 v121, s19, v198
  v_lshlrev_b32 v122, 16, v199
  v_and_b32 v123, s19, v199
  v_lshlrev_b32 v124, 16, v200
  v_and_b32 v125, s19, v200
  v_lshlrev_b32 v126, 16, v201
  v_and_b32 v127, s19, v201
  v_lshlrev_b32 v128, 16, v202
  v_and_b32 v129, s19, v202
  v_lshlrev_b32 v130, 16, v203
  v_and_b32 v131, s19, v203
  v_lshlrev_b32 v132, 16, v204
  v_and_b32 v133, s19, v204
  v_lshlrev_b32 v134, 16, v205
  v_and_b32 v135, s19, v205
  v_lshlrev_b32 v136, 16, v206
  v_and_b32 v137, s19, v206
  v_lshlrev_b32 v138, 16, v207
  v_and_b32 v139, s19, v207
  v_lshlrev_b32 v140, 16, v208
  v_and_b32 v141, s19, v208
  v_lshlrev_b32 v142, 16, v209
  v_and_b32 v143, s19, v209
  v_lshlrev_b32 v144, 16, v210
  v_and_b32 v145, s19, v210
  v_lshlrev_b32 v146, 16, v211
  v_and_b32 v147, s19, v211
  v_lshlrev_b32 v148, 16, v180
  v_and_b32 v149, s19, v180
  v_lshlrev_b32 v150, 16, v181
  v_and_b32 v151, s19, v181
  v_lshlrev_b32 v152, 16, v182
  v_and_b32 v153, s19, v182
  v_lshlrev_b32 v154, 16, v183
  v_and_b32 v155, s19, v183
  v_lshlrev_b32 v156, 16, v184
  v_and_b32 v157, s19, v184
  v_lshlrev_b32 v158, 16, v185
  v_and_b32 v159, s19, v185
  v_lshlrev_b32 v160, 16, v186
  v_and_b32 v161, s19, v186
  v_lshlrev_b32 v162, 16, v187
  v_and_b32 v163, s19, v187
  v_lshlrev_b32 v164, 16, v188
  v_and_b32 v165, s19, v188
  v_lshlrev_b32 v166, 16, v189
  v_and_b32 v167, s19, v189
  v_lshlrev_b32 v168, 16, v190
  v_and_b32 v169, s19, v190
  v_lshlrev_b32 v170, 16, v191
  v_and_b32 v171, s19, v191
  v_lshlrev_b32 v172, 16, v192
  v_and_b32 v173, s19, v192
  v_lshlrev_b32 v174, 16, v193
  v_and_b32 v175, s19, v193
  v_lshlrev_b32 v176, 16, v194
  v_and_b32 v177, s19, v194
  v_lshlrev_b32 v178, 16, v195
  v_and_b32 v179, s19, v195
  v_pk_add_f32 v[24:25], v[24:25], v[132:133]
  v_pk_add_f32 v[26:27], v[26:27], v[134:135]
  v_pk_add_f32 v[28:29], v[28:29], v[136:137]
  v_pk_add_f32 v[30:31], v[30:31], v[138:139]
  v_pk_add_f32 v[32:33], v[32:33], v[140:141]
  v_pk_add_f32 v[34:35], v[34:35], v[142:143]
  v_pk_add_f32 v[36:37], v[36:37], v[144:145]
  v_pk_add_f32 v[38:39], v[38:39], v[146:147]
  v_pk_add_f32 v[40:41], v[40:41], v[132:133]
  v_pk_add_f32 v[42:43], v[42:43], v[134:135]
  v_pk_add_f32 v[44:45], v[44:45], v[136:137]
  v_pk_add_f32 v[46:47], v[46:47], v[138:139]
  v_pk_add_f32 v[48:49], v[48:49], v[140:141]
  v_pk_add_f32 v[50:51], v[50:51], v[142:143]
  v_pk_add_f32 v[52:53], v[52:53], v[144:145]
  v_pk_add_f32 v[54:55], v[54:55], v[146:147]
  v_pk_fma_f32 v[148:149], v[24:25], v[116:117], v[148:149]
  v_pk_fma_f32 v[150:151], v[26:27], v[118:119], v[150:151]
  v_pk_fma_f32 v[152:153], v[28:29], v[120:121], v[152:153]
  v_pk_fma_f32 v[154:155], v[30:31], v[122:123], v[154:155]
  v_pk_fma_f32 v[156:157], v[32:33], v[124:125], v[156:157]
  v_pk_fma_f32 v[158:159], v[34:35], v[126:127], v[158:159]
  v_pk_fma_f32 v[160:161], v[36:37], v[128:129], v[160:161]
  v_pk_fma_f32 v[162:163], v[38:39], v[130:131], v[162:163]
  v_pk_fma_f32 v[164:165], v[40:41], v[116:117], v[164:165]
  v_pk_fma_f32 v[166:167], v[42:43], v[118:119], v[166:167]
  v_pk_fma_f32 v[168:169], v[44:45], v[120:121], v[168:169]
  v_pk_fma_f32 v[170:171], v[46:47], v[122:123], v[170:171]
  v_pk_fma_f32 v[172:173], v[48:49], v[124:125], v[172:173]
  v_pk_fma_f32 v[174:175], v[50:51], v[126:127], v[174:175]
  v_pk_fma_f32 v[176:177], v[52:53], v[128:129], v[176:177]
  v_pk_fma_f32 v[178:179], v[54:55], v[130:131], v[178:179]
  s_cmp_eq_u32 s47, 1
  s_nop 0
  s_cbranch_scc1 EX_chk
EX_probe:
  buffer_load_dword v6, v113, s[64:67], s45 offen sc1
  s_waitcnt vmcnt(0)
  v_xor_b32 v6, v112, v6
  v_and_b32 v6, 0xff, v6
  v_cmp_ne_u32 vcc, 0, v6
  s_nop 4
  s_cbranch_vccz EX_try
  s_sleep 4
  s_branch EX_probe
EX_try:
  buffer_load_dwordx4 v[56:59], v12, s[64:67], s45 offen offset:0 sc1
  buffer_load_dwordx4 v[60:63], v12, s[64:67], s45 offen offset:1024 sc1
  buffer_load_dwordx4 v[64:67], v12, s[64:67], s45 offen offset:2048 sc1
  buffer_load_dwordx4 v[68:71], v12, s[64:67], s45 offen offset:3072 sc1
  buffer_load_dwordx4 v[72:75], v111, s[64:67], s45 offen offset:0 sc1
  buffer_load_dwordx4 v[76:79], v111, s[64:67], s45 offen offset:1024 sc1
  buffer_load_dwordx4 v[80:83], v111, s[64:67], s45 offen offset:2048 sc1
  buffer_load_dwordx4 v[84:87], v111, s[64:67], s45 offen offset:3072 sc1
EX_chk:
  s_waitcnt vmcnt(0)
  v_xor_b32 v56, v112, v56
  v_xor_b32 v60, v112, v60
  v_xor_b32 v64, v112, v64
  v_xor_b32 v68, v112, v68
  v_xor_b32 v72, v112, v72
  v_xor_b32 v76, v112, v76
  v_xor_b32 v80, v112, v80
  v_xor_b32 v84, v112, v84
  v_or3_b32 v4, v56, v60, v64
  v_or3_b32 v5, v68, v72, v76
  v_or3_b32 v4, v4, v80, v84
  v_or_b32 v4, v4, v5
  v_and_b32 v4, 0xff, v4
  v_cmp_ne_u32 vcc, 0, v4
  s_nop 4
  s_cbranch_vccz EX_ok
  s_sleep 4
  s_branch EX_try
EX_ok:
  v_pk_fma_f32 v[148:149], v[56:57], v[116:117], v[148:149]
  v_pk_fma_f32 v[150:151], v[58:59], v[118:119], v[150:151]
  v_pk_fma_f32 v[152:153], v[60:61], v[120:121], v[152:153]
  v_pk_fma_f32 v[154:155], v[62:63], v[122:123], v[154:155]
  v_pk_fma_f32 v[156:157], v[64:65], v[124:125], v[156:157]
  v_pk_fma_f32 v[158:159], v[66:67], v[126:127], v[158:159]
  v_pk_fma_f32 v[160:161], v[68:69], v[128:129], v[160:161]
  v_pk_fma_f32 v[162:163], v[70:71], v[130:131], v[162:163]
  v_cvt_pk_bf16_f32 v180, v148, v149
  v_cvt_pk_bf16_f32 v181, v150, v151
  v_cvt_pk_bf16_f32 v182, v152, v153
  v_cvt_pk_bf16_f32 v183, v154, v155
  v_cvt_pk_bf16_f32 v184, v156, v157
  v_cvt_pk_bf16_f32 v185, v158, v159
  v_cvt_pk_bf16_f32 v186, v160, v161
  v_cvt_pk_bf16_f32 v187, v162, v163
  v_permlane16_swap_b32 v180, v182
  v_permlane16_swap_b32 v181, v183
  v_permlane16_swap_b32 v184, v186
  v_permlane16_swap_b32 v185, v187
  buffer_store_dwordx4 v[180:183], v109, s[60:63], s41 offen offset:0 sc1
  buffer_store_dwordx4 v[184:187], v109, s[60:63], s41 offen offset:64 sc1
  v_pk_fma_f32 v[164:165], v[72:73], v[116:117], v[164:165]
  v_pk_fma_f32 v[166:167], v[74:75], v[118:119], v[166:167]
  v_pk_fma_f32 v[168:169], v[76:77], v[120:121], v[168:169]
  v_pk_fma_f32 v[170:171], v[78:79], v[122:123], v[170:171]
  v_pk_fma_f32 v[172:173], v[80:81], v[124:125], v[172:173]
  v_pk_fma_f32 v[174:175], v[82:83], v[126:127], v[174:175]
  v_pk_fma_f32 v[176:177], v[84:85], v[128:129], v[176:177]
  v_pk_fma_f32 v[178:179], v[86:87], v[130:131], v[178:179]
  v_cvt_pk_bf16_f32 v188, v164, v165
  v_cvt_pk_bf16_f32 v189, v166, v167
  v_cvt_pk_bf16_f32 v190, v168, v169
  v_cvt_pk_bf16_f32 v191, v170, v171
  v_cvt_pk_bf16_f32 v192, v172, v173
  v_cvt_pk_bf16_f32 v193, v174, v175
  v_cvt_pk_bf16_f32 v194, v176, v177
  v_cvt_pk_bf16_f32 v195, v178, v179
  v_permlane16_swap_b32 v188, v190
  v_permlane16_swap_b32 v189, v191
  v_permlane16_swap_b32 v192, v194
  v_permlane16_swap_b32 v193, v195
  s_add_u32 s41, s41, 4096
  buffer_store_dwordx4 v[188:191], v109, s[60:63], s41 offen offset:0 sc1
  buffer_store_dwordx4 v[192:195], v109, s[60:63], s41 offen offset:64 sc1
  s_endpgm
CG_loader:
  s_setprio 2
  s_sub_u32 s37, s18, 4
  s_lshl_b32 s38, s21, 18
  s_lshl_b32 s40, s37, 12
  s_add_u32 s38, s38, s40
  s_add_u32 s44, s6, 24117248
  s_addc_u32 s45, s7, 0
  s_mov_b32 s46, 4194304
  s_mov_b32 s47, 0x20000
  s_add_u32 s56, s6, 28311552
  s_addc_u32 s57, s7, 0
  s_mov_b32 s58, 14680064
  s_mov_b32 s59, 0x20000
  v_add_u32 v162, s26, v12
  s_lshl_b32 s20, s37, 11
  v_add_u32 v164, s20, v12
  v_add_u32 v165, 65536, v164
  s_mul_i32 s52, s21, 917504
  s_mul_i32 s20, s22, 57344
  s_add_u32 s52, s52, s20
  v_add_u32 v4, 0, v3
  v_lshlrev_b32 v4, 1, v4
  v_xor_b32 v4, v4, v2
  v_lshlrev_b32 v4, 4, v4
  v_lshl_add_u32 v160, v3, 11, v4
  v_add_u32 v4, 4, v3
  v_lshlrev_b32 v4, 1, v4
  v_xor_b32 v4, v4, v2
  v_lshlrev_b32 v4, 4, v4
  v_lshl_add_u32 v161, v3, 11, v4
  s_lshr_b32 s51, s22, 3
  s_mul_i32 s48, s21, 917504
  s_mul_i32 s20, s51, 458752
  s_add_u32 s48, s48, s20
  s_lshl_b32 s20, s23, 12
  s_add_u32 s48, s48, s20
  s_mul_i32 s49, s51, 3670016
  s_and_b32 s51, s22, 7
  s_lshl_b32 s20, s51, 8
  s_add_u32 s49, s49, s20
  s_lshl_b32 s20, s23, 15
  s_add_u32 s49, s49, s20
  s_mul_i32 s50, s51, 7
  s_add_u32 s50, s50, s24
  s_mov_b32 s60, s12
  s_mov_b32 s61, s13
  s_mov_b32 s62, 7340032
  s_mov_b32 s63, 0x20000
  s_barrier
  s_sub_u32 s64, s50, s24
  s_add_u32 s39, s38, 212992
  s_add_u32 m0, s40, 0
  s_nop 0
  buffer_load_dwordx4 v12, s[44:47], s39 offen offset:0 sc1 lds
  buffer_load_dwordx4 v12, s[44:47], s39 offen offset:1024 sc1 lds
  buffer_load_dwordx4 v12, s[44:47], s39 offen offset:2048 sc1 lds
  buffer_load_dwordx4 v12, s[44:47], s39 offen offset:3072 sc1 lds
  s_add_u32 s39, s38, 229376
  s_add_u32 m0, s40, 16384
  s_nop 0
  buffer_load_dwordx4 v12, s[44:47], s39 offen offset:0 sc1 lds
  buffer_load_dwordx4 v12, s[44:47], s39 offen offset:1024 sc1 lds
  buffer_load_dwordx4 v12, s[44:47], s39 offen offset:2048 sc1 lds
  buffer_load_dwordx4 v12, s[44:47], s39 offen offset:3072 sc1 lds
  s_add_u32 s39, s38, 245760
  s_add_u32 m0, s40, 32768
  s_nop 0
  buffer_load_dwordx4 v12, s[44:47], s39 offen offset:0 sc1 lds
  buffer_load_dwordx4 v12, s[44:47], s39 offen offset:1024 sc1 lds
  buffer_load_dwordx4 v12, s[44:47], s39 offen offset:2048 sc1 lds
  buffer_load_dwordx4 v12, s[44:47], s39 offen offset:3072 sc1 lds
  s_waitcnt vmcnt(8) lgkmcnt(0)
  s_barrier
  s_waitcnt vmcnt(4) lgkmcnt(0)
  s_barrier
  s_add_u32 s39, s38, 0
  s_add_u32 m0, s40, 0
  s_nop 0
  buffer_load_dwordx4 v12, s[44:47], s39 offen offset:0 sc1 lds
  buffer_load_dwordx4 v12, s[44:47], s39 offen offset:1024 sc1 lds
  buffer_load_dwordx4 v12, s[44:47], s39 offen offset:2048 sc1 lds
  buffer_load_dwordx4 v12, s[44:47], s39 offen offset:3072 sc1 lds
  s_add_u32 s20, s25, 0
  s_add_u32 m0, s26, 0
  s_nop 0
  buffer_load_dwordx4 v16, s[28:31], s20 offen lds
  s_add_u32 m0, s26, 1024
  s_nop 0
  buffer_load_dwordx4 v17, s[28:31], s20 offen lds
  s_add_u32 m0, s26, 2048
  s_nop 0
  buffer_load_dwordx4 v18, s[28:31], s20 offen lds
  s_add_u32 m0, s26, 3072
  s_nop 0
  buffer_load_dwordx4 v19, s[28:31], s20 offen lds
  s_add_u32 m0, s26, 4096
  s_nop 0
  buffer_load_dwordx4 v20, s[28:31], s20 offen lds
  s_add_u32 m0, s26, 5120
  s_nop 0
  buffer_load_dwordx4 v21, s[28:31], s20 offen lds
  s_add_u32 m0, s26, 6144
  s_nop 0
  buffer_load_dwordx4 v22, s[28:31], s20 offen lds
  s_waitcnt vmcnt(11) lgkmcnt(0)
  s_barrier
  s_add_u32 s39, s38, 16384
  s_add_u32 m0, s40, 16384
  s_nop 0
  buffer_load_dwordx4 v12, s[44:47], s39 offen offset:0 sc1 lds
  buffer_load_dwordx4 v12, s[44:47], s39 offen offset:1024 sc1 lds
  buffer_load_dwordx4 v12, s[44:47], s39 offen offset:2048 sc1 lds
  buffer_load_dwordx4 v12, s[44:47], s39 offen offset:3072 sc1 lds
  s_add_u32 s20, s25, 458752
  s_add_u32 m0, s26, 28672
  s_nop 0
  buffer_load_dwordx4 v16, s[28:31], s20 offen lds
  s_add_u32 m0, s26, 29696
  s_nop 0
  buffer_load_dwordx4 v17, s[28:31], s20 offen lds
  s_add_u32 m0, s26, 30720
  s_nop 0
  buffer_load_dwordx4 v18, s[28:31], s20 offen lds
  s_add_u32 m0, s26, 31744
  s_nop 0
  buffer_load_dwordx4 v19, s[28:31], s20 offen lds
  s_add_u32 m0, s26, 32768
  s_nop 0
  buffer_load_dwordx4 v20, s[28:31], s20 offen lds
  s_add_u32 m0, s26, 33792
  s_nop 0
  buffer_load_dwordx4 v21, s[28:31], s20 offen lds
  s_add_u32 m0, s26, 34816
  s_nop 0
  buffer_load_dwordx4 v22, s[28:31], s20 offen lds
  s_waitcnt vmcnt(11) lgkmcnt(0)
  s_barrier
  s_add_u32 s39, s38, 32768
  s_add_u32 m0, s40, 32768
  s_nop 0
  buffer_load_dwordx4 v12, s[44:47], s39 offen offset:0 sc1 lds
  buffer_load_dwordx4 v12, s[44:47], s39 offen offset:1024 sc1 lds
  buffer_load_dwordx4 v12, s[44:47], s39 offen offset:2048 sc1 lds
  buffer_load_dwordx4 v12, s[44:47], s39 offen offset:3072 sc1 lds
  s_add_u32 s20, s25, 917504
  s_add_u32 m0, s26, 57344
  s_nop 0
  buffer_load_dwordx4 v16, s[28:31], s20 offen lds
  s_add_u32 m0, s26, 58368
  s_nop 0
  buffer_load_dwordx4 v17, s[28:31], s20 offen lds
  s_add_u32 m0, s26, 59392
  s_nop 0
  buffer_load_dwordx4 v18, s[28:31], s20 offen lds
  s_add_u32 m0, s26, 60416
  s_nop 0
  buffer_load_dwordx4 v19, s[28:31], s20 offen lds
  s_add_u32 m0, s26, 61440
  s_nop 0
  buffer_load_dwordx4 v20, s[28:31], s20 offen lds
  s_add_u32 m0, s26, 62464
  s_nop 0
  buffer_load_dwordx4 v21, s[28:31], s20 offen lds
  s_add_u32 m0, s26, 63488
  s_nop 0
  buffer_load_dwordx4 v22, s[28:31], s20 offen lds
  s_waitcnt vmcnt(11) lgkmcnt(0)
  s_barrier
  s_add_u32 s39, s38, 49152
  s_add_u32 m0, s40, 0
  s_nop 0
  buffer_load_dwordx4 v12, s[44:47], s39 offen offset:0 sc1 lds
  buffer_load_dwordx4 v12, s[44:47], s39 offen offset:1024 sc1 lds
  buffer_load_dwordx4 v12, s[44:47], s39 offen offset:2048 sc1 lds
  buffer_load_dwordx4 v12, s[44:47], s39 offen offset:3072 sc1 lds
  s_add_u32 s20, s25, 1376256
  s_add_u32 m0, s26, 0
  s_nop 0
  buffer_load_dwordx4 v16, s[28:31], s20 offen lds
  s_add_u32 m0, s26, 1024
  s_nop 0
  buffer_load_dwordx4 v17, s[28:31], s20 offen lds
  s_add_u32 m0, s26, 2048
  s_nop 0
  buffer_load_dwordx4 v18, s[28:31], s20 offen lds
  s_add_u32 m0, s26, 3072
  s_nop 0
  buffer_load_dwordx4 v19, s[28:31], s20 offen lds
  s_add_u32 m0, s26, 4096
  s_nop 0
  buffer_load_dwordx4 v20, s[28:31], s20 offen lds
  s_add_u32 m0, s26, 5120
  s_nop 0
  buffer_load_dwordx4 v21, s[28:31], s20 offen lds
  s_add_u32 m0, s26, 6144
  s_nop 0
  buffer_load_dwordx4 v22, s[28:31], s20 offen lds
  s_waitcnt vmcnt(11) lgkmcnt(0)
  s_barrier
  s_add_u32 s39, s38, 65536
  s_add_u32 m0, s40, 16384
  s_nop 0
  buffer_load_dwordx4 v12, s[44:47], s39 offen offset:0 sc1 lds
  buffer_load_dwordx4 v12, s[44:47], s39 offen offset:1024 sc1 lds
  buffer_load_dwordx4 v12, s[44:47], s39 offen offset:2048 sc1 lds
  buffer_load_dwordx4 v12, s[44:47], s39 offen offset:3072 sc1 lds
  s_add_u32 s20, s25, 1835008
  s_add_u32 m0, s26, 28672
  s_nop 0
  buffer_load_dwordx4 v16, s[28:31], s20 offen lds
  s_add_u32 m0, s26, 29696
  s_nop 0
  buffer_load_dwordx4 v17, s[28:31], s20 offen lds
  s_add_u32 m0, s26, 30720
  s_nop 0
  buffer_load_dwordx4 v18, s[28:31], s20 offen lds
  s_add_u32 m0, s26, 31744
  s_nop 0
  buffer_load_dwordx4 v19, s[28:31], s20 offen lds
  s_add_u32 m0, s26, 32768
  s_nop 0
  buffer_load_dwordx4 v20, s[28:31], s20 offen lds
  s_add_u32 m0, s26, 33792
  s_nop 0
  buffer_load_dwordx4 v21, s[28:31], s20 offen lds
  s_add_u32 m0, s26, 34816
  s_nop 0
  buffer_load_dwordx4 v22, s[28:31], s20 offen lds
  s_waitcnt vmcnt(11) lgkmcnt(0)
  s_barrier
  s_add_u32 s39, s38, 81920
  s_add_u32 m0, s40, 32768
  s_nop 0
  buffer_load_dwordx4 v12, s[44:47], s39 offen offset:0 sc1 lds
  buffer_load_dwordx4 v12, s[44:47], s39 offen offset:1024 sc1 lds
  buffer_load_dwordx4 v12, s[44:47], s39 offen offset:2048 sc1 lds
  buffer_load_dwordx4 v12, s[44:47], s39 offen offset:3072 sc1 lds
  s_add_u32 s20, s25, 2293760
  s_add_u32 m0, s26, 57344
  s_nop 0
  buffer_load_dwordx4 v16, s[28:31], s20 offen lds
  s_add_u32 m0, s26, 58368
  s_nop 0
  buffer_load_dwordx4 v17, s[28:31], s20 offen lds
  s_add_u32 m0, s26, 59392
  s_nop 0
  buffer_load_dwordx4 v18, s[28:31], s20 offen lds
  s_add_u32 m0, s26, 60416
  s_nop 0
  buffer_load_dwordx4 v19, s[28:31], s20 offen lds
  s_add_u32 m0, s26, 61440
  s_nop 0
  buffer_load_dwordx4 v20, s[28:31], s20 offen lds
  s_add_u32 m0, s26, 62464
  s_nop 0
  buffer_load_dwordx4 v21, s[28:31], s20 offen lds
  s_add_u32 m0, s26, 63488
  s_nop 0
  buffer_load_dwordx4 v22, s[28:31], s20 offen lds
  s_waitcnt vmcnt(11) lgkmcnt(0)
  s_barrier
  s_add_u32 s39, s38, 98304
  s_add_u32 m0, s40, 0
  s_nop 0
  buffer_load_dwordx4 v12, s[44:47], s39 offen offset:0 sc1 lds
  buffer_load_dwordx4 v12, s[44:47], s39 offen offset:1024 sc1 lds
  buffer_load_dwordx4 v12, s[44:47], s39 offen offset:2048 sc1 lds
  buffer_load_dwordx4 v12, s[44:47], s39 offen offset:3072 sc1 lds
  s_add_u32 s20, s25, 2752512
  s_add_u32 m0, s26, 0
  s_nop 0
  buffer_load_dwordx4 v16, s[28:31], s20 offen lds
  s_add_u32 m0, s26, 1024
  s_nop 0
  buffer_load_dwordx4 v17, s[28:31], s20 offen lds
  s_add_u32 m0, s26, 2048
  s_nop 0
  buffer_load_dwordx4 v18, s[28:31], s20 offen lds
  s_add_u32 m0, s26, 3072
  s_nop 0
  buffer_load_dwordx4 v19, s[28:31], s20 offen lds
  s_add_u32 m0, s26, 4096
  s_nop 0
  buffer_load_dwordx4 v20, s[28:31], s20 offen lds
  s_add_u32 m0, s26, 5120
  s_nop 0
  buffer_load_dwordx4 v21, s[28:31], s20 offen lds
  s_add_u32 m0, s26, 6144
  s_nop 0
  buffer_load_dwordx4 v22, s[28:31], s20 offen lds
  s_waitcnt vmcnt(11) lgkmcnt(0)
  s_barrier
  s_add_u32 s39, s38, 114688
  s_add_u32 m0, s40, 16384
  s_nop 0
  buffer_load_dwordx4 v12, s[44:47], s39 offen offset:0 sc1 lds
  buffer_load_dwordx4 v12, s[44:47], s39 offen offset:1024 sc1 lds
  buffer_load_dwordx4 v12, s[44:47], s39 offen offset:2048 sc1 lds
  buffer_load_dwordx4 v12, s[44:47], s39 offen offset:3072 sc1 lds
  s_add_u32 s20, s25, 3211264
  s_add_u32 m0, s26, 28672
  s_nop 0
  buffer_load_dwordx4 v16, s[28:31], s20 offen lds
  s_add_u32 m0, s26, 29696
  s_nop 0
  buffer_load_dwordx4 v17, s[28:31], s20 offen lds
  s_add_u32 m0, s26, 30720
  s_nop 0
  buffer_load_dwordx4 v18, s[28:31], s20 offen lds
  s_add_u32 m0, s26, 31744
  s_nop 0
  buffer_load_dwordx4 v19, s[28:31], s20 offen lds
  s_add_u32 m0, s26, 32768
  s_nop 0
  buffer_load_dwordx4 v20, s[28:31], s20 offen lds
  s_add_u32 m0, s26, 33792
  s_nop 0
  buffer_load_dwordx4 v21, s[28:31], s20 offen lds
  s_add_u32 m0, s26, 34816
  s_nop 0
  buffer_load_dwordx4 v22, s[28:31], s20 offen lds
  s_waitcnt vmcnt(11) lgkmcnt(0)
  s_barrier
  s_add_u32 s39, s38, 131072
  s_add_u32 m0, s40, 32768
  s_nop 0
  buffer_load_dwordx4 v12, s[44:47], s39 offen offset:0 sc1 lds
  buffer_load_dwordx4 v12, s[44:47], s39 offen offset:1024 sc1 lds
  buffer_load_dwordx4 v12, s[44:47], s39 offen offset:2048 sc1 lds
  buffer_load_dwordx4 v12, s[44:47], s39 offen offset:3072 sc1 lds
  s_add_u32 s20, s25, 3670016
  s_add_u32 m0, s26, 57344
  s_nop 0
  buffer_load_dwordx4 v16, s[28:31], s20 offen lds
  s_add_u32 m0, s26, 58368
  s_nop 0
  buffer_load_dwordx4 v17, s[28:31], s20 offen lds
  s_add_u32 m0, s26, 59392
  s_nop 0
  buffer_load_dwordx4 v18, s[28:31], s20 offen lds
  s_add_u32 m0, s26, 60416
  s_nop 0
  buffer_load_dwordx4 v19, s[28:31], s20 offen lds
  s_add_u32 m0, s26, 61440
  s_nop 0
  buffer_load_dwordx4 v20, s[28:31], s20 offen lds
  s_add_u32 m0, s26, 62464
  s_nop 0
  buffer_load_dwordx4 v21, s[28:31], s20 offen lds
  s_add_u32 m0, s26, 63488
  s_nop 0
  buffer_load_dwordx4 v22, s[28:31], s20 offen lds
  s_waitcnt vmcnt(11) lgkmcnt(0)
  s_barrier
  s_add_u32 s39, s38, 147456
  s_add_u32 m0, s40, 0
  s_nop 0
  buffer_load_dwordx4 v12, s[44:47], s39 offen offset:0 sc1 lds
  buffer_load_dwordx4 v12, s[44:47], s39 offen offset:1024 sc1 lds
  buffer_load_dwordx4 v12, s[44:47], s39 offen offset:2048 sc1 lds
  buffer_load_dwordx4 v12, s[44:47], s39 offen offset:3072 sc1 lds
  s_add_u32 s20, s25, 4128768
  s_add_u32 m0, s26, 0
  s_nop 0
  buffer_load_dwordx4 v16, s[28:31], s20 offen lds
  s_add_u32 m0, s26, 1024
  s_nop 0
  buffer_load_dwordx4 v17, s[28:31], s20 offen lds
  s_add_u32 m0, s26, 2048
  s_nop 0
  buffer_load_dwordx4 v18, s[28:31], s20 offen lds
  s_add_u32 m0, s26, 3072
  s_nop 0
  buffer_load_dwordx4 v19, s[28:31], s20 offen lds
  s_add_u32 m0, s26, 4096
  s_nop 0
  buffer_load_dwordx4 v20, s[28:31], s20 offen lds
  s_add_u32 m0, s26, 5120
  s_nop 0
  buffer_load_dwordx4 v21, s[28:31], s20 offen lds
  s_add_u32 m0, s26, 6144
  s_nop 0
  buffer_load_dwordx4 v22, s[28:31], s20 offen lds
  s_cmp_lg_u32 s18, 4
  s_cbranch_scc1 CW7678_uni_kernel
  s_lshr_b32 s65, s2, 3
  s_and_b32 s65, s65, 31
  s_getpc_b64 s[66:67]
CP7682_uni_kernel:
  s_add_u32 s66, s66, CG_epi1-CP7682_uni_kernel
  s_addc_u32 s67, s67, -1
  s_lshl_b32 s70, s65, 7
  v_lshl_add_u32 v6, v1, 12, s70
  v_cmp_gt_u32 vcc, CODE_END-CG_epi1, v6
  s_nop 0
  s_and_saveexec_b64 s[68:69], vcc
  s_nop 2
  s_cbranch_execz CP7682_uni_kernele
  v_mov_b32 v7, s67
  v_add_co_u32 v6, vcc, s66, v6
  s_nop 1
  v_addc_co_u32 v7, vcc, 0, v7, vcc
  global_load_dword v8, v[6:7], off
CP7682_uni_kernele:
  s_mov_b64 exec, s[68:69]
CW7678_uni_kernel:
  s_waitcnt vmcnt(11) lgkmcnt(0)
  s_barrier
  s_add_u32 s39, s38, 163840
  s_add_u32 m0, s40, 16384
  s_nop 0
  buffer_load_dwordx4 v12, s[44:47], s39 offen offset:0 sc1 lds
  buffer_load_dwordx4 v12, s[44:47], s39 offen offset:1024 sc1 lds
  buffer_load_dwordx4 v12, s[44:47], s39 offen offset:2048 sc1 lds
  buffer_load_dwordx4 v12, s[44:47], s39 offen offset:3072 sc1 lds
  s_add_u32 s20, s25, 4587520
  s_add_u32 m0, s26, 28672
  s_nop 0
  buffer_load_dwordx4 v16, s[28:31], s20 offen lds
  s_add_u32 m0, s26, 29696
  s_nop 0
  buffer_load_dwordx4 v17, s[28:31], s20 offen lds
  s_add_u32 m0, s26, 30720
  s_nop 0
  buffer_load_dwordx4 v18, s[28:31], s20 offen lds
  s_add_u32 m0, s26, 31744
  s_nop 0
  buffer_load_dwordx4 v19, s[28:31], s20 offen lds
  s_add_u32 m0, s26, 32768
  s_nop 0
  buffer_load_dwordx4 v20, s[28:31], s20 offen lds
  s_add_u32 m0, s26, 33792
  s_nop 0
  buffer_load_dwordx4 v21, s[28:31], s20 offen lds
  s_add_u32 m0, s26, 34816
  s_nop 0
  buffer_load_dwordx4 v22, s[28:31], s20 offen lds
  s_waitcnt vmcnt(11) lgkmcnt(0)
  s_barrier
  s_add_u32 s39, s38, 180224
  s_add_u32 m0, s40, 32768
  s_nop 0
  buffer_load_dwordx4 v12, s[44:47], s39 offen offset:0 sc1 lds
  buffer_load_dwordx4 v12, s[44:47], s39 offen offset:1024 sc1 lds
  buffer_load_dwordx4 v12, s[44:47], s39 offen offset:2048 sc1 lds
  buffer_load_dwordx4 v12, s[44:47], s39 offen offset:3072 sc1 lds
  s_add_u32 s20, s25, 5046272
  s_add_u32 m0, s26, 57344
  s_nop 0
  buffer_load_dwordx4 v16, s[28:31], s20 offen lds
  s_add_u32 m0, s26, 58368
  s_nop 0
  buffer_load_dwordx4 v17, s[28:31], s20 offen lds
  s_add_u32 m0, s26, 59392
  s_nop 0
  buffer_load_dwordx4 v18, s[28:31], s20 offen lds
  s_add_u32 m0, s26, 60416
  s_nop 0
  buffer_load_dwordx4 v19, s[28:31], s20 offen lds
  s_add_u32 m0, s26, 61440
  s_nop 0
  buffer_load_dwordx4 v20, s[28:31], s20 offen lds
  s_add_u32 m0, s26, 62464
  s_nop 0
  buffer_load_dwordx4 v21, s[28:31], s20 offen lds
  s_add_u32 m0, s26, 63488
  s_nop 0
  buffer_load_dwordx4 v22, s[28:31], s20 offen lds
  s_waitcnt vmcnt(11) lgkmcnt(0)
  s_barrier
  s_add_u32 s39, s38, 196608
  s_add_u32 m0, s40, 0
  s_nop 0
  buffer_load_dwordx4 v12, s[44:47], s39 offen offset:0 sc1 lds
  buffer_load_dwordx4 v12, s[44:47], s39 offen offset:1024 sc1 lds
  buffer_load_dwordx4 v12, s[44:47], s39 offen offset:2048 sc1 lds
  buffer_load_dwordx4 v12, s[44:47], s39 offen offset:3072 sc1 lds
  s_add_u32 s20, s25, 5505024
  s_add_u32 m0, s26, 0
  s_nop 0
  buffer_load_dwordx4 v16, s[28:31], s20 offen lds
  s_add_u32 m0, s26, 1024
  s_nop 0
  buffer_load_dwordx4 v17, s[28:31], s20 offen lds
  s_add_u32 m0, s26, 2048
  s_nop 0
  buffer_load_dwordx4 v18, s[28:31], s20 offen lds
  s_add_u32 m0, s26, 3072
  s_nop 0
  buffer_load_dwordx4 v19, s[28:31], s20 offen lds
  s_add_u32 m0, s26, 4096
  s_nop 0
  buffer_load_dwordx4 v20, s[28:31], s20 offen lds
  s_add_u32 m0, s26, 5120
  s_nop 0
  buffer_load_dwordx4 v21, s[28:31], s20 offen lds
  s_add_u32 m0, s26, 6144
  s_nop 0
  buffer_load_dwordx4 v22, s[28:31], s20 offen lds
  s_waitcnt vmcnt(11) lgkmcnt(0)
  s_barrier
  s_waitcnt vmcnt(0) lgkmcnt(0)
  s_barrier
  s_lshl_b32 s41, s21, 1
  s_lshr_b32 s20, s22, 3
  s_add_u32 s41, s41, s20
  s_lshl_b32 s41, s41, 12
  s_add_u32 s41, s41, 65536
  s_and_b32 s20, s22, 7
  s_lshl_b32 s20, s20, 2
  s_add_u32 s20, s20, s37
  s_lshl_b32 s20, s20, 7
  s_add_u32 s65, s41, s20
  v_and_b32 v6, 31, v1
  v_lshlrev_b32 v6, 7, v6
  s_barrier
  s_add_u32 m0, s40, 16384
  s_add_u32 s51, s50, 0
  s_lshl_b32 s51, s51, 16
  s_add_u32 s51, s51, s49
  buffer_load_dwordx4 v160, s[60:63], s51 offen lds
  s_add_u32 m0, s40, 17408
  s_add_u32 s51, s51, 8192
  buffer_load_dwordx4 v161, s[60:63], s51 offen lds
  s_add_u32 m0, s40, 18432
  s_add_u32 s51, s51, 8192
  buffer_load_dwordx4 v160, s[60:63], s51 offen lds
  s_add_u32 m0, s40, 19456
  s_add_u32 s51, s51, 8192
  buffer_load_dwordx4 v161, s[60:63], s51 offen lds
  s_add_u32 m0, s40, 49152
  s_add_u32 s51, s50, 2
  s_lshl_b32 s51, s51, 16
  s_add_u32 s51, s51, s49
  buffer_load_dwordx4 v160, s[60:63], s51 offen lds
  s_add_u32 m0, s40, 50176
  s_add_u32 s51, s51, 8192
  buffer_load_dwordx4 v161, s[60:63], s51 offen lds
  s_add_u32 m0, s40, 51200
  s_add_u32 s51, s51, 8192
  buffer_load_dwordx4 v160, s[60:63], s51 offen lds
  s_add_u32 m0, s40, 52224
  s_add_u32 s51, s51, 8192
  buffer_load_dwordx4 v161, s[60:63], s51 offen lds
  s_add_u32 m0, s40, 81920
  s_add_u32 s51, s50, 4
  s_lshl_b32 s51, s51, 16
  s_add_u32 s51, s51, s49
  buffer_load_dwordx4 v160, s[60:63], s51 offen lds
  s_add_u32 m0, s40, 82944
  s_add_u32 s51, s51, 8192
  buffer_load_dwordx4 v161, s[60:63], s51 offen lds
  s_add_u32 m0, s40, 83968
  s_add_u32 s51, s51, 8192
  buffer_load_dwordx4 v160, s[60:63], s51 offen lds
  s_add_u32 m0, s40, 84992
  s_add_u32 s51, s51, 8192
  buffer_load_dwordx4 v161, s[60:63], s51 offen lds
  s_barrier
  ds_read_b128 v[136:139], v165 offset:32768
  ds_read_b128 v[140:143], v165 offset:33792
  ds_read_b128 v[144:147], v164 offset:0
  ds_read_b128 v[148:151], v164 offset:1024
  ds_read_b128 v[152:155], v164 offset:40960
  ds_read_b128 v[156:159], v164 offset:41984
  s_add_u32 s20, s52, 49152
  s_waitcnt lgkmcnt(4)
  buffer_store_dwordx4 v[136:139], v164, s[56:59], s20 offen offset:0 sc1
  buffer_store_dwordx4 v[140:143], v164, s[56:59], s20 offen offset:1024 sc1
  s_add_u32 s20, s52, 0
  s_waitcnt lgkmcnt(2)
  buffer_store_dwordx4 v[144:147], v164, s[56:59], s20 offen offset:0 sc1
  buffer_store_dwordx4 v[148:151], v164, s[56:59], s20 offen offset:1024 sc1
  s_add_u32 s20, s52, 24576
  s_waitcnt lgkmcnt(0)
  buffer_store_dwordx4 v[152:155], v164, s[56:59], s20 offen offset:0 sc1
  buffer_store_dwordx4 v[156:159], v164, s[56:59], s20 offen offset:1024 sc1
  s_barrier
  s_waitcnt vmcnt(0)
  v_and_b32 v4, 31, v1
  v_lshlrev_b32 v4, 2, v4
  v_mov_b32 v5, s36
  buffer_store_dword v5, v4, s[32:35], s65 offen sc1
  ds_read_b128 v[136:139], v164 offset:8192
  ds_read_b128 v[140:143], v164 offset:9216
  ds_read_b128 v[144:147], v165 offset:0
  ds_read_b128 v[148:151], v165 offset:1024
  s_add_u32 s20, s52, 8192
  s_waitcnt lgkmcnt(2)
  buffer_store_dwordx4 v[136:139], v164, s[56:59], s20 offen offset:0 sc1
  buffer_store_dwordx4 v[140:143], v164, s[56:59], s20 offen offset:1024 sc1
  s_add_u32 s20, s52, 32768
  s_waitcnt lgkmcnt(0)
  buffer_store_dwordx4 v[144:147], v164, s[56:59], s20 offen offset:0 sc1
  buffer_store_dwordx4 v[148:151], v164, s[56:59], s20 offen offset:1024 sc1
  s_add_u32 m0, s40, 114688
  s_cmp_eq_u32 s24, 0
  s_cselect_b32 s51, 0, 0
  s_cmp_ge_u32 s51, s64
  s_cselect_b32 s39, 7, 0
  s_add_u32 s51, s51, s39
  s_add_u32 s39, s64, 6
  s_cmp_eq_u32 s24, 0
  s_cselect_b32 s51, s39, s51
  s_lshl_b32 s51, s51, 16
  s_add_u32 s51, s51, s49
  buffer_load_dwordx4 v160, s[60:63], s51 offen lds
  s_add_u32 m0, s40, 115712
  s_add_u32 s51, s51, 8192
  buffer_load_dwordx4 v161, s[60:63], s51 offen lds
  s_add_u32 m0, s40, 116736
  s_add_u32 s51, s51, 8192
  buffer_load_dwordx4 v160, s[60:63], s51 offen lds
  s_add_u32 m0, s40, 117760
  s_add_u32 s51, s51, 8192
  buffer_load_dwordx4 v161, s[60:63], s51 offen lds
  s_add_u32 m0, s40, 147456
  s_cmp_eq_u32 s24, 0
  s_cselect_b32 s51, 3, 6
  s_cmp_ge_u32 s51, s64
  s_cselect_b32 s39, 7, 0
  s_add_u32 s51, s51, s39
  s_lshl_b32 s51, s51, 16
  s_add_u32 s51, s51, s49
  buffer_load_dwordx4 v160, s[60:63], s51 offen lds
  s_add_u32 m0, s40, 148480
  s_add_u32 s51, s51, 8192
  buffer_load_dwordx4 v161, s[60:63], s51 offen lds
  s_add_u32 m0, s40, 149504
  s_add_u32 s51, s51, 8192
  buffer_load_dwordx4 v160, s[60:63], s51 offen lds
  s_add_u32 m0, s40, 150528
  s_add_u32 s51, s51, 8192
  buffer_load_dwordx4 v161, s[60:63], s51 offen lds
  s_barrier
  buffer_load_dword v7, v6, s[32:35], s41 offen sc1
  s_barrier
  s_waitcnt vmcnt(0)
  v_cmp_ne_u32 vcc, s36, v7
  s_nop 4
  s_cbranch_vccz CG_p2_ok
CG_p2:
  buffer_load_dword v7, v6, s[32:35], s41 offen sc1
  s_waitcnt vmcnt(0)
  v_cmp_ne_u32 vcc, s36, v7
  s_nop 4
  s_cbranch_vccz CG_p2_ok
  s_sleep 1
  s_branch CG_p2
CG_p2_ok:
  s_cmp_eq_u32 s24, 0
  s_cbranch_scc1 CG_h3
  s_add_u32 m0, s40, 98304
  s_cmp_eq_u32 s24, 0
  s_cselect_b32 s51, 0, 0
  s_cmp_ge_u32 s51, s64
  s_cselect_b32 s39, 7, 0
  s_add_u32 s51, s51, s39
  s_add_u32 s39, s64, 6
  s_cmp_eq_u32 s24, 0
  s_cselect_b32 s51, s39, s51
  s_lshl_b32 s51, s51, 13
  s_add_u32 s51, s51, s48
  buffer_load_dwordx4 v12, s[56:59], s51 offen offset:0 sc1 lds
  buffer_load_dwordx4 v12, s[56:59], s51 offen offset:1024 sc1 lds
  buffer_load_dwordx4 v12, s[56:59], s51 offen offset:2048 sc1 lds
  buffer_load_dwordx4 v12, s[56:59], s51 offen offset:3072 sc1 lds
CG_h3:
  s_add_u32 m0, s40, 131072
  s_cmp_eq_u32 s24, 0
  s_cselect_b32 s51, 3, 6
  s_cmp_ge_u32 s51, s64
  s_cselect_b32 s39, 7, 0
  s_add_u32 s51, s51, s39
  s_lshl_b32 s51, s51, 13
  s_add_u32 s51, s51, s48
  buffer_load_dwordx4 v12, s[56:59], s51 offen offset:0 sc1 lds
  buffer_load_dwordx4 v12, s[56:59], s51 offen offset:1024 sc1 lds
  buffer_load_dwordx4 v12, s[56:59], s51 offen offset:2048 sc1 lds
  buffer_load_dwordx4 v12, s[56:59], s51 offen offset:3072 sc1 lds
  s_sub_u32 s65, s65, s41
  s_sub_u32 s41, s41, 65536
  s_lshl_b32 s41, s41, 1
  s_add_u32 s41, s41, 786432
  s_add_u32 s65, s65, s41
  v_lshlrev_b32 v6, 7, v1
  v_and_b32 v4, 31, v1
  v_lshlrev_b32 v4, 2, v4
  v_mov_b32 v5, s36
  buffer_store_dword v5, v4, s[32:35], s65 offen sc1
  s_add_u32 m0, s40, 0
  s_cmp_eq_u32 s24, 0
  s_cselect_b32 s51, 7, 10
  s_cmp_ge_u32 s51, s64
  s_cselect_b32 s39, 7, 0
  s_add_u32 s51, s51, s39
  s_lshl_b32 s51, s51, 13
  s_add_u32 s51, s51, s48
  buffer_load_dwordx4 v12, s[56:59], s51 offen offset:0 sc1 lds
  buffer_load_dwordx4 v12, s[56:59], s51 offen offset:1024 sc1 lds
  buffer_load_dwordx4 v12, s[56:59], s51 offen offset:2048 sc1 lds
  buffer_load_dwordx4 v12, s[56:59], s51 offen offset:3072 sc1 lds
  s_add_u32 m0, s40, 16384
  s_cmp_eq_u32 s24, 0
  s_cselect_b32 s51, 7, 10
  s_cmp_ge_u32 s51, s64
  s_cselect_b32 s39, 7, 0
  s_add_u32 s51, s51, s39
  s_lshl_b32 s51, s51, 16
  s_add_u32 s51, s51, s49
  buffer_load_dwordx4 v160, s[60:63], s51 offen lds
  s_add_u32 m0, s40, 17408
  s_add_u32 s51, s51, 8192
  buffer_load_dwordx4 v161, s[60:63], s51 offen lds
  s_add_u32 m0, s40, 18432
  s_add_u32 s51, s51, 8192
  buffer_load_dwordx4 v160, s[60:63], s51 offen lds
  s_add_u32 m0, s40, 19456
  s_add_u32 s51, s51, 8192
  buffer_load_dwordx4 v161, s[60:63], s51 offen lds
  s_waitcnt vmcnt(17)
  s_barrier
  s_add_u32 m0, s40, 32768
  s_cmp_eq_u32 s24, 0
  s_cselect_b32 s51, 13, 14
  s_cmp_ge_u32 s51, s64
  s_cselect_b32 s39, 7, 0
  s_add_u32 s51, s51, s39
  s_lshl_b32 s51, s51, 13
  s_add_u32 s51, s51, s48
  buffer_load_dwordx4 v12, s[56:59], s51 offen offset:0 sc1 lds
  buffer_load_dwordx4 v12, s[56:59], s51 offen offset:1024 sc1 lds
  buffer_load_dwordx4 v12, s[56:59], s51 offen offset:2048 sc1 lds
  buffer_load_dwordx4 v12, s[56:59], s51 offen offset:3072 sc1 lds
  s_add_u32 m0, s40, 49152
  s_cmp_eq_u32 s24, 0
  s_cselect_b32 s51, 13, 14
  s_cmp_ge_u32 s51, s64
  s_cselect_b32 s39, 7, 0
  s_add_u32 s51, s51, s39
  s_lshl_b32 s51, s51, 16
  s_add_u32 s51, s51, s49
  buffer_load_dwordx4 v160, s[60:63], s51 offen lds
  s_add_u32 m0, s40, 50176
  s_add_u32 s51, s51, 8192
  buffer_load_dwordx4 v161, s[60:63], s51 offen lds
  s_add_u32 m0, s40, 51200
  s_add_u32 s51, s51, 8192
  buffer_load_dwordx4 v160, s[60:63], s51 offen lds
  s_add_u32 m0, s40, 52224
  s_add_u32 s51, s51, 8192
  buffer_load_dwordx4 v161, s[60:63], s51 offen lds
  s_waitcnt vmcnt(21)
  s_barrier
  s_add_u32 m0, s40, 65536
  s_cmp_eq_u32 s24, 0
  s_cselect_b32 s51, 17, 20
  s_cmp_ge_u32 s51, s64
  s_cselect_b32 s39, 7, 0
  s_add_u32 s51, s51, s39
  s_lshl_b32 s51, s51, 13
  s_add_u32 s51, s51, s48
  buffer_load_dwordx4 v12, s[56:59], s51 offen offset:0 sc1 lds
  buffer_load_dwordx4 v12, s[56:59], s51 offen offset:1024 sc1 lds
  buffer_load_dwordx4 v12, s[56:59], s51 offen offset:2048 sc1 lds
  buffer_load_dwordx4 v12, s[56:59], s51 offen offset:3072 sc1 lds
  s_add_u32 m0, s40, 81920
  s_cmp_eq_u32 s24, 0
  s_cselect_b32 s51, 17, 20
  s_cmp_ge_u32 s51, s64
  s_cselect_b32 s39, 7, 0
  s_add_u32 s51, s51, s39
  s_lshl_b32 s51, s51, 16
  s_add_u32 s51, s51, s49
  buffer_load_dwordx4 v160, s[60:63], s51 offen lds
  s_add_u32 m0, s40, 82944
  s_add_u32 s51, s51, 8192
  buffer_load_dwordx4 v161, s[60:63], s51 offen lds
  s_add_u32 m0, s40, 83968
  s_add_u32 s51, s51, 8192
  buffer_load_dwordx4 v160, s[60:63], s51 offen lds
  s_add_u32 m0, s40, 84992
  s_add_u32 s51, s51, 8192
  buffer_load_dwordx4 v161, s[60:63], s51 offen lds
  s_waitcnt vmcnt(25)
  s_barrier
  s_add_u32 m0, s40, 98304
  s_cmp_eq_u32 s24, 0
  s_cselect_b32 s51, 21, 24
  s_cmp_ge_u32 s51, s64
  s_cselect_b32 s39, 7, 0
  s_add_u32 s51, s51, s39
  s_lshl_b32 s51, s51, 13
  s_add_u32 s51, s51, s48
  buffer_load_dwordx4 v12, s[56:59], s51 offen offset:0 sc1 lds
  buffer_load_dwordx4 v12, s[56:59], s51 offen offset:1024 sc1 lds
  buffer_load_dwordx4 v12, s[56:59], s51 offen offset:2048 sc1 lds
  buffer_load_dwordx4 v12, s[56:59], s51 offen offset:3072 sc1 lds
  s_add_u32 m0, s40, 114688
  s_cmp_eq_u32 s24, 0
  s_cselect_b32 s51, 21, 24
  s_cmp_ge_u32 s51, s64
  s_cselect_b32 s39, 7, 0
  s_add_u32 s51, s51, s39
  s_lshl_b32 s51, s51, 16
  s_add_u32 s51, s51, s49
  buffer_load_dwordx4 v160, s[60:63], s51 offen lds
  s_add_u32 m0, s40, 115712
  s_add_u32 s51, s51, 8192
  buffer_load_dwordx4 v161, s[60:63], s51 offen lds
  s_add_u32 m0, s40, 116736
  s_add_u32 s51, s51, 8192
  buffer_load_dwordx4 v160, s[60:63], s51 offen lds
  s_add_u32 m0, s40, 117760
  s_add_u32 s51, s51, 8192
  buffer_load_dwordx4 v161, s[60:63], s51 offen lds
  s_waitcnt vmcnt(24)
  s_barrier
  s_add_u32 m0, s40, 131072
  s_cmp_eq_u32 s24, 0
  s_cselect_b32 s51, 27, 28
  s_cmp_ge_u32 s51, s64
  s_cselect_b32 s39, 7, 0
  s_add_u32 s51, s51, s39
  s_lshl_b32 s51, s51, 13
  s_add_u32 s51, s51, s48
  buffer_load_dwordx4 v12, s[56:59], s51 offen offset:0 sc1 lds
  buffer_load_dwordx4 v12, s[56:59], s51 offen offset:1024 sc1 lds
  buffer_load_dwordx4 v12, s[56:59], s51 offen offset:2048 sc1 lds
  buffer_load_dwordx4 v12, s[56:59], s51 offen offset:3072 sc1 lds
  s_add_u32 m0, s40, 147456
  s_cmp_eq_u32 s24, 0
  s_cselect_b32 s51, 27, 28
  s_cmp_ge_u32 s51, s64
  s_cselect_b32 s39, 7, 0
  s_add_u32 s51, s51, s39
  s_lshl_b32 s51, s51, 16
  s_add_u32 s51, s51, s49
  buffer_load_dwordx4 v160, s[60:63], s51 offen lds
  s_add_u32 m0, s40, 148480
  s_add_u32 s51, s51, 8192
  buffer_load_dwordx4 v161, s[60:63], s51 offen lds
  s_add_u32 m0, s40, 149504
  s_add_u32 s51, s51, 8192
  buffer_load_dwordx4 v160, s[60:63], s51 offen lds
  s_add_u32 m0, s40, 150528
  s_add_u32 s51, s51, 8192
  buffer_load_dwordx4 v161, s[60:63], s51 offen lds
  s_waitcnt vmcnt(24)
  s_barrier
  s_add_u32 m0, s40, 0
  s_cmp_eq_u32 s24, 0
  s_cselect_b32 s51, 31, 34
  s_cmp_ge_u32 s51, s64
  s_cselect_b32 s39, 7, 0
  s_add_u32 s51, s51, s39
  s_lshl_b32 s51, s51, 13
  s_add_u32 s51, s51, s48
  buffer_load_dwordx4 v12, s[56:59], s51 offen offset:0 sc1 lds
  buffer_load_dwordx4 v12, s[56:59], s51 offen offset:1024 sc1 lds
  buffer_load_dwordx4 v12, s[56:59], s51 offen offset:2048 sc1 lds
  buffer_load_dwordx4 v12, s[56:59], s51 offen offset:3072 sc1 lds
  s_add_u32 m0, s40, 16384
  s_cmp_eq_u32 s24, 0
  s_cselect_b32 s51, 31, 34
  s_cmp_ge_u32 s51, s64
  s_cselect_b32 s39, 7, 0
  s_add_u32 s51, s51, s39
  s_lshl_b32 s51, s51, 16
  s_add_u32 s51, s51, s49
  buffer_load_dwordx4 v160, s[60:63], s51 offen lds
  s_add_u32 m0, s40, 17408
  s_add_u32 s51, s51, 8192
  buffer_load_dwordx4 v161, s[60:63], s51 offen lds
  s_add_u32 m0, s40, 18432
  s_add_u32 s51, s51, 8192
  buffer_load_dwordx4 v160, s[60:63], s51 offen lds
  s_add_u32 m0, s40, 19456
  s_add_u32 s51, s51, 8192
  buffer_load_dwordx4 v161, s[60:63], s51 offen lds
  s_waitcnt vmcnt(24)
  s_barrier
  buffer_load_dword v7, v6, s[32:35], s41 offen sc1
  s_add_u32 m0, s40, 32768
  s_cmp_eq_u32 s24, 0
  s_cselect_b32 s51, 35, 38
  s_cmp_ge_u32 s51, s64
  s_cselect_b32 s39, 7, 0
  s_add_u32 s51, s51, s39
  s_lshl_b32 s51, s51, 13
  s_add_u32 s51, s51, s48
  buffer_load_dwordx4 v12, s[56:59], s51 offen offset:0 sc1 lds
  buffer_load_dwordx4 v12, s[56:59], s51 offen offset:1024 sc1 lds
  buffer_load_dwordx4 v12, s[56:59], s51 offen offset:2048 sc1 lds
  buffer_load_dwordx4 v12, s[56:59], s51 offen offset:3072 sc1 lds
  s_add_u32 m0, s40, 49152
  s_cmp_eq_u32 s24, 0
  s_cselect_b32 s51, 35, 38
  s_cmp_ge_u32 s51, s64
  s_cselect_b32 s39, 7, 0
  s_add_u32 s51, s51, s39
  s_lshl_b32 s51, s51, 16
  s_add_u32 s51, s51, s49
  buffer_load_dwordx4 v160, s[60:63], s51 offen lds
  s_add_u32 m0, s40, 50176
  s_add_u32 s51, s51, 8192
  buffer_load_dwordx4 v161, s[60:63], s51 offen lds
  s_add_u32 m0, s40, 51200
  s_add_u32 s51, s51, 8192
  buffer_load_dwordx4 v160, s[60:63], s51 offen lds
  s_add_u32 m0, s40, 52224
  s_add_u32 s51, s51, 8192
  buffer_load_dwordx4 v161, s[60:63], s51 offen lds
  s_waitcnt vmcnt(25)
  s_barrier
  s_add_u32 m0, s40, 65536
  s_cmp_eq_u32 s24, 0
  s_cselect_b32 s51, 41, 42
  s_cmp_ge_u32 s51, s64
  s_cselect_b32 s39, 7, 0
  s_add_u32 s51, s51, s39
  s_lshl_b32 s51, s51, 13
  s_add_u32 s51, s51, s48
  buffer_load_dwordx4 v12, s[56:59], s51 offen offset:0 sc1 lds
  buffer_load_dwordx4 v12, s[56:59], s51 offen offset:1024 sc1 lds
  buffer_load_dwordx4 v12, s[56:59], s51 offen offset:2048 sc1 lds
  buffer_load_dwordx4 v12, s[56:59], s51 offen offset:3072 sc1 lds
  s_add_u32 m0, s40, 81920
  s_cmp_eq_u32 s24, 0
  s_cselect_b32 s51, 41, 42
  s_cmp_ge_u32 s51, s64
  s_cselect_b32 s39, 7, 0
  s_add_u32 s51, s51, s39
  s_lshl_b32 s51, s51, 16
  s_add_u32 s51, s51, s49
  buffer_load_dwordx4 v160, s[60:63], s51 offen lds
  s_add_u32 m0, s40, 82944
  s_add_u32 s51, s51, 8192
  buffer_load_dwordx4 v161, s[60:63], s51 offen lds
  s_add_u32 m0, s40, 83968
  s_add_u32 s51, s51, 8192
  buffer_load_dwordx4 v160, s[60:63], s51 offen lds
  s_add_u32 m0, s40, 84992
  s_add_u32 s51, s51, 8192
  buffer_load_dwordx4 v161, s[60:63], s51 offen lds
  s_waitcnt vmcnt(25)
  s_barrier
  s_add_u32 m0, s40, 98304
  s_cmp_eq_u32 s24, 0
  s_cselect_b32 s51, 45, 48
  s_cmp_ge_u32 s51, s64
  s_cselect_b32 s39, 7, 0
  s_add_u32 s51, s51, s39
  s_lshl_b32 s51, s51, 13
  s_add_u32 s51, s51, s48
  buffer_load_dwordx4 v12, s[56:59], s51 offen offset:0 sc1 lds
  buffer_load_dwordx4 v12, s[56:59], s51 offen offset:1024 sc1 lds
  buffer_load_dwordx4 v12, s[56:59], s51 offen offset:2048 sc1 lds
  buffer_load_dwordx4 v12, s[56:59], s51 offen offset:3072 sc1 lds
  s_add_u32 m0, s40, 114688
  s_cmp_eq_u32 s24, 0
  s_cselect_b32 s51, 45, 48
  s_cmp_ge_u32 s51, s64
  s_cselect_b32 s39, 7, 0
  s_add_u32 s51, s51, s39
  s_lshl_b32 s51, s51, 16
  s_add_u32 s51, s51, s49
  buffer_load_dwordx4 v160, s[60:63], s51 offen lds
  s_add_u32 m0, s40, 115712
  s_add_u32 s51, s51, 8192
  buffer_load_dwordx4 v161, s[60:63], s51 offen lds
  s_add_u32 m0, s40, 116736
  s_add_u32 s51, s51, 8192
  buffer_load_dwordx4 v160, s[60:63], s51 offen lds
  s_add_u32 m0, s40, 117760
  s_add_u32 s51, s51, 8192
  buffer_load_dwordx4 v161, s[60:63], s51 offen lds
  s_waitcnt vmcnt(25)
  s_barrier
  s_waitcnt vmcnt(24)
  v_cmp_ne_u32 vcc, s36, v7
  s_nop 4
  s_cbranch_vccz CG_p2b_ok
CG_p2b:
  buffer_load_dword v7, v6, s[32:35], s41 offen sc1
  s_waitcnt vmcnt(0)
  v_cmp_ne_u32 vcc, s36, v7
  s_nop 4
  s_cbranch_vccz CG_p2b_ok
  s_sleep 1
  s_branch CG_p2b
CG_p2b_ok:
  s_add_u32 m0, s40, 131072
  s_cmp_eq_u32 s24, 0
  s_cselect_b32 s51, 1, 2
  s_cmp_ge_u32 s51, s64
  s_cselect_b32 s39, 7, 0
  s_add_u32 s51, s51, s39
  s_lshl_b32 s51, s51, 13
  s_add_u32 s51, s51, s48
  buffer_load_dwordx4 v12, s[56:59], s51 offen offset:0 sc1 lds
  buffer_load_dwordx4 v12, s[56:59], s51 offen offset:1024 sc1 lds
  buffer_load_dwordx4 v12, s[56:59], s51 offen offset:2048 sc1 lds
  buffer_load_dwordx4 v12, s[56:59], s51 offen offset:3072 sc1 lds
  s_add_u32 m0, s40, 147456
  s_cmp_eq_u32 s24, 0
  s_cselect_b32 s51, 1, 2
  s_cmp_ge_u32 s51, s64
  s_cselect_b32 s39, 7, 0
  s_add_u32 s51, s51, s39
  s_lshl_b32 s51, s51, 16
  s_add_u32 s51, s51, s49
  buffer_load_dwordx4 v160, s[60:63], s51 offen lds
  s_add_u32 m0, s40, 148480
  s_add_u32 s51, s51, 8192
  buffer_load_dwordx4 v161, s[60:63], s51 offen lds
  s_add_u32 m0, s40, 149504
  s_add_u32 s51, s51, 8192
  buffer_load_dwordx4 v160, s[60:63], s51 offen lds
  s_add_u32 m0, s40, 150528
  s_add_u32 s51, s51, 8192
  buffer_load_dwordx4 v161, s[60:63], s51 offen lds
  s_waitcnt vmcnt(24)
  s_barrier
  s_add_u32 m0, s40, 0
  s_cmp_eq_u32 s24, 0
  s_cselect_b32 s51, 4, 5
  s_cmp_ge_u32 s51, s64
  s_cselect_b32 s39, 7, 0
  s_add_u32 s51, s51, s39
  s_lshl_b32 s51, s51, 13
  s_add_u32 s51, s51, s48
  buffer_load_dwordx4 v12, s[56:59], s51 offen offset:0 sc1 lds
  buffer_load_dwordx4 v12, s[56:59], s51 offen offset:1024 sc1 lds
  buffer_load_dwordx4 v12, s[56:59], s51 offen offset:2048 sc1 lds
  buffer_load_dwordx4 v12, s[56:59], s51 offen offset:3072 sc1 lds
  s_add_u32 m0, s40, 16384
  s_cmp_eq_u32 s24, 0
  s_cselect_b32 s51, 4, 5
  s_cmp_ge_u32 s51, s64
  s_cselect_b32 s39, 7, 0
  s_add_u32 s51, s51, s39
  s_lshl_b32 s51, s51, 16
  s_add_u32 s51, s51, s49
  buffer_load_dwordx4 v160, s[60:63], s51 offen lds
  s_add_u32 m0, s40, 17408
  s_add_u32 s51, s51, 8192
  buffer_load_dwordx4 v161, s[60:63], s51 offen lds
  s_add_u32 m0, s40, 18432
  s_add_u32 s51, s51, 8192
  buffer_load_dwordx4 v160, s[60:63], s51 offen lds
  s_add_u32 m0, s40, 19456
  s_add_u32 s51, s51, 8192
  buffer_load_dwordx4 v161, s[60:63], s51 offen lds
  s_waitcnt vmcnt(24)
  s_barrier
  s_add_u32 m0, s40, 32768
  s_cmp_eq_u32 s24, 0
  s_cselect_b32 s51, 8, 9
  s_cmp_ge_u32 s51, s64
  s_cselect_b32 s39, 7, 0
  s_add_u32 s51, s51, s39
  s_lshl_b32 s51, s51, 13
  s_add_u32 s51, s51, s48
  buffer_load_dwordx4 v12, s[56:59], s51 offen offset:0 sc1 lds
  buffer_load_dwordx4 v12, s[56:59], s51 offen offset:1024 sc1 lds
  buffer_load_dwordx4 v12, s[56:59], s51 offen offset:2048 sc1 lds
  buffer_load_dwordx4 v12, s[56:59], s51 offen offset:3072 sc1 lds
  s_add_u32 m0, s40, 49152
  s_cmp_eq_u32 s24, 0
  s_cselect_b32 s51, 8, 9
  s_cmp_ge_u32 s51, s64
  s_cselect_b32 s39, 7, 0
  s_add_u32 s51, s51, s39
  s_lshl_b32 s51, s51, 16
  s_add_u32 s51, s51, s49
  buffer_load_dwordx4 v160, s[60:63], s51 offen lds
  s_add_u32 m0, s40, 50176
  s_add_u32 s51, s51, 8192
  buffer_load_dwordx4 v161, s[60:63], s51 offen lds
  s_add_u32 m0, s40, 51200
  s_add_u32 s51, s51, 8192
  buffer_load_dwordx4 v160, s[60:63], s51 offen lds
  s_add_u32 m0, s40, 52224
  s_add_u32 s51, s51, 8192
  buffer_load_dwordx4 v161, s[60:63], s51 offen lds
  s_waitcnt vmcnt(24)
  s_barrier
  s_add_u32 m0, s40, 65536
  s_cmp_eq_u32 s24, 0
  s_cselect_b32 s51, 11, 12
  s_cmp_ge_u32 s51, s64
  s_cselect_b32 s39, 7, 0
  s_add_u32 s51, s51, s39
  s_lshl_b32 s51, s51, 13
  s_add_u32 s51, s51, s48
  buffer_load_dwordx4 v12, s[56:59], s51 offen offset:0 sc1 lds
  buffer_load_dwordx4 v12, s[56:59], s51 offen offset:1024 sc1 lds
  buffer_load_dwordx4 v12, s[56:59], s51 offen offset:2048 sc1 lds
  buffer_load_dwordx4 v12, s[56:59], s51 offen offset:3072 sc1 lds
  s_add_u32 m0, s40, 81920
  s_cmp_eq_u32 s24, 0
  s_cselect_b32 s51, 11, 12
  s_cmp_ge_u32 s51, s64
  s_cselect_b32 s39, 7, 0
  s_add_u32 s51, s51, s39
  s_lshl_b32 s51, s51, 16
  s_add_u32 s51, s51, s49
  buffer_load_dwordx4 v160, s[60:63], s51 offen lds
  s_add_u32 m0, s40, 82944
  s_add_u32 s51, s51, 8192
  buffer_load_dwordx4 v161, s[60:63], s51 offen lds
  s_add_u32 m0, s40, 83968
  s_add_u32 s51, s51, 8192
  buffer_load_dwordx4 v160, s[60:63], s51 offen lds
  s_add_u32 m0, s40, 84992
  s_add_u32 s51, s51, 8192
  buffer_load_dwordx4 v161, s[60:63], s51 offen lds
  s_waitcnt vmcnt(24)
  s_barrier
  s_add_u32 m0, s40, 98304
  s_cmp_eq_u32 s24, 0
  s_cselect_b32 s51, 15, 16
  s_cmp_ge_u32 s51, s64
  s_cselect_b32 s39, 7, 0
  s_add_u32 s51, s51, s39
  s_lshl_b32 s51, s51, 13
  s_add_u32 s51, s51, s48
  buffer_load_dwordx4 v12, s[56:59], s51 offen offset:0 sc1 lds
  buffer_load_dwordx4 v12, s[56:59], s51 offen offset:1024 sc1 lds
  buffer_load_dwordx4 v12, s[56:59], s51 offen offset:2048 sc1 lds
  buffer_load_dwordx4 v12, s[56:59], s51 offen offset:3072 sc1 lds
  s_add_u32 m0, s40, 114688
  s_cmp_eq_u32 s24, 0
  s_cselect_b32 s51, 15, 16
  s_cmp_ge_u32 s51, s64
  s_cselect_b32 s39, 7, 0
  s_add_u32 s51, s51, s39
  s_lshl_b32 s51, s51, 16
  s_add_u32 s51, s51, s49
  buffer_load_dwordx4 v160, s[60:63], s51 offen lds
  s_add_u32 m0, s40, 115712
  s_add_u32 s51, s51, 8192
  buffer_load_dwordx4 v161, s[60:63], s51 offen lds
  s_add_u32 m0, s40, 116736
  s_add_u32 s51, s51, 8192
  buffer_load_dwordx4 v160, s[60:63], s51 offen lds
  s_add_u32 m0, s40, 117760
  s_add_u32 s51, s51, 8192
  buffer_load_dwordx4 v161, s[60:63], s51 offen lds
  s_waitcnt vmcnt(24)
  s_barrier
  s_add_u32 m0, s40, 131072
  s_cmp_eq_u32 s24, 0
  s_cselect_b32 s51, 18, 19
  s_cmp_ge_u32 s51, s64
  s_cselect_b32 s39, 7, 0
  s_add_u32 s51, s51, s39
  s_lshl_b32 s51, s51, 13
  s_add_u32 s51, s51, s48
  buffer_load_dwordx4 v12, s[56:59], s51 offen offset:0 sc1 lds
  buffer_load_dwordx4 v12, s[56:59], s51 offen offset:1024 sc1 lds
  buffer_load_dwordx4 v12, s[56:59], s51 offen offset:2048 sc1 lds
  buffer_load_dwordx4 v12, s[56:59], s51 offen offset:3072 sc1 lds
  s_add_u32 m0, s40, 147456
  s_cmp_eq_u32 s24, 0
  s_cselect_b32 s51, 18, 19
  s_cmp_ge_u32 s51, s64
  s_cselect_b32 s39, 7, 0
  s_add_u32 s51, s51, s39
  s_lshl_b32 s51, s51, 16
  s_add_u32 s51, s51, s49
  buffer_load_dwordx4 v160, s[60:63], s51 offen lds
  s_add_u32 m0, s40, 148480
  s_add_u32 s51, s51, 8192
  buffer_load_dwordx4 v161, s[60:63], s51 offen lds
  s_add_u32 m0, s40, 149504
  s_add_u32 s51, s51, 8192
  buffer_load_dwordx4 v160, s[60:63], s51 offen lds
  s_add_u32 m0, s40, 150528
  s_add_u32 s51, s51, 8192
  buffer_load_dwordx4 v161, s[60:63], s51 offen lds
  s_waitcnt vmcnt(24)
  s_barrier
  s_add_u32 m0, s40, 0
  s_cmp_eq_u32 s24, 0
  s_cselect_b32 s51, 22, 23
  s_cmp_ge_u32 s51, s64
  s_cselect_b32 s39, 7, 0
  s_add_u32 s51, s51, s39
  s_lshl_b32 s51, s51, 13
  s_add_u32 s51, s51, s48
  buffer_load_dwordx4 v12, s[56:59], s51 offen offset:0 sc1 lds
  buffer_load_dwordx4 v12, s[56:59], s51 offen offset:1024 sc1 lds
  buffer_load_dwordx4 v12, s[56:59], s51 offen offset:2048 sc1 lds
  buffer_load_dwordx4 v12, s[56:59], s51 offen offset:3072 sc1 lds
  s_add_u32 m0, s40, 16384
  s_cmp_eq_u32 s24, 0
  s_cselect_b32 s51, 22, 23
  s_cmp_ge_u32 s51, s64
  s_cselect_b32 s39, 7, 0
  s_add_u32 s51, s51, s39
  s_lshl_b32 s51, s51, 16
  s_add_u32 s51, s51, s49
  buffer_load_dwordx4 v160, s[60:63], s51 offen lds
  s_add_u32 m0, s40, 17408
  s_add_u32 s51, s51, 8192
  buffer_load_dwordx4 v161, s[60:63], s51 offen lds
  s_add_u32 m0, s40, 18432
  s_add_u32 s51, s51, 8192
  buffer_load_dwordx4 v160, s[60:63], s51 offen lds
  s_add_u32 m0, s40, 19456
  s_add_u32 s51, s51, 8192
  buffer_load_dwordx4 v161, s[60:63], s51 offen lds
  s_waitcnt vmcnt(24)
  s_barrier
  s_add_u32 m0, s40, 32768
  s_cmp_eq_u32 s24, 0
  s_cselect_b32 s51, 25, 26
  s_cmp_ge_u32 s51, s64
  s_cselect_b32 s39, 7, 0
  s_add_u32 s51, s51, s39
  s_lshl_b32 s51, s51, 13
  s_add_u32 s51, s51, s48
  buffer_load_dwordx4 v12, s[56:59], s51 offen offset:0 sc1 lds
  buffer_load_dwordx4 v12, s[56:59], s51 offen offset:1024 sc1 lds
  buffer_load_dwordx4 v12, s[56:59], s51 offen offset:2048 sc1 lds
  buffer_load_dwordx4 v12, s[56:59], s51 offen offset:3072 sc1 lds
  s_add_u32 m0, s40, 49152
  s_cmp_eq_u32 s24, 0
  s_cselect_b32 s51, 25, 26
  s_cmp_ge_u32 s51, s64
  s_cselect_b32 s39, 7, 0
  s_add_u32 s51, s51, s39
  s_lshl_b32 s51, s51, 16
  s_add_u32 s51, s51, s49
  buffer_load_dwordx4 v160, s[60:63], s51 offen lds
  s_add_u32 m0, s40, 50176
  s_add_u32 s51, s51, 8192
  buffer_load_dwordx4 v161, s[60:63], s51 offen lds
  s_add_u32 m0, s40, 51200
  s_add_u32 s51, s51, 8192
  buffer_load_dwordx4 v160, s[60:63], s51 offen lds
  s_add_u32 m0, s40, 52224
  s_add_u32 s51, s51, 8192
  buffer_load_dwordx4 v161, s[60:63], s51 offen lds
  s_waitcnt vmcnt(24)
  s_barrier
  s_add_u32 m0, s40, 65536
  s_cmp_eq_u32 s24, 0
  s_cselect_b32 s51, 29, 30
  s_cmp_ge_u32 s51, s64
  s_cselect_b32 s39, 7, 0
  s_add_u32 s51, s51, s39
  s_lshl_b32 s51, s51, 13
  s_add_u32 s51, s51, s48
  buffer_load_dwordx4 v12, s[56:59], s51 offen offset:0 sc1 lds
  buffer_load_dwordx4 v12, s[56:59], s51 offen offset:1024 sc1 lds
  buffer_load_dwordx4 v12, s[56:59], s51 offen offset:2048 sc1 lds
  buffer_load_dwordx4 v12, s[56:59], s51 offen offset:3072 sc1 lds
  s_add_u32 m0, s40, 81920
  s_cmp_eq_u32 s24, 0
  s_cselect_b32 s51, 29, 30
  s_cmp_ge_u32 s51, s64
  s_cselect_b32 s39, 7, 0
  s_add_u32 s51, s51, s39
  s_lshl_b32 s51, s51, 16
  s_add_u32 s51, s51, s49
  buffer_load_dwordx4 v160, s[60:63], s51 offen lds
  s_add_u32 m0, s40, 82944
  s_add_u32 s51, s51, 8192
  buffer_load_dwordx4 v161, s[60:63], s51 offen lds
  s_add_u32 m0, s40, 83968
  s_add_u32 s51, s51, 8192
  buffer_load_dwordx4 v160, s[60:63], s51 offen lds
  s_add_u32 m0, s40, 84992
  s_add_u32 s51, s51, 8192
  buffer_load_dwordx4 v161, s[60:63], s51 offen lds
  s_cmp_lg_u32 s18, 4
  s_cbranch_scc1 CW8542_uni_kernel
  s_lshr_b32 s66, s2, 3
  s_and_b32 s66, s66, 31
  s_getpc_b64 s[68:69]
CP8546_uni_kernel:
  s_add_u32 s68, s68, CG_epi2-CP8546_uni_kernel
  s_addc_u32 s69, s69, -1
  s_lshl_b32 s72, s66, 7
  v_lshl_add_u32 v8, v1, 12, s72
  v_cmp_gt_u32 vcc, CG_loader-CG_epi2, v8
  s_nop 0
  s_and_saveexec_b64 s[70:71], vcc
  s_nop 2
  s_cbranch_execz CP8546_uni_kernele
  v_mov_b32 v9, s69
  v_add_co_u32 v8, vcc, s68, v8
  s_nop 1
  v_addc_co_u32 v9, vcc, 0, v9, vcc
  global_load_dword v10, v[8:9], off
CP8546_uni_kernele:
  s_mov_b64 exec, s[70:71]
CW8542_uni_kernel:
  s_waitcnt vmcnt(24)
  s_barrier
  s_add_u32 m0, s40, 98304
  s_cmp_eq_u32 s24, 0
  s_cselect_b32 s51, 32, 33
  s_cmp_ge_u32 s51, s64
  s_cselect_b32 s39, 7, 0
  s_add_u32 s51, s51, s39
  s_lshl_b32 s51, s51, 13
  s_add_u32 s51, s51, s48
  buffer_load_dwordx4 v12, s[56:59], s51 offen offset:0 sc1 lds
  buffer_load_dwordx4 v12, s[56:59], s51 offen offset:1024 sc1 lds
  buffer_load_dwordx4 v12, s[56:59], s51 offen offset:2048 sc1 lds
  buffer_load_dwordx4 v12, s[56:59], s51 offen offset:3072 sc1 lds
  s_add_u32 m0, s40, 114688
  s_cmp_eq_u32 s24, 0
  s_cselect_b32 s51, 32, 33
  s_cmp_ge_u32 s51, s64
  s_cselect_b32 s39, 7, 0
  s_add_u32 s51, s51, s39
  s_lshl_b32 s51, s51, 16
  s_add_u32 s51, s51, s49
  buffer_load_dwordx4 v160, s[60:63], s51 offen lds
  s_add_u32 m0, s40, 115712
  s_add_u32 s51, s51, 8192
  buffer_load_dwordx4 v161, s[60:63], s51 offen lds
  s_add_u32 m0, s40, 116736
  s_add_u32 s51, s51, 8192
  buffer_load_dwordx4 v160, s[60:63], s51 offen lds
  s_add_u32 m0, s40, 117760
  s_add_u32 s51, s51, 8192
  buffer_load_dwordx4 v161, s[60:63], s51 offen lds
  s_waitcnt vmcnt(24)
  s_barrier
  s_add_u32 m0, s40, 131072
  s_cmp_eq_u32 s24, 0
  s_cselect_b32 s51, 36, 37
  s_cmp_ge_u32 s51, s64
  s_cselect_b32 s39, 7, 0
  s_add_u32 s51, s51, s39
  s_lshl_b32 s51, s51, 13
  s_add_u32 s51, s51, s48
  buffer_load_dwordx4 v12, s[56:59], s51 offen offset:0 sc1 lds
  buffer_load_dwordx4 v12, s[56:59], s51 offen offset:1024 sc1 lds
  buffer_load_dwordx4 v12, s[56:59], s51 offen offset:2048 sc1 lds
  buffer_load_dwordx4 v12, s[56:59], s51 offen offset:3072 sc1 lds
  s_add_u32 m0, s40, 147456
  s_cmp_eq_u32 s24, 0
  s_cselect_b32 s51, 36, 37
  s_cmp_ge_u32 s51, s64
  s_cselect_b32 s39, 7, 0
  s_add_u32 s51, s51, s39
  s_lshl_b32 s51, s51, 16
  s_add_u32 s51, s51, s49
  buffer_load_dwordx4 v160, s[60:63], s51 offen lds
  s_add_u32 m0, s40, 148480
  s_add_u32 s51, s51, 8192
  buffer_load_dwordx4 v161, s[60:63], s51 offen lds
  s_add_u32 m0, s40, 149504
  s_add_u32 s51, s51, 8192
  buffer_load_dwordx4 v160, s[60:63], s51 offen lds
  s_add_u32 m0, s40, 150528
  s_add_u32 s51, s51, 8192
  buffer_load_dwordx4 v161, s[60:63], s51 offen lds
  s_waitcnt vmcnt(24)
  s_barrier
  s_add_u32 m0, s40, 0
  s_cmp_eq_u32 s24, 0
  s_cselect_b32 s51, 39, 40
  s_cmp_ge_u32 s51, s64
  s_cselect_b32 s39, 7, 0
  s_add_u32 s51, s51, s39
  s_lshl_b32 s51, s51, 13
  s_add_u32 s51, s51, s48
  buffer_load_dwordx4 v12, s[56:59], s51 offen offset:0 sc1 lds
  buffer_load_dwordx4 v12, s[56:59], s51 offen offset:1024 sc1 lds
  buffer_load_dwordx4 v12, s[56:59], s51 offen offset:2048 sc1 lds
  buffer_load_dwordx4 v12, s[56:59], s51 offen offset:3072 sc1 lds
  s_add_u32 m0, s40, 16384
  s_cmp_eq_u32 s24, 0
  s_cselect_b32 s51, 39, 40
  s_cmp_ge_u32 s51, s64
  s_cselect_b32 s39, 7, 0
  s_add_u32 s51, s51, s39
  s_lshl_b32 s51, s51, 16
  s_add_u32 s51, s51, s49
  buffer_load_dwordx4 v160, s[60:63], s51 offen lds
  s_add_u32 m0, s40, 17408
  s_add_u32 s51, s51, 8192
  buffer_load_dwordx4 v161, s[60:63], s51 offen lds
  s_add_u32 m0, s40, 18432
  s_add_u32 s51, s51, 8192
  buffer_load_dwordx4 v160, s[60:63], s51 offen lds
  s_add_u32 m0, s40, 19456
  s_add_u32 s51, s51, 8192
  buffer_load_dwordx4 v161, s[60:63], s51 offen lds
  s_waitcnt vmcnt(24)
  s_barrier
  s_add_u32 m0, s40, 32768
  s_cmp_eq_u32 s24, 0
  s_cselect_b32 s51, 43, 44
  s_cmp_ge_u32 s51, s64
  s_cselect_b32 s39, 7, 0
  s_add_u32 s51, s51, s39
  s_lshl_b32 s51, s51, 13
  s_add_u32 s51, s51, s48
  buffer_load_dwordx4 v12, s[56:59], s51 offen offset:0 sc1 lds
  buffer_load_dwordx4 v12, s[56:59], s51 offen offset:1024 sc1 lds
  buffer_load_dwordx4 v12, s[56:59], s51 offen offset:2048 sc1 lds
  buffer_load_dwordx4 v12, s[56:59], s51 offen offset:3072 sc1 lds
  s_add_u32 m0, s40, 49152
  s_cmp_eq_u32 s24, 0
  s_cselect_b32 s51, 43, 44
  s_cmp_ge_u32 s51, s64
  s_cselect_b32 s39, 7, 0
  s_add_u32 s51, s51, s39
  s_lshl_b32 s51, s51, 16
  s_add_u32 s51, s51, s49
  buffer_load_dwordx4 v160, s[60:63], s51 offen lds
  s_add_u32 m0, s40, 50176
  s_add_u32 s51, s51, 8192
  buffer_load_dwordx4 v161, s[60:63], s51 offen lds
  s_add_u32 m0, s40, 51200
  s_add_u32 s51, s51, 8192
  buffer_load_dwordx4 v160, s[60:63], s51 offen lds
  s_add_u32 m0, s40, 52224
  s_add_u32 s51, s51, 8192
  buffer_load_dwordx4 v161, s[60:63], s51 offen lds
  s_waitcnt vmcnt(24)
  s_barrier
  s_add_u32 m0, s40, 65536
  s_cmp_eq_u32 s24, 0
  s_cselect_b32 s51, 46, 47
  s_cmp_ge_u32 s51, s64
  s_cselect_b32 s39, 7, 0
  s_add_u32 s51, s51, s39
  s_lshl_b32 s51, s51, 13
  s_add_u32 s51, s51, s48
  buffer_load_dwordx4 v12, s[56:59], s51 offen offset:0 sc1 lds
  buffer_load_dwordx4 v12, s[56:59], s51 offen offset:1024 sc1 lds
  buffer_load_dwordx4 v12, s[56:59], s51 offen offset:2048 sc1 lds
  buffer_load_dwordx4 v12, s[56:59], s51 offen offset:3072 sc1 lds
  s_add_u32 m0, s40, 81920
  s_cmp_eq_u32 s24, 0
  s_cselect_b32 s51, 46, 47
  s_cmp_ge_u32 s51, s64
  s_cselect_b32 s39, 7, 0
  s_add_u32 s51, s51, s39
  s_lshl_b32 s51, s51, 16
  s_add_u32 s51, s51, s49
  buffer_load_dwordx4 v160, s[60:63], s51 offen lds
  s_add_u32 m0, s40, 82944
  s_add_u32 s51, s51, 8192
  buffer_load_dwordx4 v161, s[60:63], s51 offen lds
  s_add_u32 m0, s40, 83968
  s_add_u32 s51, s51, 8192
  buffer_load_dwordx4 v160, s[60:63], s51 offen lds
  s_add_u32 m0, s40, 84992
  s_add_u32 s51, s51, 8192
  buffer_load_dwordx4 v161, s[60:63], s51 offen lds
  s_waitcnt vmcnt(24)
  s_barrier
  s_waitcnt vmcnt(16)
  s_barrier
  s_waitcnt vmcnt(8)
  s_barrier
  s_waitcnt vmcnt(0)
  s_barrier
CG_end:
  s_endpgm
CODE_END:
  s_endpgm
.section .rodata,"a"
.p2align 6
.amdhsa_kernel uni_kernel
  .amdhsa_next_free_vgpr 237
  .amdhsa_next_free_sgpr 96
  .amdhsa_accum_offset 240
  .amdhsa_group_segment_fixed_size 0
  .amdhsa_kernarg_size 104
  .amdhsa_user_sgpr_count 2
  .amdhsa_user_sgpr_kernarg_segment_ptr 1
  .amdhsa_system_sgpr_workgroup_id_x 1
.end_amdhsa_kernel
```
